```python
import torch

def _softmax(x, axis=-1):
    return torch.softmax(x, dim=axis)
def _gelu(x):
    return torch.nn.functional.gelu(x, approximate="tanh")
def _silu(x):
    return torch.nn.functional.silu(x)
def _sigmoid(x):
    return torch.sigmoid(x)
def _layernorm(x, axis=-1, eps=1e-5):
    m = x.mean(dim=axis, keepdim=True)
    v = x.var(dim=axis, keepdim=True, unbiased=False)
    return (x - m) / torch.sqrt(v + eps)
def _scatter_add(tgt, idx, src, axis=0):
    return tgt.clone().index_add_(axis, idx, src)
def _segment_sum(src, seg, n):
    out = torch.zeros((n,) + src.shape[1:], dtype=src.dtype)
    return out.index_add_(0, seg, src)
def _pad(x, pw):
    flat = tuple(v for pair in reversed(pw) for v in pair)
    return torch.nn.functional.pad(x, flat)

kernel_name = 'interleave_layers__sliding_block__glu_gated_geglu__prompt'

def setup_inputs():

    _w = (lambda a: (lambda t: t.to(torch.bfloat16) if t.is_floating_point() else t)(torch.as_tensor(a)))
    def _A_setup():
        B, S, D = 1, 2048, 640
        return {
            "x": _w((lambda *s: torch.randn(*s, dtype=torch.bfloat16) * 0.05)(B, S, D)),
            "wqkv": _w((lambda *s: torch.randn(*s, dtype=torch.bfloat16) * 0.05)(D, 3 * D)),
            "wo": _w((lambda *s: torch.randn(*s, dtype=torch.bfloat16) * 0.05)(D, D)),
        }
    _A_in = _A_setup()

    def _B_setup():
        B, S, Dm, Df = 1, 2048, 640, 1728
        return {
            "x": _w((lambda *s: torch.randn(*s, dtype=torch.bfloat16) * 0.05)(B, S, Dm)),
            "w_gate": _w((lambda *s: torch.randn(*s, dtype=torch.bfloat16) * 0.8)(Dm, Df) * (Dm ** -0.5)),
            "w_up": _w((lambda *s: torch.randn(*s, dtype=torch.bfloat16) * 0.8)(Dm, Df) * (Dm ** -0.5)),
            "w_down": _w((lambda *s: torch.randn(*s, dtype=torch.bfloat16) * 0.8)(Df, Dm) * (Df ** -0.5)),
        }
    _B_in = _B_setup()

    return {
        "A_x": _A_in["x"],
        "A_wqkv": _A_in["wqkv"],
        "A_wo": _A_in["wo"],
        "B_x": _B_in["x"],
        "B_w_gate": _B_in["w_gate"],
        "B_w_up": _B_in["w_up"],
        "B_w_down": _B_in["w_down"],
    }

def reference(A_x, A_wqkv, A_wo, B_x, B_w_gate, B_w_up, B_w_down):
    def _A_ref(x, wqkv, wo):
        B, S, D = x.shape
        H = 32; Dh = D // H; W = 256
        qkv = (lambda x, *d: x.permute(*d))((x @ wqkv).reshape(B, S, 3, H, Dh), 2, 0, 3, 1, 4)
        q, k, v = qkv[0], qkv[1], qkv[2]
        scores = torch.einsum("bhqd,bhkd->bhqk", q, k) * (Dh ** -0.5)
        idx = torch.arange(S)
        mask = (idx[:, None] - idx[None, :] >= 0) & (idx[:, None] - idx[None, :] < W)
        scores = torch.where(mask[None, None], scores, -1e9)
        p = _softmax(scores, axis=-1)
        o = torch.einsum("bhqk,bhkd->bhqd", p, v)
        return (lambda x, *d: x.permute(*d))(o, 0, 2, 1, 3).reshape(B, S, D) @ wo

    def _B_ref(x, w_gate, w_up, w_down):
        g = torch.einsum("bsd,df->bsf", x, w_gate)
        u = torch.einsum("bsd,df->bsf", x, w_up)
        h = _gelu(g) * u
        return torch.einsum("bsf,fd->bsd", h, w_down)

    x = A_x
    x = x + _A_ref(_layernorm(x, axis=-1), A_wqkv, A_wo)
    x = x + _B_ref(_layernorm(x, axis=-1), B_w_gate, B_w_up, B_w_down)
    x = x + _A_ref(_layernorm(x, axis=-1), A_wqkv, A_wo)
    x = x + _B_ref(_layernorm(x, axis=-1), B_w_gate, B_w_up, B_w_down)
    return x
```

```asm
; @launch grid=(256,1,1) block=(512,1,1) lds=163840
.amdgcn_target "amdgcn-amd-amdhsa--gfx950"
.text
.globl interleave_layers__sliding_block__glu_gated_geglu__prompt_kernel
.p2align 8
.type interleave_layers__sliding_block__glu_gated_geglu__prompt_kernel,@function
interleave_layers__sliding_block__glu_gated_geglu__prompt_kernel:

    s_cmp_ge_u32 s2, 256
    s_cbranch_scc1 L_end
    s_load_dwordx4 s[4:7], s[0:1], 64
    s_load_dwordx4 s[84:87], s[0:1], 0
    s_load_dwordx2 s[88:89], s[0:1], 16
    s_load_dwordx8 s[92:99], s[0:1], 32
    v_lshrrev_b32 v2, 6, v0
    v_and_b32 v1, 63, v0
    v_readfirstlane_b32 s20, v2
    v_and_b32 v2, 31, v0
    v_lshrrev_b32 v3, 5, v1
    s_and_b32 s18, s2, 7
    s_lshr_b32 s19, s2, 3
    s_mov_b32 s16, 0
    s_mov_b32 s17, 0
    s_mov_b32 s3, 0x80000000
    s_waitcnt lgkmcnt(0)
    s_add_u32 s72, s6, 0x1880000
    s_addc_u32 s73, s7, 0
    s_mov_b32 s74, 0x20000
    s_mov_b32 s75, 0x20000
    s_cmp_ge_u32 s19, 30
    s_cbranch_scc1 L_p1a_idle
    s_and_b32 s26, s20, 3
    s_and_b32 s24, s19, 1
    s_lshl_b32 s24, s24, 7
    s_lshl_b32 s25, s26, 5
    s_add_u32 s24, s24, s25
    s_lshl_b32 s27, s18, 8
    s_add_u32 s27, s27, s24
    s_lshr_b32 s28, s19, 1
    s_mul_i32 s21, s18, 10
    s_lshr_b32 s21, s21, 3
    s_lshl_b32 s30, s21, 11
    s_mul_i32 s31, s21, 245760
    s_cmp_lt_u32 s20, 4
    s_cbranch_scc1 L_p1a_comp
    s_add_u32 s12, s86, 0x0
    s_addc_u32 s13, s87, 0
    s_mov_b32 s14, 0x258000
    s_mov_b32 s15, 0x20000
    v_lshrrev_b32 v20, 4, v1
    v_lshlrev_b32 v20, 3, v20
    v_add_u32 v20, s26, v20
    v_mul_u32_u24 v20, 3840, v20
    v_and_b32 v21, 15, v1
    v_lshl_add_u32 v20, v21, 4, v20
    s_lshl_b32 s25, s28, 8
    v_add_u32 v4, s25, v20
    v_add_u32 v5, 15360, v4
    v_add_u32 v6, 122880, v4
    v_add_u32 v7, 122880, v5
    s_mul_i32 s32, s26, 4160
    s_add_u32 m0, s32, 0
    s_nop 0
    buffer_load_dwordx4 v4, s[12:15], s31 offen lds
    s_add_u32 m0, s32, 1024
    s_nop 0
    buffer_load_dwordx4 v5, s[12:15], s31 offen lds
    s_add_u32 m0, s32, 2048
    s_nop 0
    buffer_load_dwordx4 v6, s[12:15], s31 offen lds
    s_add_u32 m0, s32, 3072
    s_nop 0
    buffer_load_dwordx4 v7, s[12:15], s31 offen lds
    s_add_u32 s31, s31, 245760
    s_cmp_ge_u32 s31, 2457600
    s_cselect_b32 s31, 0, s31
    s_add_u32 m0, s32, 16640
    s_nop 0
    buffer_load_dwordx4 v4, s[12:15], s31 offen lds
    s_add_u32 m0, s32, 17664
    s_nop 0
    buffer_load_dwordx4 v5, s[12:15], s31 offen lds
    s_add_u32 m0, s32, 18688
    s_nop 0
    buffer_load_dwordx4 v6, s[12:15], s31 offen lds
    s_add_u32 m0, s32, 19712
    s_nop 0
    buffer_load_dwordx4 v7, s[12:15], s31 offen lds
    s_add_u32 s31, s31, 245760
    s_cmp_ge_u32 s31, 2457600
    s_cselect_b32 s31, 0, s31
    s_branch L_p1a_ld
L_p1a_comp:
    s_add_u32 s8, s84, 0x0
    s_addc_u32 s9, s85, 0
    s_mov_b32 s10, 0x280000
    s_mov_b32 s11, 0x20000
    v_lshrrev_b32 v20, 3, v1
    v_add_u32 v20, s27, v20
    v_mul_u32_u24 v20, 1280, v20
    v_lshrrev_b32 v21, 4, v1
    v_and_b32 v22, 7, v1
    v_xor_b32 v21, v21, v22
    v_lshl_add_u32 v4, v21, 4, v20
    v_xor_b32 v21, 4, v21
    v_lshl_add_u32 v5, v21, 4, v20
    v_add_u32 v5, 10240, v5
    v_add_u32 v6, 20480, v4
    v_add_u32 v7, 20480, v5
    s_lshr_b32 s30, s30, 4
    s_mul_i32 s33, s26, 16384
    s_add_u32 s33, s33, 83200
    s_add_u32 m0, s33, 0
    s_nop 0
    buffer_load_dwordx4 v4, s[8:11], s30 offen lds
    s_add_u32 m0, s33, 1024
    s_nop 0
    buffer_load_dwordx4 v5, s[8:11], s30 offen lds
    s_add_u32 m0, s33, 2048
    s_nop 0
    buffer_load_dwordx4 v6, s[8:11], s30 offen lds
    s_add_u32 m0, s33, 3072
    s_nop 0
    buffer_load_dwordx4 v7, s[8:11], s30 offen lds
    s_add_u32 s30, s30, 128
    s_cmp_ge_u32 s30, 1280
    s_cselect_b32 s30, 0, s30
    s_add_u32 m0, s33, 4096
    s_nop 0
    buffer_load_dwordx4 v4, s[8:11], s30 offen lds
    s_add_u32 m0, s33, 5120
    s_nop 0
    buffer_load_dwordx4 v5, s[8:11], s30 offen lds
    s_add_u32 m0, s33, 6144
    s_nop 0
    buffer_load_dwordx4 v6, s[8:11], s30 offen lds
    s_add_u32 m0, s33, 7168
    s_nop 0
    buffer_load_dwordx4 v7, s[8:11], s30 offen lds
    s_add_u32 s30, s30, 128
    s_cmp_ge_u32 s30, 1280
    s_cselect_b32 s30, 0, s30
    s_add_u32 m0, s33, 8192
    s_nop 0
    buffer_load_dwordx4 v4, s[8:11], s30 offen lds
    s_add_u32 m0, s33, 9216
    s_nop 0
    buffer_load_dwordx4 v5, s[8:11], s30 offen lds
    s_add_u32 m0, s33, 10240
    s_nop 0
    buffer_load_dwordx4 v6, s[8:11], s30 offen lds
    s_add_u32 m0, s33, 11264
    s_nop 0
    buffer_load_dwordx4 v7, s[8:11], s30 offen lds
    s_add_u32 s30, s30, 128
    s_cmp_ge_u32 s30, 1280
    s_cselect_b32 s30, 0, s30
    v_bfe_u32 v20, v1, 2, 2
    v_mul_u32_u24 v9, 4160, v20
    v_mul_u32_u24 v20, 256, v3
    v_add_u32 v9, v9, v20
    v_bfe_u32 v20, v1, 4, 1
    v_mul_u32_u24 v20, 32, v20
    v_add_u32 v9, v9, v20
    v_and_b32 v20, 3, v1
    v_lshl_add_u32 v9, v20, 3, v9
    v_add_u32 v10, 49920, v9
    v_add_u32 v11, 99840, v9
    v_and_b32 v20, 15, v1
    v_lshlrev_b32 v14, 4, v20
    v_lshl_add_u32 v14, v3, 11, v14
    v_bfe_u32 v20, v1, 4, 1
    v_lshl_add_u32 v14, v20, 12, v14
    s_lshl_b32 s21, s24, 3
    v_add_u32 v14, s21, v14
    v_lshlrev_b32 v13, 4, v3
    v_add_u32 v13, 161792, v13
    s_add_u32 s80, s6, 0x1000000
    s_addc_u32 s81, s7, 0
    s_mov_b32 s82, 0x780000
    s_mov_b32 s83, 0x20000
    v_bfe_u32 v20, v1, 1, 3
    v_xor_b32 v20, v20, v3
    v_lshlrev_b32 v21, 7, v2
    v_add_u32 v21, s33, v21
    v_xor_b32 v22, 0, v20
    v_lshl_add_u32 v248, v22, 4, v21
    v_xor_b32 v22, 2, v20
    v_lshl_add_u32 v249, v22, 4, v21
    v_xor_b32 v22, 4, v20
    v_lshl_add_u32 v250, v22, 4, v21
    v_xor_b32 v22, 6, v20
    v_lshl_add_u32 v251, v22, 4, v21
    s_lshl_b32 s21, s26, 8
    s_add_u32 s21, s21, 160768
    v_lshlrev_b32 v12, 3, v2
    v_add_u32 v12, s21, v12
    s_barrier
    s_waitcnt vmcnt(8)
    ds_read_b128 v[144:147], v248 offset:0
    ds_read_b128 v[148:151], v249 offset:0
    ds_read_b128 v[152:155], v250 offset:0
    ds_read_b128 v[156:159], v251 offset:0
    ds_read_b64_tr_b16 v[32:33], v9 offset:0
    ds_read_b64_tr_b16 v[34:35], v9 offset:1024
    ds_read_b64_tr_b16 v[36:37], v9 offset:64
    ds_read_b64_tr_b16 v[38:39], v9 offset:1088
    ds_read_b64_tr_b16 v[40:41], v9 offset:128
    ds_read_b64_tr_b16 v[42:43], v9 offset:1152
    ds_read_b64_tr_b16 v[44:45], v9 offset:192
    ds_read_b64_tr_b16 v[46:47], v9 offset:1216
    s_waitcnt lgkmcnt(6)
    v_mfma_f32_32x32x16_bf16 v[64:79], v[32:35], v[144:147], 0
    ds_read_b64_tr_b16 v[48:49], v9 offset:512
    ds_read_b64_tr_b16 v[50:51], v9 offset:1536
    s_waitcnt lgkmcnt(6)
    v_mfma_f32_32x32x16_bf16 v[80:95], v[36:39], v[144:147], 0
    ds_read_b64_tr_b16 v[52:53], v9 offset:576
    ds_read_b64_tr_b16 v[54:55], v9 offset:1600
    s_waitcnt lgkmcnt(6)
    v_mfma_f32_32x32x16_bf16 v[96:111], v[40:43], v[144:147], 0
    ds_read_b64_tr_b16 v[56:57], v9 offset:640
    ds_read_b64_tr_b16 v[58:59], v9 offset:1664
    s_waitcnt lgkmcnt(6)
    v_mfma_f32_32x32x16_bf16 v[112:127], v[44:47], v[144:147], 0
    ds_read_b64_tr_b16 v[60:61], v9 offset:704
    ds_read_b64_tr_b16 v[62:63], v9 offset:1728
    s_add_u32 m0, s33, 12288
    s_nop 0
    buffer_load_dwordx4 v4, s[8:11], s30 offen lds
    s_waitcnt lgkmcnt(6)
    v_mfma_f32_32x32x16_bf16 v[64:79], v[48:51], v[148:151], v[64:79]
    ds_read_b64_tr_b16 v[32:33], v9 offset:2048
    ds_read_b64_tr_b16 v[34:35], v9 offset:3072
    s_waitcnt lgkmcnt(6)
    v_mfma_f32_32x32x16_bf16 v[80:95], v[52:55], v[148:151], v[80:95]
    ds_read_b64_tr_b16 v[36:37], v9 offset:2112
    ds_read_b64_tr_b16 v[38:39], v9 offset:3136
    s_waitcnt lgkmcnt(6)
    v_mfma_f32_32x32x16_bf16 v[96:111], v[56:59], v[148:151], v[96:111]
    ds_read_b64_tr_b16 v[40:41], v9 offset:2176
    ds_read_b64_tr_b16 v[42:43], v9 offset:3200
    s_waitcnt lgkmcnt(6)
    v_mfma_f32_32x32x16_bf16 v[112:127], v[60:63], v[148:151], v[112:127]
    ds_read_b64_tr_b16 v[44:45], v9 offset:2240
    ds_read_b64_tr_b16 v[46:47], v9 offset:3264
    s_add_u32 m0, s33, 13312
    s_nop 0
    buffer_load_dwordx4 v5, s[8:11], s30 offen lds
    s_waitcnt vmcnt(6)
    ds_read_b128 v[160:163], v248 offset:4096
    ds_read_b128 v[164:167], v249 offset:4096
    s_waitcnt lgkmcnt(8)
    v_mfma_f32_32x32x16_bf16 v[64:79], v[32:35], v[152:155], v[64:79]
    ds_read_b64_tr_b16 v[48:49], v9 offset:2560
    ds_read_b64_tr_b16 v[50:51], v9 offset:3584
    s_waitcnt lgkmcnt(8)
    v_mfma_f32_32x32x16_bf16 v[80:95], v[36:39], v[152:155], v[80:95]
    ds_read_b64_tr_b16 v[52:53], v9 offset:2624
    ds_read_b64_tr_b16 v[54:55], v9 offset:3648
    s_waitcnt lgkmcnt(8)
    v_mfma_f32_32x32x16_bf16 v[96:111], v[40:43], v[152:155], v[96:111]
    ds_read_b64_tr_b16 v[56:57], v9 offset:2688
    ds_read_b64_tr_b16 v[58:59], v9 offset:3712
    s_waitcnt lgkmcnt(8)
    v_mfma_f32_32x32x16_bf16 v[112:127], v[44:47], v[152:155], v[112:127]
    ds_read_b64_tr_b16 v[60:61], v9 offset:2752
    ds_read_b64_tr_b16 v[62:63], v9 offset:3776
    s_add_u32 m0, s33, 14336
    s_nop 0
    buffer_load_dwordx4 v6, s[8:11], s30 offen lds
    s_barrier
    ds_read_b128 v[168:171], v250 offset:4096
    ds_read_b128 v[172:175], v251 offset:4096
    s_waitcnt lgkmcnt(8)
    v_mfma_f32_32x32x16_bf16 v[64:79], v[48:51], v[156:159], v[64:79]
    ds_read_b64_tr_b16 v[32:33], v9 offset:16640
    ds_read_b64_tr_b16 v[34:35], v9 offset:17664
    s_waitcnt lgkmcnt(8)
    v_mfma_f32_32x32x16_bf16 v[80:95], v[52:55], v[156:159], v[80:95]
    ds_read_b64_tr_b16 v[36:37], v9 offset:16704
    ds_read_b64_tr_b16 v[38:39], v9 offset:17728
    s_waitcnt lgkmcnt(8)
    v_mfma_f32_32x32x16_bf16 v[96:111], v[56:59], v[156:159], v[96:111]
    ds_read_b64_tr_b16 v[40:41], v9 offset:16768
    ds_read_b64_tr_b16 v[42:43], v9 offset:17792
    s_waitcnt lgkmcnt(8)
    v_mfma_f32_32x32x16_bf16 v[112:127], v[60:63], v[156:159], v[112:127]
    ds_read_b64_tr_b16 v[44:45], v9 offset:16832
    ds_read_b64_tr_b16 v[46:47], v9 offset:17856
    s_add_u32 m0, s33, 15360
    s_nop 0
    buffer_load_dwordx4 v7, s[8:11], s30 offen lds
    s_add_u32 s30, s30, 128
    s_cmp_ge_u32 s30, 1280
    s_cselect_b32 s30, 0, s30
    s_waitcnt lgkmcnt(6)
    v_mfma_f32_32x32x16_bf16 v[64:79], v[32:35], v[160:163], v[64:79]
    ds_read_b64_tr_b16 v[48:49], v9 offset:17152
    ds_read_b64_tr_b16 v[50:51], v9 offset:18176
    s_waitcnt lgkmcnt(6)
    v_mfma_f32_32x32x16_bf16 v[80:95], v[36:39], v[160:163], v[80:95]
    ds_read_b64_tr_b16 v[52:53], v9 offset:17216
    ds_read_b64_tr_b16 v[54:55], v9 offset:18240
    s_waitcnt lgkmcnt(6)
    v_mfma_f32_32x32x16_bf16 v[96:111], v[40:43], v[160:163], v[96:111]
    ds_read_b64_tr_b16 v[56:57], v9 offset:17280
    ds_read_b64_tr_b16 v[58:59], v9 offset:18304
    s_waitcnt lgkmcnt(6)
    v_mfma_f32_32x32x16_bf16 v[112:127], v[44:47], v[160:163], v[112:127]
    ds_read_b64_tr_b16 v[60:61], v9 offset:17344
    ds_read_b64_tr_b16 v[62:63], v9 offset:18368
    s_add_u32 m0, s33, 0
    s_nop 0
    buffer_load_dwordx4 v4, s[8:11], s30 offen lds
    s_waitcnt lgkmcnt(6)
    v_mfma_f32_32x32x16_bf16 v[64:79], v[48:51], v[164:167], v[64:79]
    ds_read_b64_tr_b16 v[32:33], v9 offset:18688
    ds_read_b64_tr_b16 v[34:35], v9 offset:19712
    s_waitcnt lgkmcnt(6)
    v_mfma_f32_32x32x16_bf16 v[80:95], v[52:55], v[164:167], v[80:95]
    ds_read_b64_tr_b16 v[36:37], v9 offset:18752
    ds_read_b64_tr_b16 v[38:39], v9 offset:19776
    s_waitcnt lgkmcnt(6)
    v_mfma_f32_32x32x16_bf16 v[96:111], v[56:59], v[164:167], v[96:111]
    ds_read_b64_tr_b16 v[40:41], v9 offset:18816
    ds_read_b64_tr_b16 v[42:43], v9 offset:19840
    s_waitcnt lgkmcnt(6)
    v_mfma_f32_32x32x16_bf16 v[112:127], v[60:63], v[164:167], v[112:127]
    ds_read_b64_tr_b16 v[44:45], v9 offset:18880
    ds_read_b64_tr_b16 v[46:47], v9 offset:19904
    s_add_u32 m0, s33, 1024
    s_nop 0
    buffer_load_dwordx4 v5, s[8:11], s30 offen lds
    s_waitcnt vmcnt(6)
    ds_read_b128 v[144:147], v248 offset:8192
    ds_read_b128 v[148:151], v249 offset:8192
    s_waitcnt lgkmcnt(8)
    v_mfma_f32_32x32x16_bf16 v[64:79], v[32:35], v[168:171], v[64:79]
    ds_read_b64_tr_b16 v[48:49], v9 offset:19200
    ds_read_b64_tr_b16 v[50:51], v9 offset:20224
    s_waitcnt lgkmcnt(8)
    v_mfma_f32_32x32x16_bf16 v[80:95], v[36:39], v[168:171], v[80:95]
    ds_read_b64_tr_b16 v[52:53], v9 offset:19264
    ds_read_b64_tr_b16 v[54:55], v9 offset:20288
    s_waitcnt lgkmcnt(8)
    v_mfma_f32_32x32x16_bf16 v[96:111], v[40:43], v[168:171], v[96:111]
    ds_read_b64_tr_b16 v[56:57], v9 offset:19328
    ds_read_b64_tr_b16 v[58:59], v9 offset:20352
    s_waitcnt lgkmcnt(8)
    v_mfma_f32_32x32x16_bf16 v[112:127], v[44:47], v[168:171], v[112:127]
    ds_read_b64_tr_b16 v[60:61], v9 offset:19392
    ds_read_b64_tr_b16 v[62:63], v9 offset:20416
    s_add_u32 m0, s33, 2048
    s_nop 0
    buffer_load_dwordx4 v6, s[8:11], s30 offen lds
    s_barrier
    ds_read_b128 v[152:155], v250 offset:8192
    ds_read_b128 v[156:159], v251 offset:8192
    s_waitcnt lgkmcnt(8)
    v_mfma_f32_32x32x16_bf16 v[64:79], v[48:51], v[172:175], v[64:79]
    ds_read_b64_tr_b16 v[32:33], v9 offset:33280
    ds_read_b64_tr_b16 v[34:35], v9 offset:34304
    s_waitcnt lgkmcnt(8)
    v_mfma_f32_32x32x16_bf16 v[80:95], v[52:55], v[172:175], v[80:95]
    ds_read_b64_tr_b16 v[36:37], v9 offset:33344
    ds_read_b64_tr_b16 v[38:39], v9 offset:34368
    s_waitcnt lgkmcnt(8)
    v_mfma_f32_32x32x16_bf16 v[96:111], v[56:59], v[172:175], v[96:111]
    ds_read_b64_tr_b16 v[40:41], v9 offset:33408
    ds_read_b64_tr_b16 v[42:43], v9 offset:34432
    s_waitcnt lgkmcnt(8)
    v_mfma_f32_32x32x16_bf16 v[112:127], v[60:63], v[172:175], v[112:127]
    ds_read_b64_tr_b16 v[44:45], v9 offset:33472
    ds_read_b64_tr_b16 v[46:47], v9 offset:34496
    s_add_u32 m0, s33, 3072
    s_nop 0
    buffer_load_dwordx4 v7, s[8:11], s30 offen lds
    s_add_u32 s30, s30, 128
    s_cmp_ge_u32 s30, 1280
    s_cselect_b32 s30, 0, s30
    s_waitcnt lgkmcnt(6)
    v_mfma_f32_32x32x16_bf16 v[64:79], v[32:35], v[144:147], v[64:79]
    ds_read_b64_tr_b16 v[48:49], v9 offset:33792
    ds_read_b64_tr_b16 v[50:51], v9 offset:34816
    s_waitcnt lgkmcnt(6)
    v_mfma_f32_32x32x16_bf16 v[80:95], v[36:39], v[144:147], v[80:95]
    ds_read_b64_tr_b16 v[52:53], v9 offset:33856
    ds_read_b64_tr_b16 v[54:55], v9 offset:34880
    s_waitcnt lgkmcnt(6)
    v_mfma_f32_32x32x16_bf16 v[96:111], v[40:43], v[144:147], v[96:111]
    ds_read_b64_tr_b16 v[56:57], v9 offset:33920
    ds_read_b64_tr_b16 v[58:59], v9 offset:34944
    s_waitcnt lgkmcnt(6)
    v_mfma_f32_32x32x16_bf16 v[112:127], v[44:47], v[144:147], v[112:127]
    ds_read_b64_tr_b16 v[60:61], v9 offset:33984
    ds_read_b64_tr_b16 v[62:63], v9 offset:35008
    s_add_u32 m0, s33, 4096
    s_nop 0
    buffer_load_dwordx4 v4, s[8:11], s30 offen lds
    s_waitcnt lgkmcnt(6)
    v_mfma_f32_32x32x16_bf16 v[64:79], v[48:51], v[148:151], v[64:79]
    ds_read_b64_tr_b16 v[32:33], v9 offset:35328
    ds_read_b64_tr_b16 v[34:35], v9 offset:36352
    s_waitcnt lgkmcnt(6)
    v_mfma_f32_32x32x16_bf16 v[80:95], v[52:55], v[148:151], v[80:95]
    ds_read_b64_tr_b16 v[36:37], v9 offset:35392
    ds_read_b64_tr_b16 v[38:39], v9 offset:36416
    s_waitcnt lgkmcnt(6)
    v_mfma_f32_32x32x16_bf16 v[96:111], v[56:59], v[148:151], v[96:111]
    ds_read_b64_tr_b16 v[40:41], v9 offset:35456
    ds_read_b64_tr_b16 v[42:43], v9 offset:36480
    s_waitcnt lgkmcnt(6)
    v_mfma_f32_32x32x16_bf16 v[112:127], v[60:63], v[148:151], v[112:127]
    ds_read_b64_tr_b16 v[44:45], v9 offset:35520
    ds_read_b64_tr_b16 v[46:47], v9 offset:36544
    s_add_u32 m0, s33, 5120
    s_nop 0
    buffer_load_dwordx4 v5, s[8:11], s30 offen lds
    s_waitcnt vmcnt(6)
    ds_read_b128 v[160:163], v248 offset:12288
    ds_read_b128 v[164:167], v249 offset:12288
    s_waitcnt lgkmcnt(8)
    v_mfma_f32_32x32x16_bf16 v[64:79], v[32:35], v[152:155], v[64:79]
    ds_read_b64_tr_b16 v[48:49], v9 offset:35840
    ds_read_b64_tr_b16 v[50:51], v9 offset:36864
    s_waitcnt lgkmcnt(8)
    v_mfma_f32_32x32x16_bf16 v[80:95], v[36:39], v[152:155], v[80:95]
    ds_read_b64_tr_b16 v[52:53], v9 offset:35904
    ds_read_b64_tr_b16 v[54:55], v9 offset:36928
    s_waitcnt lgkmcnt(8)
    v_mfma_f32_32x32x16_bf16 v[96:111], v[40:43], v[152:155], v[96:111]
    ds_read_b64_tr_b16 v[56:57], v9 offset:35968
    ds_read_b64_tr_b16 v[58:59], v9 offset:36992
    s_waitcnt lgkmcnt(8)
    v_mfma_f32_32x32x16_bf16 v[112:127], v[44:47], v[152:155], v[112:127]
    ds_read_b64_tr_b16 v[60:61], v9 offset:36032
    ds_read_b64_tr_b16 v[62:63], v9 offset:37056
    s_add_u32 m0, s33, 6144
    s_nop 0
    buffer_load_dwordx4 v6, s[8:11], s30 offen lds
    s_barrier
    ds_read_b128 v[168:171], v250 offset:12288
    ds_read_b128 v[172:175], v251 offset:12288
    s_waitcnt lgkmcnt(8)
    v_mfma_f32_32x32x16_bf16 v[64:79], v[48:51], v[156:159], v[64:79]
    ds_read_b64_tr_b16 v[32:33], v10 offset:0
    ds_read_b64_tr_b16 v[34:35], v10 offset:1024
    s_waitcnt lgkmcnt(8)
    v_mfma_f32_32x32x16_bf16 v[80:95], v[52:55], v[156:159], v[80:95]
    ds_read_b64_tr_b16 v[36:37], v10 offset:64
    ds_read_b64_tr_b16 v[38:39], v10 offset:1088
    s_waitcnt lgkmcnt(8)
    v_mfma_f32_32x32x16_bf16 v[96:111], v[56:59], v[156:159], v[96:111]
    ds_read_b64_tr_b16 v[40:41], v10 offset:128
    ds_read_b64_tr_b16 v[42:43], v10 offset:1152
    s_waitcnt lgkmcnt(8)
    v_mfma_f32_32x32x16_bf16 v[112:127], v[60:63], v[156:159], v[112:127]
    ds_read_b64_tr_b16 v[44:45], v10 offset:192
    ds_read_b64_tr_b16 v[46:47], v10 offset:1216
    s_add_u32 m0, s33, 7168
    s_nop 0
    buffer_load_dwordx4 v7, s[8:11], s30 offen lds
    s_add_u32 s30, s30, 128
    s_cmp_ge_u32 s30, 1280
    s_cselect_b32 s30, 0, s30
    s_waitcnt lgkmcnt(6)
    v_mfma_f32_32x32x16_bf16 v[64:79], v[32:35], v[160:163], v[64:79]
    ds_read_b64_tr_b16 v[48:49], v10 offset:512
    ds_read_b64_tr_b16 v[50:51], v10 offset:1536
    s_waitcnt lgkmcnt(6)
    v_mfma_f32_32x32x16_bf16 v[80:95], v[36:39], v[160:163], v[80:95]
    ds_read_b64_tr_b16 v[52:53], v10 offset:576
    ds_read_b64_tr_b16 v[54:55], v10 offset:1600
    s_waitcnt lgkmcnt(6)
    v_mfma_f32_32x32x16_bf16 v[96:111], v[40:43], v[160:163], v[96:111]
    ds_read_b64_tr_b16 v[56:57], v10 offset:640
    ds_read_b64_tr_b16 v[58:59], v10 offset:1664
    s_waitcnt lgkmcnt(6)
    v_mfma_f32_32x32x16_bf16 v[112:127], v[44:47], v[160:163], v[112:127]
    ds_read_b64_tr_b16 v[60:61], v10 offset:704
    ds_read_b64_tr_b16 v[62:63], v10 offset:1728
    s_add_u32 m0, s33, 8192
    s_nop 0
    buffer_load_dwordx4 v4, s[8:11], s30 offen lds
    s_waitcnt lgkmcnt(6)
    v_mfma_f32_32x32x16_bf16 v[64:79], v[48:51], v[164:167], v[64:79]
    ds_read_b64_tr_b16 v[32:33], v10 offset:2048
    ds_read_b64_tr_b16 v[34:35], v10 offset:3072
    s_waitcnt lgkmcnt(6)
    v_mfma_f32_32x32x16_bf16 v[80:95], v[52:55], v[164:167], v[80:95]
    ds_read_b64_tr_b16 v[36:37], v10 offset:2112
    ds_read_b64_tr_b16 v[38:39], v10 offset:3136
    s_waitcnt lgkmcnt(6)
    v_mfma_f32_32x32x16_bf16 v[96:111], v[56:59], v[164:167], v[96:111]
    ds_read_b64_tr_b16 v[40:41], v10 offset:2176
    ds_read_b64_tr_b16 v[42:43], v10 offset:3200
    s_waitcnt lgkmcnt(6)
    v_mfma_f32_32x32x16_bf16 v[112:127], v[60:63], v[164:167], v[112:127]
    ds_read_b64_tr_b16 v[44:45], v10 offset:2240
    ds_read_b64_tr_b16 v[46:47], v10 offset:3264
    s_add_u32 m0, s33, 9216
    s_nop 0
    buffer_load_dwordx4 v5, s[8:11], s30 offen lds
    s_waitcnt vmcnt(6)
    ds_read_b128 v[144:147], v248 offset:0
    ds_read_b128 v[148:151], v249 offset:0
    s_waitcnt lgkmcnt(8)
    v_mfma_f32_32x32x16_bf16 v[64:79], v[32:35], v[168:171], v[64:79]
    ds_read_b64_tr_b16 v[48:49], v10 offset:2560
    ds_read_b64_tr_b16 v[50:51], v10 offset:3584
    s_waitcnt lgkmcnt(8)
    v_mfma_f32_32x32x16_bf16 v[80:95], v[36:39], v[168:171], v[80:95]
    ds_read_b64_tr_b16 v[52:53], v10 offset:2624
    ds_read_b64_tr_b16 v[54:55], v10 offset:3648
    s_waitcnt lgkmcnt(8)
    v_mfma_f32_32x32x16_bf16 v[96:111], v[40:43], v[168:171], v[96:111]
    ds_read_b64_tr_b16 v[56:57], v10 offset:2688
    ds_read_b64_tr_b16 v[58:59], v10 offset:3712
    s_waitcnt lgkmcnt(8)
    v_mfma_f32_32x32x16_bf16 v[112:127], v[44:47], v[168:171], v[112:127]
    ds_read_b64_tr_b16 v[60:61], v10 offset:2752
    ds_read_b64_tr_b16 v[62:63], v10 offset:3776
    s_add_u32 m0, s33, 10240
    s_nop 0
    buffer_load_dwordx4 v6, s[8:11], s30 offen lds
    s_barrier
    ds_read_b128 v[152:155], v250 offset:0
    ds_read_b128 v[156:159], v251 offset:0
    s_waitcnt lgkmcnt(8)
    v_mfma_f32_32x32x16_bf16 v[64:79], v[48:51], v[172:175], v[64:79]
    ds_read_b64_tr_b16 v[32:33], v10 offset:16640
    ds_read_b64_tr_b16 v[34:35], v10 offset:17664
    s_waitcnt lgkmcnt(8)
    v_mfma_f32_32x32x16_bf16 v[80:95], v[52:55], v[172:175], v[80:95]
    ds_read_b64_tr_b16 v[36:37], v10 offset:16704
    ds_read_b64_tr_b16 v[38:39], v10 offset:17728
    s_waitcnt lgkmcnt(8)
    v_mfma_f32_32x32x16_bf16 v[96:111], v[56:59], v[172:175], v[96:111]
    ds_read_b64_tr_b16 v[40:41], v10 offset:16768
    ds_read_b64_tr_b16 v[42:43], v10 offset:17792
    s_waitcnt lgkmcnt(8)
    v_mfma_f32_32x32x16_bf16 v[112:127], v[60:63], v[172:175], v[112:127]
    ds_read_b64_tr_b16 v[44:45], v10 offset:16832
    ds_read_b64_tr_b16 v[46:47], v10 offset:17856
    s_add_u32 m0, s33, 11264
    s_nop 0
    buffer_load_dwordx4 v7, s[8:11], s30 offen lds
    s_add_u32 s30, s30, 128
    s_cmp_ge_u32 s30, 1280
    s_cselect_b32 s30, 0, s30
    s_waitcnt lgkmcnt(6)
    v_mfma_f32_32x32x16_bf16 v[64:79], v[32:35], v[144:147], v[64:79]
    ds_read_b64_tr_b16 v[48:49], v10 offset:17152
    ds_read_b64_tr_b16 v[50:51], v10 offset:18176
    s_waitcnt lgkmcnt(6)
    v_mfma_f32_32x32x16_bf16 v[80:95], v[36:39], v[144:147], v[80:95]
    ds_read_b64_tr_b16 v[52:53], v10 offset:17216
    ds_read_b64_tr_b16 v[54:55], v10 offset:18240
    s_waitcnt lgkmcnt(6)
    v_mfma_f32_32x32x16_bf16 v[96:111], v[40:43], v[144:147], v[96:111]
    ds_read_b64_tr_b16 v[56:57], v10 offset:17280
    ds_read_b64_tr_b16 v[58:59], v10 offset:18304
    s_waitcnt lgkmcnt(6)
    v_mfma_f32_32x32x16_bf16 v[112:127], v[44:47], v[144:147], v[112:127]
    ds_read_b64_tr_b16 v[60:61], v10 offset:17344
    ds_read_b64_tr_b16 v[62:63], v10 offset:18368
    s_add_u32 m0, s33, 12288
    s_nop 0
    buffer_load_dwordx4 v4, s[8:11], s30 offen lds
    s_waitcnt lgkmcnt(6)
    v_mfma_f32_32x32x16_bf16 v[64:79], v[48:51], v[148:151], v[64:79]
    ds_read_b64_tr_b16 v[32:33], v10 offset:18688
    ds_read_b64_tr_b16 v[34:35], v10 offset:19712
    s_waitcnt lgkmcnt(6)
    v_mfma_f32_32x32x16_bf16 v[80:95], v[52:55], v[148:151], v[80:95]
    ds_read_b64_tr_b16 v[36:37], v10 offset:18752
    ds_read_b64_tr_b16 v[38:39], v10 offset:19776
    s_waitcnt lgkmcnt(6)
    v_mfma_f32_32x32x16_bf16 v[96:111], v[56:59], v[148:151], v[96:111]
    ds_read_b64_tr_b16 v[40:41], v10 offset:18816
    ds_read_b64_tr_b16 v[42:43], v10 offset:19840
    s_waitcnt lgkmcnt(6)
    v_mfma_f32_32x32x16_bf16 v[112:127], v[60:63], v[148:151], v[112:127]
    ds_read_b64_tr_b16 v[44:45], v10 offset:18880
    ds_read_b64_tr_b16 v[46:47], v10 offset:19904
    s_add_u32 m0, s33, 13312
    s_nop 0
    buffer_load_dwordx4 v5, s[8:11], s30 offen lds
    s_waitcnt vmcnt(6)
    ds_read_b128 v[160:163], v248 offset:4096
    ds_read_b128 v[164:167], v249 offset:4096
    s_waitcnt lgkmcnt(8)
    v_mfma_f32_32x32x16_bf16 v[64:79], v[32:35], v[152:155], v[64:79]
    ds_read_b64_tr_b16 v[48:49], v10 offset:19200
    ds_read_b64_tr_b16 v[50:51], v10 offset:20224
    s_waitcnt lgkmcnt(8)
    v_mfma_f32_32x32x16_bf16 v[80:95], v[36:39], v[152:155], v[80:95]
    ds_read_b64_tr_b16 v[52:53], v10 offset:19264
    ds_read_b64_tr_b16 v[54:55], v10 offset:20288
    s_waitcnt lgkmcnt(8)
    v_mfma_f32_32x32x16_bf16 v[96:111], v[40:43], v[152:155], v[96:111]
    ds_read_b64_tr_b16 v[56:57], v10 offset:19328
    ds_read_b64_tr_b16 v[58:59], v10 offset:20352
    s_waitcnt lgkmcnt(8)
    v_mfma_f32_32x32x16_bf16 v[112:127], v[44:47], v[152:155], v[112:127]
    ds_read_b64_tr_b16 v[60:61], v10 offset:19392
    ds_read_b64_tr_b16 v[62:63], v10 offset:20416
    s_add_u32 m0, s33, 14336
    s_nop 0
    buffer_load_dwordx4 v6, s[8:11], s30 offen lds
    s_barrier
    ds_read_b128 v[168:171], v250 offset:4096
    ds_read_b128 v[172:175], v251 offset:4096
    s_waitcnt lgkmcnt(8)
    v_mfma_f32_32x32x16_bf16 v[64:79], v[48:51], v[156:159], v[64:79]
    ds_read_b64_tr_b16 v[32:33], v9 offset:0
    ds_read_b64_tr_b16 v[34:35], v9 offset:1024
    s_waitcnt lgkmcnt(8)
    v_mfma_f32_32x32x16_bf16 v[80:95], v[52:55], v[156:159], v[80:95]
    ds_read_b64_tr_b16 v[36:37], v9 offset:64
    ds_read_b64_tr_b16 v[38:39], v9 offset:1088
    s_waitcnt lgkmcnt(8)
    v_mfma_f32_32x32x16_bf16 v[96:111], v[56:59], v[156:159], v[96:111]
    ds_read_b64_tr_b16 v[40:41], v9 offset:128
    ds_read_b64_tr_b16 v[42:43], v9 offset:1152
    s_waitcnt lgkmcnt(8)
    v_mfma_f32_32x32x16_bf16 v[112:127], v[60:63], v[156:159], v[112:127]
    ds_read_b64_tr_b16 v[44:45], v9 offset:192
    ds_read_b64_tr_b16 v[46:47], v9 offset:1216
    s_add_u32 m0, s33, 15360
    s_nop 0
    buffer_load_dwordx4 v7, s[8:11], s30 offen lds
    s_add_u32 s30, s30, 128
    s_cmp_ge_u32 s30, 1280
    s_cselect_b32 s30, 0, s30
    s_waitcnt lgkmcnt(6)
    v_mfma_f32_32x32x16_bf16 v[64:79], v[32:35], v[160:163], v[64:79]
    ds_read_b64_tr_b16 v[48:49], v9 offset:512
    ds_read_b64_tr_b16 v[50:51], v9 offset:1536
    s_waitcnt lgkmcnt(6)
    v_mfma_f32_32x32x16_bf16 v[80:95], v[36:39], v[160:163], v[80:95]
    ds_read_b64_tr_b16 v[52:53], v9 offset:576
    ds_read_b64_tr_b16 v[54:55], v9 offset:1600
    s_waitcnt lgkmcnt(6)
    v_mfma_f32_32x32x16_bf16 v[96:111], v[40:43], v[160:163], v[96:111]
    ds_read_b64_tr_b16 v[56:57], v9 offset:640
    ds_read_b64_tr_b16 v[58:59], v9 offset:1664
    s_waitcnt lgkmcnt(6)
    v_mfma_f32_32x32x16_bf16 v[112:127], v[44:47], v[160:163], v[112:127]
    ds_read_b64_tr_b16 v[60:61], v9 offset:704
    ds_read_b64_tr_b16 v[62:63], v9 offset:1728
    s_add_u32 m0, s33, 0
    s_nop 0
    buffer_load_dwordx4 v4, s[8:11], s30 offen lds
    s_waitcnt lgkmcnt(6)
    v_mfma_f32_32x32x16_bf16 v[64:79], v[48:51], v[164:167], v[64:79]
    ds_read_b64_tr_b16 v[32:33], v9 offset:2048
    ds_read_b64_tr_b16 v[34:35], v9 offset:3072
    s_waitcnt lgkmcnt(6)
    v_mfma_f32_32x32x16_bf16 v[80:95], v[52:55], v[164:167], v[80:95]
    ds_read_b64_tr_b16 v[36:37], v9 offset:2112
    ds_read_b64_tr_b16 v[38:39], v9 offset:3136
    s_waitcnt lgkmcnt(6)
    v_mfma_f32_32x32x16_bf16 v[96:111], v[56:59], v[164:167], v[96:111]
    ds_read_b64_tr_b16 v[40:41], v9 offset:2176
    ds_read_b64_tr_b16 v[42:43], v9 offset:3200
    s_waitcnt lgkmcnt(6)
    v_mfma_f32_32x32x16_bf16 v[112:127], v[60:63], v[164:167], v[112:127]
    ds_read_b64_tr_b16 v[44:45], v9 offset:2240
    ds_read_b64_tr_b16 v[46:47], v9 offset:3264
    s_add_u32 m0, s33, 1024
    s_nop 0
    buffer_load_dwordx4 v5, s[8:11], s30 offen lds
    s_waitcnt vmcnt(6)
    ds_read_b128 v[144:147], v248 offset:8192
    ds_read_b128 v[148:151], v249 offset:8192
    s_waitcnt lgkmcnt(8)
    v_mfma_f32_32x32x16_bf16 v[64:79], v[32:35], v[168:171], v[64:79]
    ds_read_b64_tr_b16 v[48:49], v9 offset:2560
    ds_read_b64_tr_b16 v[50:51], v9 offset:3584
    s_waitcnt lgkmcnt(8)
    v_mfma_f32_32x32x16_bf16 v[80:95], v[36:39], v[168:171], v[80:95]
    ds_read_b64_tr_b16 v[52:53], v9 offset:2624
    ds_read_b64_tr_b16 v[54:55], v9 offset:3648
    s_waitcnt lgkmcnt(8)
    v_mfma_f32_32x32x16_bf16 v[96:111], v[40:43], v[168:171], v[96:111]
    ds_read_b64_tr_b16 v[56:57], v9 offset:2688
    ds_read_b64_tr_b16 v[58:59], v9 offset:3712
    s_waitcnt lgkmcnt(8)
    v_mfma_f32_32x32x16_bf16 v[112:127], v[44:47], v[168:171], v[112:127]
    ds_read_b64_tr_b16 v[60:61], v9 offset:2752
    ds_read_b64_tr_b16 v[62:63], v9 offset:3776
    s_add_u32 m0, s33, 2048
    s_nop 0
    buffer_load_dwordx4 v6, s[8:11], s30 offen lds
    s_barrier
    ds_read_b128 v[152:155], v250 offset:8192
    ds_read_b128 v[156:159], v251 offset:8192
    s_waitcnt lgkmcnt(8)
    v_mfma_f32_32x32x16_bf16 v[64:79], v[48:51], v[172:175], v[64:79]
    ds_read_b64_tr_b16 v[32:33], v9 offset:16640
    ds_read_b64_tr_b16 v[34:35], v9 offset:17664
    s_waitcnt lgkmcnt(8)
    v_mfma_f32_32x32x16_bf16 v[80:95], v[52:55], v[172:175], v[80:95]
    ds_read_b64_tr_b16 v[36:37], v9 offset:16704
    ds_read_b64_tr_b16 v[38:39], v9 offset:17728
    s_waitcnt lgkmcnt(8)
    v_mfma_f32_32x32x16_bf16 v[96:111], v[56:59], v[172:175], v[96:111]
    ds_read_b64_tr_b16 v[40:41], v9 offset:16768
    ds_read_b64_tr_b16 v[42:43], v9 offset:17792
    s_waitcnt lgkmcnt(8)
    v_mfma_f32_32x32x16_bf16 v[112:127], v[60:63], v[172:175], v[112:127]
    ds_read_b64_tr_b16 v[44:45], v9 offset:16832
    ds_read_b64_tr_b16 v[46:47], v9 offset:17856
    s_add_u32 m0, s33, 3072
    s_nop 0
    buffer_load_dwordx4 v7, s[8:11], s30 offen lds
    s_add_u32 s30, s30, 128
    s_cmp_ge_u32 s30, 1280
    s_cselect_b32 s30, 0, s30
    s_waitcnt lgkmcnt(6)
    v_mfma_f32_32x32x16_bf16 v[64:79], v[32:35], v[144:147], v[64:79]
    ds_read_b64_tr_b16 v[48:49], v9 offset:17152
    ds_read_b64_tr_b16 v[50:51], v9 offset:18176
    s_waitcnt lgkmcnt(6)
    v_mfma_f32_32x32x16_bf16 v[80:95], v[36:39], v[144:147], v[80:95]
    ds_read_b64_tr_b16 v[52:53], v9 offset:17216
    ds_read_b64_tr_b16 v[54:55], v9 offset:18240
    s_waitcnt lgkmcnt(6)
    v_mfma_f32_32x32x16_bf16 v[96:111], v[40:43], v[144:147], v[96:111]
    ds_read_b64_tr_b16 v[56:57], v9 offset:17280
    ds_read_b64_tr_b16 v[58:59], v9 offset:18304
    s_waitcnt lgkmcnt(6)
    v_mfma_f32_32x32x16_bf16 v[112:127], v[44:47], v[144:147], v[112:127]
    ds_read_b64_tr_b16 v[60:61], v9 offset:17344
    ds_read_b64_tr_b16 v[62:63], v9 offset:18368
    s_add_u32 m0, s33, 4096
    s_nop 0
    buffer_load_dwordx4 v4, s[8:11], s30 offen lds
    s_waitcnt lgkmcnt(6)
    v_mfma_f32_32x32x16_bf16 v[64:79], v[48:51], v[148:151], v[64:79]
    ds_read_b64_tr_b16 v[32:33], v9 offset:18688
    ds_read_b64_tr_b16 v[34:35], v9 offset:19712
    s_waitcnt lgkmcnt(6)
    v_mfma_f32_32x32x16_bf16 v[80:95], v[52:55], v[148:151], v[80:95]
    ds_read_b64_tr_b16 v[36:37], v9 offset:18752
    ds_read_b64_tr_b16 v[38:39], v9 offset:19776
    s_waitcnt lgkmcnt(6)
    v_mfma_f32_32x32x16_bf16 v[96:111], v[56:59], v[148:151], v[96:111]
    ds_read_b64_tr_b16 v[40:41], v9 offset:18816
    ds_read_b64_tr_b16 v[42:43], v9 offset:19840
    s_waitcnt lgkmcnt(6)
    v_mfma_f32_32x32x16_bf16 v[112:127], v[60:63], v[148:151], v[112:127]
    ds_read_b64_tr_b16 v[44:45], v9 offset:18880
    ds_read_b64_tr_b16 v[46:47], v9 offset:19904
    s_add_u32 m0, s33, 5120
    s_nop 0
    buffer_load_dwordx4 v5, s[8:11], s30 offen lds
    s_waitcnt vmcnt(6)
    ds_read_b128 v[160:163], v248 offset:12288
    ds_read_b128 v[164:167], v249 offset:12288
    s_waitcnt lgkmcnt(8)
    v_mfma_f32_32x32x16_bf16 v[64:79], v[32:35], v[152:155], v[64:79]
    ds_read_b64_tr_b16 v[48:49], v9 offset:19200
    ds_read_b64_tr_b16 v[50:51], v9 offset:20224
    s_waitcnt lgkmcnt(8)
    v_mfma_f32_32x32x16_bf16 v[80:95], v[36:39], v[152:155], v[80:95]
    ds_read_b64_tr_b16 v[52:53], v9 offset:19264
    ds_read_b64_tr_b16 v[54:55], v9 offset:20288
    s_waitcnt lgkmcnt(8)
    v_mfma_f32_32x32x16_bf16 v[96:111], v[40:43], v[152:155], v[96:111]
    ds_read_b64_tr_b16 v[56:57], v9 offset:19328
    ds_read_b64_tr_b16 v[58:59], v9 offset:20352
    s_waitcnt lgkmcnt(8)
    v_mfma_f32_32x32x16_bf16 v[112:127], v[44:47], v[152:155], v[112:127]
    ds_read_b64_tr_b16 v[60:61], v9 offset:19392
    ds_read_b64_tr_b16 v[62:63], v9 offset:20416
    s_add_u32 m0, s33, 6144
    s_nop 0
    buffer_load_dwordx4 v6, s[8:11], s30 offen lds
    s_barrier
    ds_read_b128 v[168:171], v250 offset:12288
    ds_read_b128 v[172:175], v251 offset:12288
    s_waitcnt lgkmcnt(8)
    v_mfma_f32_32x32x16_bf16 v[64:79], v[48:51], v[156:159], v[64:79]
    ds_read_b64_tr_b16 v[32:33], v9 offset:33280
    ds_read_b64_tr_b16 v[34:35], v9 offset:34304
    s_waitcnt lgkmcnt(8)
    v_mfma_f32_32x32x16_bf16 v[80:95], v[52:55], v[156:159], v[80:95]
    ds_read_b64_tr_b16 v[36:37], v9 offset:33344
    ds_read_b64_tr_b16 v[38:39], v9 offset:34368
    s_waitcnt lgkmcnt(8)
    v_mfma_f32_32x32x16_bf16 v[96:111], v[56:59], v[156:159], v[96:111]
    ds_read_b64_tr_b16 v[40:41], v9 offset:33408
    ds_read_b64_tr_b16 v[42:43], v9 offset:34432
    s_waitcnt lgkmcnt(8)
    v_mfma_f32_32x32x16_bf16 v[112:127], v[60:63], v[156:159], v[112:127]
    ds_read_b64_tr_b16 v[44:45], v9 offset:33472
    ds_read_b64_tr_b16 v[46:47], v9 offset:34496
    s_add_u32 m0, s33, 7168
    s_nop 0
    buffer_load_dwordx4 v7, s[8:11], s30 offen lds
    s_waitcnt lgkmcnt(6)
    v_mfma_f32_32x32x16_bf16 v[64:79], v[32:35], v[160:163], v[64:79]
    ds_read_b64_tr_b16 v[48:49], v9 offset:33792
    ds_read_b64_tr_b16 v[50:51], v9 offset:34816
    s_waitcnt lgkmcnt(6)
    v_mfma_f32_32x32x16_bf16 v[80:95], v[36:39], v[160:163], v[80:95]
    ds_read_b64_tr_b16 v[52:53], v9 offset:33856
    ds_read_b64_tr_b16 v[54:55], v9 offset:34880
    s_waitcnt lgkmcnt(6)
    v_mfma_f32_32x32x16_bf16 v[96:111], v[40:43], v[160:163], v[96:111]
    ds_read_b64_tr_b16 v[56:57], v9 offset:33920
    ds_read_b64_tr_b16 v[58:59], v9 offset:34944
    s_waitcnt lgkmcnt(6)
    v_mfma_f32_32x32x16_bf16 v[112:127], v[44:47], v[160:163], v[112:127]
    ds_read_b64_tr_b16 v[60:61], v9 offset:33984
    ds_read_b64_tr_b16 v[62:63], v9 offset:35008
    s_waitcnt lgkmcnt(6)
    v_mfma_f32_32x32x16_bf16 v[64:79], v[48:51], v[164:167], v[64:79]
    ds_read_b64_tr_b16 v[32:33], v9 offset:35328
    ds_read_b64_tr_b16 v[34:35], v9 offset:36352
    s_waitcnt lgkmcnt(6)
    v_mfma_f32_32x32x16_bf16 v[80:95], v[52:55], v[164:167], v[80:95]
    ds_read_b64_tr_b16 v[36:37], v9 offset:35392
    ds_read_b64_tr_b16 v[38:39], v9 offset:36416
    s_waitcnt lgkmcnt(6)
    v_mfma_f32_32x32x16_bf16 v[96:111], v[56:59], v[164:167], v[96:111]
    ds_read_b64_tr_b16 v[40:41], v9 offset:35456
    ds_read_b64_tr_b16 v[42:43], v9 offset:36480
    s_waitcnt lgkmcnt(6)
    v_mfma_f32_32x32x16_bf16 v[112:127], v[60:63], v[164:167], v[112:127]
    ds_read_b64_tr_b16 v[44:45], v9 offset:35520
    ds_read_b64_tr_b16 v[46:47], v9 offset:36544
    s_waitcnt vmcnt(4)
    ds_read_b128 v[144:147], v248 offset:0
    ds_read_b128 v[148:151], v249 offset:0
    s_waitcnt lgkmcnt(8)
    v_mfma_f32_32x32x16_bf16 v[64:79], v[32:35], v[168:171], v[64:79]
    ds_read_b64_tr_b16 v[48:49], v9 offset:35840
    ds_read_b64_tr_b16 v[50:51], v9 offset:36864
    s_waitcnt lgkmcnt(8)
    v_mfma_f32_32x32x16_bf16 v[80:95], v[36:39], v[168:171], v[80:95]
    ds_read_b64_tr_b16 v[52:53], v9 offset:35904
    ds_read_b64_tr_b16 v[54:55], v9 offset:36928
    s_waitcnt lgkmcnt(8)
    v_mfma_f32_32x32x16_bf16 v[96:111], v[40:43], v[168:171], v[96:111]
    ds_read_b64_tr_b16 v[56:57], v9 offset:35968
    ds_read_b64_tr_b16 v[58:59], v9 offset:36992
    s_waitcnt lgkmcnt(8)
    v_mfma_f32_32x32x16_bf16 v[112:127], v[44:47], v[168:171], v[112:127]
    ds_read_b64_tr_b16 v[60:61], v9 offset:36032
    ds_read_b64_tr_b16 v[62:63], v9 offset:37056
    s_barrier
    ds_read_b128 v[152:155], v250 offset:0
    ds_read_b128 v[156:159], v251 offset:0
    s_waitcnt lgkmcnt(8)
    v_mfma_f32_32x32x16_bf16 v[64:79], v[48:51], v[172:175], v[64:79]
    ds_read_b64_tr_b16 v[32:33], v10 offset:0
    ds_read_b64_tr_b16 v[34:35], v10 offset:1024
    s_waitcnt lgkmcnt(8)
    v_mfma_f32_32x32x16_bf16 v[80:95], v[52:55], v[172:175], v[80:95]
    ds_read_b64_tr_b16 v[36:37], v10 offset:64
    ds_read_b64_tr_b16 v[38:39], v10 offset:1088
    s_waitcnt lgkmcnt(8)
    v_mfma_f32_32x32x16_bf16 v[96:111], v[56:59], v[172:175], v[96:111]
    ds_read_b64_tr_b16 v[40:41], v10 offset:128
    ds_read_b64_tr_b16 v[42:43], v10 offset:1152
    s_waitcnt lgkmcnt(8)
    v_mfma_f32_32x32x16_bf16 v[112:127], v[60:63], v[172:175], v[112:127]
    ds_read_b64_tr_b16 v[44:45], v10 offset:192
    ds_read_b64_tr_b16 v[46:47], v10 offset:1216
    s_waitcnt lgkmcnt(6)
    v_mfma_f32_32x32x16_bf16 v[64:79], v[32:35], v[144:147], v[64:79]
    ds_read_b64_tr_b16 v[48:49], v10 offset:512
    ds_read_b64_tr_b16 v[50:51], v10 offset:1536
    s_waitcnt lgkmcnt(6)
    v_mfma_f32_32x32x16_bf16 v[80:95], v[36:39], v[144:147], v[80:95]
    ds_read_b64_tr_b16 v[52:53], v10 offset:576
    ds_read_b64_tr_b16 v[54:55], v10 offset:1600
    s_waitcnt lgkmcnt(6)
    v_mfma_f32_32x32x16_bf16 v[96:111], v[40:43], v[144:147], v[96:111]
    ds_read_b64_tr_b16 v[56:57], v10 offset:640
    ds_read_b64_tr_b16 v[58:59], v10 offset:1664
    s_waitcnt lgkmcnt(6)
    v_mfma_f32_32x32x16_bf16 v[112:127], v[44:47], v[144:147], v[112:127]
    ds_read_b64_tr_b16 v[60:61], v10 offset:704
    ds_read_b64_tr_b16 v[62:63], v10 offset:1728
    s_waitcnt lgkmcnt(6)
    v_mfma_f32_32x32x16_bf16 v[64:79], v[48:51], v[148:151], v[64:79]
    ds_read_b64_tr_b16 v[32:33], v10 offset:2048
    ds_read_b64_tr_b16 v[34:35], v10 offset:3072
    s_waitcnt lgkmcnt(6)
    v_mfma_f32_32x32x16_bf16 v[80:95], v[52:55], v[148:151], v[80:95]
    ds_read_b64_tr_b16 v[36:37], v10 offset:2112
    ds_read_b64_tr_b16 v[38:39], v10 offset:3136
    s_waitcnt lgkmcnt(6)
    v_mfma_f32_32x32x16_bf16 v[96:111], v[56:59], v[148:151], v[96:111]
    ds_read_b64_tr_b16 v[40:41], v10 offset:2176
    ds_read_b64_tr_b16 v[42:43], v10 offset:3200
    s_waitcnt lgkmcnt(6)
    v_mfma_f32_32x32x16_bf16 v[112:127], v[60:63], v[148:151], v[112:127]
    ds_read_b64_tr_b16 v[44:45], v10 offset:2240
    ds_read_b64_tr_b16 v[46:47], v10 offset:3264
    s_waitcnt vmcnt(0)
    ds_read_b128 v[160:163], v248 offset:4096
    ds_read_b128 v[164:167], v249 offset:4096
    s_waitcnt lgkmcnt(8)
    v_mfma_f32_32x32x16_bf16 v[64:79], v[32:35], v[152:155], v[64:79]
    ds_read_b64_tr_b16 v[48:49], v10 offset:2560
    ds_read_b64_tr_b16 v[50:51], v10 offset:3584
    s_waitcnt lgkmcnt(8)
    v_mfma_f32_32x32x16_bf16 v[80:95], v[36:39], v[152:155], v[80:95]
    ds_read_b64_tr_b16 v[52:53], v10 offset:2624
    ds_read_b64_tr_b16 v[54:55], v10 offset:3648
    s_waitcnt lgkmcnt(8)
    v_mfma_f32_32x32x16_bf16 v[96:111], v[40:43], v[152:155], v[96:111]
    ds_read_b64_tr_b16 v[56:57], v10 offset:2688
    ds_read_b64_tr_b16 v[58:59], v10 offset:3712
    s_waitcnt lgkmcnt(8)
    v_mfma_f32_32x32x16_bf16 v[112:127], v[44:47], v[152:155], v[112:127]
    ds_read_b64_tr_b16 v[60:61], v10 offset:2752
    ds_read_b64_tr_b16 v[62:63], v10 offset:3776
    s_barrier
    ds_read_b128 v[168:171], v250 offset:4096
    ds_read_b128 v[172:175], v251 offset:4096
    s_waitcnt lgkmcnt(8)
    v_mfma_f32_32x32x16_bf16 v[64:79], v[48:51], v[156:159], v[64:79]
    ds_read_b64_tr_b16 v[32:33], v10 offset:16640
    ds_read_b64_tr_b16 v[34:35], v10 offset:17664
    s_waitcnt lgkmcnt(8)
    v_mfma_f32_32x32x16_bf16 v[80:95], v[52:55], v[156:159], v[80:95]
    ds_read_b64_tr_b16 v[36:37], v10 offset:16704
    ds_read_b64_tr_b16 v[38:39], v10 offset:17728
    s_waitcnt lgkmcnt(8)
    v_mfma_f32_32x32x16_bf16 v[96:111], v[56:59], v[156:159], v[96:111]
    ds_read_b64_tr_b16 v[40:41], v10 offset:16768
    ds_read_b64_tr_b16 v[42:43], v10 offset:17792
    s_waitcnt lgkmcnt(8)
    v_mfma_f32_32x32x16_bf16 v[112:127], v[60:63], v[156:159], v[112:127]
    ds_read_b64_tr_b16 v[44:45], v10 offset:16832
    ds_read_b64_tr_b16 v[46:47], v10 offset:17856
    s_waitcnt lgkmcnt(6)
    v_mfma_f32_32x32x16_bf16 v[64:79], v[32:35], v[160:163], v[64:79]
    ds_read_b64_tr_b16 v[48:49], v10 offset:17152
    ds_read_b64_tr_b16 v[50:51], v10 offset:18176
    s_waitcnt lgkmcnt(6)
    v_mfma_f32_32x32x16_bf16 v[80:95], v[36:39], v[160:163], v[80:95]
    ds_read_b64_tr_b16 v[52:53], v10 offset:17216
    ds_read_b64_tr_b16 v[54:55], v10 offset:18240
    s_waitcnt lgkmcnt(6)
    v_mfma_f32_32x32x16_bf16 v[96:111], v[40:43], v[160:163], v[96:111]
    ds_read_b64_tr_b16 v[56:57], v10 offset:17280
    ds_read_b64_tr_b16 v[58:59], v10 offset:18304
    s_waitcnt lgkmcnt(6)
    v_mfma_f32_32x32x16_bf16 v[112:127], v[44:47], v[160:163], v[112:127]
    ds_read_b64_tr_b16 v[60:61], v10 offset:17344
    ds_read_b64_tr_b16 v[62:63], v10 offset:18368
    s_waitcnt lgkmcnt(6)
    v_mfma_f32_32x32x16_bf16 v[64:79], v[48:51], v[164:167], v[64:79]
    ds_read_b64_tr_b16 v[32:33], v10 offset:18688
    ds_read_b64_tr_b16 v[34:35], v10 offset:19712
    s_waitcnt lgkmcnt(6)
    v_mfma_f32_32x32x16_bf16 v[80:95], v[52:55], v[164:167], v[80:95]
    ds_read_b64_tr_b16 v[36:37], v10 offset:18752
    ds_read_b64_tr_b16 v[38:39], v10 offset:19776
    s_waitcnt lgkmcnt(6)
    v_mfma_f32_32x32x16_bf16 v[96:111], v[56:59], v[164:167], v[96:111]
    ds_read_b64_tr_b16 v[40:41], v10 offset:18816
    ds_read_b64_tr_b16 v[42:43], v10 offset:19840
    s_waitcnt lgkmcnt(6)
    v_mfma_f32_32x32x16_bf16 v[112:127], v[60:63], v[164:167], v[112:127]
    ds_read_b64_tr_b16 v[44:45], v10 offset:18880
    ds_read_b64_tr_b16 v[46:47], v10 offset:19904
    s_waitcnt lgkmcnt(6)
    v_mfma_f32_32x32x16_bf16 v[64:79], v[32:35], v[168:171], v[64:79]
    ds_read_b64_tr_b16 v[48:49], v10 offset:19200
    ds_read_b64_tr_b16 v[50:51], v10 offset:20224
    s_waitcnt lgkmcnt(6)
    v_mfma_f32_32x32x16_bf16 v[80:95], v[36:39], v[168:171], v[80:95]
    ds_read_b64_tr_b16 v[52:53], v10 offset:19264
    ds_read_b64_tr_b16 v[54:55], v10 offset:20288
    s_waitcnt lgkmcnt(6)
    v_mfma_f32_32x32x16_bf16 v[96:111], v[40:43], v[168:171], v[96:111]
    ds_read_b64_tr_b16 v[56:57], v10 offset:19328
    ds_read_b64_tr_b16 v[58:59], v10 offset:20352
    s_waitcnt lgkmcnt(6)
    v_mfma_f32_32x32x16_bf16 v[112:127], v[44:47], v[168:171], v[112:127]
    ds_read_b64_tr_b16 v[60:61], v10 offset:19392
    ds_read_b64_tr_b16 v[62:63], v10 offset:20416
    s_waitcnt lgkmcnt(6)
    v_mfma_f32_32x32x16_bf16 v[64:79], v[48:51], v[172:175], v[64:79]
    s_waitcnt lgkmcnt(4)
    v_mfma_f32_32x32x16_bf16 v[80:95], v[52:55], v[172:175], v[80:95]
    s_waitcnt lgkmcnt(2)
    v_mfma_f32_32x32x16_bf16 v[96:111], v[56:59], v[172:175], v[96:111]
    s_waitcnt lgkmcnt(0)
    v_mfma_f32_32x32x16_bf16 v[112:127], v[60:63], v[172:175], v[112:127]
    s_branch L_p1_epi
L_layer:
    s_cmp_ge_u32 s19, 30
    s_cbranch_scc1 L_p1b_idle
    s_and_b32 s26, s20, 3
    s_and_b32 s24, s19, 1
    s_lshl_b32 s24, s24, 7
    s_lshl_b32 s25, s26, 5
    s_add_u32 s24, s24, s25
    s_lshl_b32 s27, s18, 8
    s_add_u32 s27, s27, s24
    s_lshr_b32 s28, s19, 1
    s_mul_i32 s21, s18, 10
    s_lshr_b32 s21, s21, 3
    s_lshl_b32 s30, s21, 11
    s_mul_i32 s31, s21, 245760
    s_cmp_lt_u32 s20, 4
    s_cbranch_scc1 L_p1b_comp
    s_add_u32 s12, s86, 0x0
    s_addc_u32 s13, s87, 0
    s_mov_b32 s14, 0x258000
    s_mov_b32 s15, 0x20000
    v_lshrrev_b32 v20, 4, v1
    v_lshlrev_b32 v20, 2, v20
    v_add_u32 v20, s26, v20
    v_mul_u32_u24 v20, 3840, v20
    v_and_b32 v21, 15, v1
    v_lshl_add_u32 v20, v21, 4, v20
    s_lshl_b32 s25, s28, 8
    v_add_u32 v4, s25, v20
    v_add_u32 v5, 61440, v4
    v_add_u32 v6, 122880, v4
    v_add_u32 v7, 122880, v5
    s_mul_i32 s32, s26, 4160
    v_add_u32 v20, s24, v2
    v_lshlrev_b32 v12, 3, v20
    v_mul_u32_u24 v20, 10240, v3
    v_add_u32 v12, v12, v20
    s_mul_i32 s21, s18, 20480
    v_add_u32 v12, s21, v12
    s_add_u32 s36, s6, 0x1800000
    s_addc_u32 s37, s7, 0
    s_mov_b32 s38, 0x28000
    s_mov_b32 s39, 0x20000
    s_add_u32 m0, s32, 0
    s_nop 0
    buffer_load_dwordx4 v4, s[12:15], s31 offen lds
    s_add_u32 m0, s32, 1024
    s_nop 0
    buffer_load_dwordx4 v5, s[12:15], s31 offen lds
    s_add_u32 m0, s32, 2048
    s_nop 0
    buffer_load_dwordx4 v6, s[12:15], s31 offen lds
    s_add_u32 m0, s32, 3072
    s_nop 0
    buffer_load_dwordx4 v7, s[12:15], s31 offen lds
    s_add_u32 s31, s31, 245760
    s_cmp_ge_u32 s31, 2457600
    s_cselect_b32 s31, 0, s31
    s_add_u32 m0, s32, 16640
    s_nop 0
    buffer_load_dwordx4 v4, s[12:15], s31 offen lds
    s_add_u32 m0, s32, 17664
    s_nop 0
    buffer_load_dwordx4 v5, s[12:15], s31 offen lds
    s_add_u32 m0, s32, 18688
    s_nop 0
    buffer_load_dwordx4 v6, s[12:15], s31 offen lds
    s_add_u32 m0, s32, 19712
    s_nop 0
    buffer_load_dwordx4 v7, s[12:15], s31 offen lds
    s_add_u32 s31, s31, 245760
    s_cmp_ge_u32 s31, 2457600
    s_cselect_b32 s31, 0, s31
    s_add_u32 m0, s32, 33280
    s_nop 0
    buffer_load_dwordx4 v4, s[12:15], s31 offen lds
    s_add_u32 m0, s32, 34304
    s_nop 0
    buffer_load_dwordx4 v5, s[12:15], s31 offen lds
    s_add_u32 m0, s32, 35328
    s_nop 0
    buffer_load_dwordx4 v6, s[12:15], s31 offen lds
    s_add_u32 m0, s32, 36352
    s_nop 0
    buffer_load_dwordx4 v7, s[12:15], s31 offen lds
    s_add_u32 s31, s31, 245760
    s_cmp_ge_u32 s31, 2457600
    s_cselect_b32 s31, 0, s31
    s_add_u32 m0, s32, 49920
    s_nop 0
    buffer_load_dwordx4 v4, s[12:15], s31 offen lds
    s_add_u32 m0, s32, 50944
    s_nop 0
    buffer_load_dwordx4 v5, s[12:15], s31 offen lds
    s_add_u32 m0, s32, 51968
    s_nop 0
    buffer_load_dwordx4 v6, s[12:15], s31 offen lds
    s_add_u32 m0, s32, 52992
    s_nop 0
    buffer_load_dwordx4 v7, s[12:15], s31 offen lds
    s_add_u32 s31, s31, 245760
    s_cmp_ge_u32 s31, 2457600
    s_cselect_b32 s31, 0, s31
    s_add_u32 m0, s32, 66560
    s_nop 0
    buffer_load_dwordx4 v4, s[12:15], s31 offen lds
    s_add_u32 m0, s32, 67584
    s_nop 0
    buffer_load_dwordx4 v5, s[12:15], s31 offen lds
    s_add_u32 m0, s32, 68608
    s_nop 0
    buffer_load_dwordx4 v6, s[12:15], s31 offen lds
    s_add_u32 m0, s32, 69632
    s_nop 0
    buffer_load_dwordx4 v7, s[12:15], s31 offen lds
    s_add_u32 s31, s31, 245760
    s_cmp_ge_u32 s31, 2457600
    s_cselect_b32 s31, 0, s31
    s_add_u32 m0, s32, 83200
    s_nop 0
    buffer_load_dwordx4 v4, s[12:15], s31 offen lds
    s_add_u32 m0, s32, 84224
    s_nop 0
    buffer_load_dwordx4 v5, s[12:15], s31 offen lds
    s_add_u32 m0, s32, 85248
    s_nop 0
    buffer_load_dwordx4 v6, s[12:15], s31 offen lds
    s_add_u32 m0, s32, 86272
    s_nop 0
    buffer_load_dwordx4 v7, s[12:15], s31 offen lds
    s_add_u32 s31, s31, 245760
    s_cmp_ge_u32 s31, 2457600
    s_cselect_b32 s31, 0, s31
    s_add_u32 m0, s32, 99840
    s_nop 0
    buffer_load_dwordx4 v4, s[12:15], s31 offen lds
    s_add_u32 m0, s32, 100864
    s_nop 0
    buffer_load_dwordx4 v5, s[12:15], s31 offen lds
    s_add_u32 m0, s32, 101888
    s_nop 0
    buffer_load_dwordx4 v6, s[12:15], s31 offen lds
    s_add_u32 m0, s32, 102912
    s_nop 0
    buffer_load_dwordx4 v7, s[12:15], s31 offen lds
    s_add_u32 s31, s31, 245760
    s_cmp_ge_u32 s31, 2457600
    s_cselect_b32 s31, 0, s31
    s_waitcnt vmcnt(24)
    s_barrier
    s_add_u32 m0, s32, 116480
    s_nop 0
    buffer_load_dwordx4 v4, s[12:15], s31 offen lds
    s_add_u32 m0, s32, 117504
    s_nop 0
    buffer_load_dwordx4 v5, s[12:15], s31 offen lds
    s_add_u32 m0, s32, 118528
    s_nop 0
    buffer_load_dwordx4 v6, s[12:15], s31 offen lds
    s_add_u32 m0, s32, 119552
    s_nop 0
    buffer_load_dwordx4 v7, s[12:15], s31 offen lds
    s_add_u32 s31, s31, 245760
    s_cmp_ge_u32 s31, 2457600
    s_cselect_b32 s31, 0, s31
    s_waitcnt vmcnt(24)
    s_barrier
    s_add_u32 m0, s32, 133120
    s_nop 0
    buffer_load_dwordx4 v4, s[12:15], s31 offen lds
    s_add_u32 m0, s32, 134144
    s_nop 0
    buffer_load_dwordx4 v5, s[12:15], s31 offen lds
    s_add_u32 m0, s32, 135168
    s_nop 0
    buffer_load_dwordx4 v6, s[12:15], s31 offen lds
    s_add_u32 m0, s32, 136192
    s_nop 0
    buffer_load_dwordx4 v7, s[12:15], s31 offen lds
    s_add_u32 s31, s31, 245760
    s_cmp_ge_u32 s31, 2457600
    s_cselect_b32 s31, 0, s31
    s_waitcnt vmcnt(24)
    s_barrier
    s_add_u32 m0, s32, 0
    s_nop 0
    buffer_load_dwordx4 v4, s[12:15], s31 offen lds
    s_add_u32 m0, s32, 1024
    s_nop 0
    buffer_load_dwordx4 v5, s[12:15], s31 offen lds
    s_add_u32 m0, s32, 2048
    s_nop 0
    buffer_load_dwordx4 v6, s[12:15], s31 offen lds
    s_add_u32 m0, s32, 3072
    s_nop 0
    buffer_load_dwordx4 v7, s[12:15], s31 offen lds
    s_waitcnt vmcnt(24)
    s_barrier
    s_waitcnt vmcnt(20)
    s_barrier
    s_mov_b32 s21, 0
    buffer_load_dwordx2 v[20:21], v12, s[36:39], s21 offen sc1
    s_mov_b32 s21, 2048
    buffer_load_dwordx2 v[22:23], v12, s[36:39], s21 offen sc1
    s_mov_b32 s21, 4096
    buffer_load_dwordx2 v[24:25], v12, s[36:39], s21 offen sc1
    s_mov_b32 s21, 6144
    buffer_load_dwordx2 v[26:27], v12, s[36:39], s21 offen sc1
    s_mov_b32 s21, 8192
    buffer_load_dwordx2 v[28:29], v12, s[36:39], s21 offen sc1
    s_waitcnt vmcnt(21)
    s_barrier
    s_waitcnt vmcnt(17)
    s_barrier
    s_waitcnt vmcnt(13)
    s_barrier
    s_waitcnt vmcnt(0)
    v_pk_add_f32 v[20:21], v[20:21], v[22:23]
    v_pk_add_f32 v[24:25], v[24:25], v[26:27]
    v_pk_add_f32 v[20:21], v[20:21], v[28:29]
    v_pk_add_f32 v[20:21], v[20:21], v[24:25]
    v_mov_b32 v30, v20
    v_mov_b32 v31, v21
    s_nop 0
    v_permlane32_swap_b32 v20, v30
    v_permlane32_swap_b32 v21, v31
    v_pk_add_f32 v[20:21], v[20:21], v[30:31]
    v_mul_f32 v16, 0xbacccccd, v20
    v_mul_f32 v21, 0x3acccccd, v21
    v_fma_f32 v21, -v16, v16, v21
    v_max_f32 v21, 0, v21
    v_cvt_pk_bf16_f32 v16, v16, v16
    v_and_b32 v16, 0xffff0000, v16
    v_cvt_pk_bf16_f32 v21, v21, v21
    v_and_b32 v21, 0xffff0000, v21
    v_add_f32 v21, 0x3727c5ac, v21
    v_cvt_pk_bf16_f32 v21, v21, v21
    v_and_b32 v21, 0xffff0000, v21
    v_sqrt_f32 v21, v21
    s_nop 0
    v_cvt_pk_bf16_f32 v21, v21, v21
    v_and_b32 v21, 0xffff0000, v21
    v_rcp_f32 v17, v21
    v_mul_f32 v21, v21, v21
    s_cmp_lt_u32 s28, 5
    s_cselect_b32 s21, 0x3ea52b5c, 1.0
    v_mul_f32 v17, s21, v17
    s_lshl_b32 s21, s26, 8
    s_add_u32 s21, s21, 160768
    v_lshlrev_b32 v20, 3, v2
    v_add_u32 v20, s21, v20
    ds_write_b64 v20, v[16:17]
    s_barrier
    s_barrier
    s_waitcnt lgkmcnt(0)
    s_barrier
    s_branch L_p1_done
L_p1b_comp:
    v_lshrrev_b32 v20, 4, v2
    s_lshr_b32 s21, s27, 4
    v_add_u32 v20, s21, v20
    s_mov_b32 s21, 20480
    v_mul_lo_u32 v4, v20, s21
    v_lshl_add_u32 v4, v3, 8, v4
    v_and_b32 v20, 15, v2
    v_lshl_add_u32 v4, v20, 4, v4
    s_add_u32 s8, s6, 0x0
    s_addc_u32 s9, s7, 0
    s_mov_b32 s10, 0x280000
    s_mov_b32 s11, 0x20000
    v_bfe_u32 v20, v1, 2, 2
    v_mul_u32_u24 v9, 4160, v20
    v_mul_u32_u24 v20, 256, v3
    v_add_u32 v9, v9, v20
    v_bfe_u32 v20, v1, 4, 1
    v_mul_u32_u24 v20, 32, v20
    v_add_u32 v9, v9, v20
    v_and_b32 v20, 3, v1
    v_lshl_add_u32 v9, v20, 3, v9
    v_add_u32 v10, 49920, v9
    v_add_u32 v11, 99840, v9
    v_and_b32 v20, 15, v1
    v_lshlrev_b32 v14, 4, v20
    v_lshl_add_u32 v14, v3, 11, v14
    v_bfe_u32 v20, v1, 4, 1
    v_lshl_add_u32 v14, v20, 12, v14
    s_lshl_b32 s21, s24, 3
    v_add_u32 v14, s21, v14
    v_lshlrev_b32 v13, 4, v3
    v_add_u32 v13, 161792, v13
    s_add_u32 s80, s6, 0x1000000
    s_addc_u32 s81, s7, 0
    s_mov_b32 s82, 0x780000
    s_mov_b32 s83, 0x20000
    s_lshl_b32 s21, s26, 8
    s_add_u32 s21, s21, 160768
    v_lshlrev_b32 v12, 3, v2
    v_add_u32 v12, s21, v12
    s_lshr_b32 s29, s24, 5
    v_and_b32 v21, 7, v1
    v_lshlrev_b32 v22, 5, v21
    v_mov_b32 v20, 0
    v_cmp_eq_u32 vcc, 2, v21
    v_mov_b32 v22, 0x101
    s_nop 0
    v_cndmask_b32 v20, v20, v22, vcc
    v_subrev_u32 v22, 0, v21
    v_cmp_gt_u32 vcc, 2, v22
    v_mov_b32 v22, 0x01010101
    s_nop 0
    v_cndmask_b32 v20, v20, v22, vcc
    v_lshlrev_b32 v21, 2, v21
    s_add_u32 s21, s16, 0xffffffff
    s_lshl_b32 s21, s21, 3
    s_add_u32 s21, s21, 3
    s_lshl_b32 s21, s21, 3
    s_add_u32 s21, s21, s18
    s_lshl_b32 s21, s21, 3
    s_add_u32 s21, s21, s29
    s_lshl_b32 s21, s21, 5
    s_mov_b32 s35, 0
L_wl_11:
    buffer_load_dword v22, v21, s[72:75], s21 offen sc1
    s_waitcnt vmcnt(0)
    v_and_b32 v22, v22, v20
    v_cmp_ne_u32 vcc, v22, v20
    s_add_u32 s35, s35, 1
    s_cmp_gt_u32 s35, 65536
    s_cbranch_scc1 L_wlx_12
    s_cbranch_vccz L_wlx_12
    s_sleep 1
    s_branch L_wl_11
L_wlx_12:
    s_cmp_lg_u32 s17, 0
    s_cbranch_scc1 L_acq_13
    buffer_inv sc1
    s_waitcnt vmcnt(0)
L_acq_13:
    buffer_load_dwordx4 v[144:147], v4, s[8:11], s30 offen offset:0 sc1
    buffer_load_dwordx4 v[148:151], v4, s[8:11], s30 offen offset:512 sc1
    buffer_load_dwordx4 v[152:155], v4, s[8:11], s30 offen offset:1024 sc1
    buffer_load_dwordx4 v[156:159], v4, s[8:11], s30 offen offset:1536 sc1
    s_add_u32 s30, s30, 2048
    s_cmp_ge_u32 s30, 20480
    s_cselect_b32 s30, 0, s30
    buffer_load_dwordx4 v[160:163], v4, s[8:11], s30 offen offset:0 sc1
    buffer_load_dwordx4 v[164:167], v4, s[8:11], s30 offen offset:512 sc1
    buffer_load_dwordx4 v[168:171], v4, s[8:11], s30 offen offset:1024 sc1
    buffer_load_dwordx4 v[172:175], v4, s[8:11], s30 offen offset:1536 sc1
    s_add_u32 s30, s30, 2048
    s_cmp_ge_u32 s30, 20480
    s_cselect_b32 s30, 0, s30
    s_barrier
    ds_read_b64_tr_b16 v[32:33], v9 offset:0
    ds_read_b64_tr_b16 v[34:35], v9 offset:1024
    ds_read_b64_tr_b16 v[36:37], v9 offset:64
    ds_read_b64_tr_b16 v[38:39], v9 offset:1088
    ds_read_b64_tr_b16 v[40:41], v9 offset:128
    ds_read_b64_tr_b16 v[42:43], v9 offset:1152
    ds_read_b64_tr_b16 v[44:45], v9 offset:192
    ds_read_b64_tr_b16 v[46:47], v9 offset:1216
    s_waitcnt vmcnt(7)
    s_waitcnt lgkmcnt(6)
    v_mfma_f32_32x32x16_bf16 v[64:79], v[32:35], v[144:147], 0
    ds_read_b64_tr_b16 v[48:49], v9 offset:512
    ds_read_b64_tr_b16 v[50:51], v9 offset:1536
    s_waitcnt lgkmcnt(6)
    v_mfma_f32_32x32x16_bf16 v[80:95], v[36:39], v[144:147], 0
    ds_read_b64_tr_b16 v[52:53], v9 offset:576
    ds_read_b64_tr_b16 v[54:55], v9 offset:1600
    s_waitcnt lgkmcnt(6)
    v_mfma_f32_32x32x16_bf16 v[96:111], v[40:43], v[144:147], 0
    ds_read_b64_tr_b16 v[56:57], v9 offset:640
    ds_read_b64_tr_b16 v[58:59], v9 offset:1664
    s_waitcnt lgkmcnt(6)
    v_mfma_f32_32x32x16_bf16 v[112:127], v[44:47], v[144:147], 0
    ds_read_b64_tr_b16 v[60:61], v9 offset:704
    ds_read_b64_tr_b16 v[62:63], v9 offset:1728
    buffer_load_dwordx4 v[176:179], v4, s[8:11], s30 offen offset:0 sc1
    s_waitcnt vmcnt(7)
    s_waitcnt lgkmcnt(6)
    v_mfma_f32_32x32x16_bf16 v[64:79], v[48:51], v[148:151], v[64:79]
    ds_read_b64_tr_b16 v[32:33], v9 offset:2048
    ds_read_b64_tr_b16 v[34:35], v9 offset:3072
    s_waitcnt lgkmcnt(6)
    v_mfma_f32_32x32x16_bf16 v[80:95], v[52:55], v[148:151], v[80:95]
    ds_read_b64_tr_b16 v[36:37], v9 offset:2112
    ds_read_b64_tr_b16 v[38:39], v9 offset:3136
    s_waitcnt lgkmcnt(6)
    v_mfma_f32_32x32x16_bf16 v[96:111], v[56:59], v[148:151], v[96:111]
    ds_read_b64_tr_b16 v[40:41], v9 offset:2176
    ds_read_b64_tr_b16 v[42:43], v9 offset:3200
    s_waitcnt lgkmcnt(6)
    v_mfma_f32_32x32x16_bf16 v[112:127], v[60:63], v[148:151], v[112:127]
    ds_read_b64_tr_b16 v[44:45], v9 offset:2240
    ds_read_b64_tr_b16 v[46:47], v9 offset:3264
    buffer_load_dwordx4 v[180:183], v4, s[8:11], s30 offen offset:512 sc1
    s_waitcnt vmcnt(7)
    s_waitcnt lgkmcnt(6)
    v_mfma_f32_32x32x16_bf16 v[64:79], v[32:35], v[152:155], v[64:79]
    ds_read_b64_tr_b16 v[48:49], v9 offset:2560
    ds_read_b64_tr_b16 v[50:51], v9 offset:3584
    s_waitcnt lgkmcnt(6)
    v_mfma_f32_32x32x16_bf16 v[80:95], v[36:39], v[152:155], v[80:95]
    ds_read_b64_tr_b16 v[52:53], v9 offset:2624
    ds_read_b64_tr_b16 v[54:55], v9 offset:3648
    s_waitcnt lgkmcnt(6)
    v_mfma_f32_32x32x16_bf16 v[96:111], v[40:43], v[152:155], v[96:111]
    ds_read_b64_tr_b16 v[56:57], v9 offset:2688
    ds_read_b64_tr_b16 v[58:59], v9 offset:3712
    s_waitcnt lgkmcnt(6)
    v_mfma_f32_32x32x16_bf16 v[112:127], v[44:47], v[152:155], v[112:127]
    ds_read_b64_tr_b16 v[60:61], v9 offset:2752
    ds_read_b64_tr_b16 v[62:63], v9 offset:3776
    buffer_load_dwordx4 v[184:187], v4, s[8:11], s30 offen offset:1024 sc1
    s_barrier
    s_waitcnt vmcnt(7)
    s_waitcnt lgkmcnt(6)
    v_mfma_f32_32x32x16_bf16 v[64:79], v[48:51], v[156:159], v[64:79]
    ds_read_b64_tr_b16 v[32:33], v9 offset:16640
    ds_read_b64_tr_b16 v[34:35], v9 offset:17664
    s_waitcnt lgkmcnt(6)
    v_mfma_f32_32x32x16_bf16 v[80:95], v[52:55], v[156:159], v[80:95]
    ds_read_b64_tr_b16 v[36:37], v9 offset:16704
    ds_read_b64_tr_b16 v[38:39], v9 offset:17728
    s_waitcnt lgkmcnt(6)
    v_mfma_f32_32x32x16_bf16 v[96:111], v[56:59], v[156:159], v[96:111]
    ds_read_b64_tr_b16 v[40:41], v9 offset:16768
    ds_read_b64_tr_b16 v[42:43], v9 offset:17792
    s_waitcnt lgkmcnt(6)
    v_mfma_f32_32x32x16_bf16 v[112:127], v[60:63], v[156:159], v[112:127]
    ds_read_b64_tr_b16 v[44:45], v9 offset:16832
    ds_read_b64_tr_b16 v[46:47], v9 offset:17856
    buffer_load_dwordx4 v[188:191], v4, s[8:11], s30 offen offset:1536 sc1
    s_add_u32 s30, s30, 2048
    s_cmp_ge_u32 s30, 20480
    s_cselect_b32 s30, 0, s30
    s_waitcnt vmcnt(7)
    s_waitcnt lgkmcnt(6)
    v_mfma_f32_32x32x16_bf16 v[64:79], v[32:35], v[160:163], v[64:79]
    ds_read_b64_tr_b16 v[48:49], v9 offset:17152
    ds_read_b64_tr_b16 v[50:51], v9 offset:18176
    s_waitcnt lgkmcnt(6)
    v_mfma_f32_32x32x16_bf16 v[80:95], v[36:39], v[160:163], v[80:95]
    ds_read_b64_tr_b16 v[52:53], v9 offset:17216
    ds_read_b64_tr_b16 v[54:55], v9 offset:18240
    s_waitcnt lgkmcnt(6)
    v_mfma_f32_32x32x16_bf16 v[96:111], v[40:43], v[160:163], v[96:111]
    ds_read_b64_tr_b16 v[56:57], v9 offset:17280
    ds_read_b64_tr_b16 v[58:59], v9 offset:18304
    s_waitcnt lgkmcnt(6)
    v_mfma_f32_32x32x16_bf16 v[112:127], v[44:47], v[160:163], v[112:127]
    ds_read_b64_tr_b16 v[60:61], v9 offset:17344
    ds_read_b64_tr_b16 v[62:63], v9 offset:18368
    buffer_load_dwordx4 v[192:195], v4, s[8:11], s30 offen offset:0 sc1
    s_waitcnt vmcnt(7)
    s_waitcnt lgkmcnt(6)
    v_mfma_f32_32x32x16_bf16 v[64:79], v[48:51], v[164:167], v[64:79]
    ds_read_b64_tr_b16 v[32:33], v9 offset:18688
    ds_read_b64_tr_b16 v[34:35], v9 offset:19712
    s_waitcnt lgkmcnt(6)
    v_mfma_f32_32x32x16_bf16 v[80:95], v[52:55], v[164:167], v[80:95]
    ds_read_b64_tr_b16 v[36:37], v9 offset:18752
    ds_read_b64_tr_b16 v[38:39], v9 offset:19776
    s_waitcnt lgkmcnt(6)
    v_mfma_f32_32x32x16_bf16 v[96:111], v[56:59], v[164:167], v[96:111]
    ds_read_b64_tr_b16 v[40:41], v9 offset:18816
    ds_read_b64_tr_b16 v[42:43], v9 offset:19840
    s_waitcnt lgkmcnt(6)
    v_mfma_f32_32x32x16_bf16 v[112:127], v[60:63], v[164:167], v[112:127]
    ds_read_b64_tr_b16 v[44:45], v9 offset:18880
    ds_read_b64_tr_b16 v[46:47], v9 offset:19904
    buffer_load_dwordx4 v[196:199], v4, s[8:11], s30 offen offset:512 sc1
    s_waitcnt vmcnt(7)
    s_waitcnt lgkmcnt(6)
    v_mfma_f32_32x32x16_bf16 v[64:79], v[32:35], v[168:171], v[64:79]
    ds_read_b64_tr_b16 v[48:49], v9 offset:19200
    ds_read_b64_tr_b16 v[50:51], v9 offset:20224
    s_waitcnt lgkmcnt(6)
    v_mfma_f32_32x32x16_bf16 v[80:95], v[36:39], v[168:171], v[80:95]
    ds_read_b64_tr_b16 v[52:53], v9 offset:19264
    ds_read_b64_tr_b16 v[54:55], v9 offset:20288
    s_waitcnt lgkmcnt(6)
    v_mfma_f32_32x32x16_bf16 v[96:111], v[40:43], v[168:171], v[96:111]
    ds_read_b64_tr_b16 v[56:57], v9 offset:19328
    ds_read_b64_tr_b16 v[58:59], v9 offset:20352
    s_waitcnt lgkmcnt(6)
    v_mfma_f32_32x32x16_bf16 v[112:127], v[44:47], v[168:171], v[112:127]
    ds_read_b64_tr_b16 v[60:61], v9 offset:19392
    ds_read_b64_tr_b16 v[62:63], v9 offset:20416
    buffer_load_dwordx4 v[200:203], v4, s[8:11], s30 offen offset:1024 sc1
    s_barrier
    s_waitcnt vmcnt(7)
    s_waitcnt lgkmcnt(6)
    v_mfma_f32_32x32x16_bf16 v[64:79], v[48:51], v[172:175], v[64:79]
    ds_read_b64_tr_b16 v[32:33], v9 offset:33280
    ds_read_b64_tr_b16 v[34:35], v9 offset:34304
    s_waitcnt lgkmcnt(6)
    v_mfma_f32_32x32x16_bf16 v[80:95], v[52:55], v[172:175], v[80:95]
    ds_read_b64_tr_b16 v[36:37], v9 offset:33344
    ds_read_b64_tr_b16 v[38:39], v9 offset:34368
    s_waitcnt lgkmcnt(6)
    v_mfma_f32_32x32x16_bf16 v[96:111], v[56:59], v[172:175], v[96:111]
    ds_read_b64_tr_b16 v[40:41], v9 offset:33408
    ds_read_b64_tr_b16 v[42:43], v9 offset:34432
    s_waitcnt lgkmcnt(6)
    v_mfma_f32_32x32x16_bf16 v[112:127], v[60:63], v[172:175], v[112:127]
    ds_read_b64_tr_b16 v[44:45], v9 offset:33472
    ds_read_b64_tr_b16 v[46:47], v9 offset:34496
    buffer_load_dwordx4 v[204:207], v4, s[8:11], s30 offen offset:1536 sc1
    s_add_u32 s30, s30, 2048
    s_cmp_ge_u32 s30, 20480
    s_cselect_b32 s30, 0, s30
    s_waitcnt vmcnt(7)
    s_waitcnt lgkmcnt(6)
    v_mfma_f32_32x32x16_bf16 v[64:79], v[32:35], v[176:179], v[64:79]
    ds_read_b64_tr_b16 v[48:49], v9 offset:33792
    ds_read_b64_tr_b16 v[50:51], v9 offset:34816
    s_waitcnt lgkmcnt(6)
    v_mfma_f32_32x32x16_bf16 v[80:95], v[36:39], v[176:179], v[80:95]
    ds_read_b64_tr_b16 v[52:53], v9 offset:33856
    ds_read_b64_tr_b16 v[54:55], v9 offset:34880
    s_waitcnt lgkmcnt(6)
    v_mfma_f32_32x32x16_bf16 v[96:111], v[40:43], v[176:179], v[96:111]
    ds_read_b64_tr_b16 v[56:57], v9 offset:33920
    ds_read_b64_tr_b16 v[58:59], v9 offset:34944
    s_waitcnt lgkmcnt(6)
    v_mfma_f32_32x32x16_bf16 v[112:127], v[44:47], v[176:179], v[112:127]
    ds_read_b64_tr_b16 v[60:61], v9 offset:33984
    ds_read_b64_tr_b16 v[62:63], v9 offset:35008
    buffer_load_dwordx4 v[208:211], v4, s[8:11], s30 offen offset:0 sc1
    s_waitcnt vmcnt(7)
    s_waitcnt lgkmcnt(6)
    v_mfma_f32_32x32x16_bf16 v[64:79], v[48:51], v[180:183], v[64:79]
    ds_read_b64_tr_b16 v[32:33], v9 offset:35328
    ds_read_b64_tr_b16 v[34:35], v9 offset:36352
    s_waitcnt lgkmcnt(6)
    v_mfma_f32_32x32x16_bf16 v[80:95], v[52:55], v[180:183], v[80:95]
    ds_read_b64_tr_b16 v[36:37], v9 offset:35392
    ds_read_b64_tr_b16 v[38:39], v9 offset:36416
    s_waitcnt lgkmcnt(6)
    v_mfma_f32_32x32x16_bf16 v[96:111], v[56:59], v[180:183], v[96:111]
    ds_read_b64_tr_b16 v[40:41], v9 offset:35456
    ds_read_b64_tr_b16 v[42:43], v9 offset:36480
    s_waitcnt lgkmcnt(6)
    v_mfma_f32_32x32x16_bf16 v[112:127], v[60:63], v[180:183], v[112:127]
    ds_read_b64_tr_b16 v[44:45], v9 offset:35520
    ds_read_b64_tr_b16 v[46:47], v9 offset:36544
    buffer_load_dwordx4 v[212:215], v4, s[8:11], s30 offen offset:512 sc1
    s_waitcnt vmcnt(7)
    s_waitcnt lgkmcnt(6)
    v_mfma_f32_32x32x16_bf16 v[64:79], v[32:35], v[184:187], v[64:79]
    ds_read_b64_tr_b16 v[48:49], v9 offset:35840
    ds_read_b64_tr_b16 v[50:51], v9 offset:36864
    s_waitcnt lgkmcnt(6)
    v_mfma_f32_32x32x16_bf16 v[80:95], v[36:39], v[184:187], v[80:95]
    ds_read_b64_tr_b16 v[52:53], v9 offset:35904
    ds_read_b64_tr_b16 v[54:55], v9 offset:36928
    s_waitcnt lgkmcnt(6)
    v_mfma_f32_32x32x16_bf16 v[96:111], v[40:43], v[184:187], v[96:111]
    ds_read_b64_tr_b16 v[56:57], v9 offset:35968
    ds_read_b64_tr_b16 v[58:59], v9 offset:36992
    s_waitcnt lgkmcnt(6)
    v_mfma_f32_32x32x16_bf16 v[112:127], v[44:47], v[184:187], v[112:127]
    ds_read_b64_tr_b16 v[60:61], v9 offset:36032
    ds_read_b64_tr_b16 v[62:63], v9 offset:37056
    buffer_load_dwordx4 v[216:219], v4, s[8:11], s30 offen offset:1024 sc1
    s_barrier
    s_waitcnt vmcnt(7)
    s_waitcnt lgkmcnt(6)
    v_mfma_f32_32x32x16_bf16 v[64:79], v[48:51], v[188:191], v[64:79]
    ds_read_b64_tr_b16 v[32:33], v10 offset:0
    ds_read_b64_tr_b16 v[34:35], v10 offset:1024
    s_waitcnt lgkmcnt(6)
    v_mfma_f32_32x32x16_bf16 v[80:95], v[52:55], v[188:191], v[80:95]
    ds_read_b64_tr_b16 v[36:37], v10 offset:64
    ds_read_b64_tr_b16 v[38:39], v10 offset:1088
    s_waitcnt lgkmcnt(6)
    v_mfma_f32_32x32x16_bf16 v[96:111], v[56:59], v[188:191], v[96:111]
    ds_read_b64_tr_b16 v[40:41], v10 offset:128
    ds_read_b64_tr_b16 v[42:43], v10 offset:1152
    s_waitcnt lgkmcnt(6)
    v_mfma_f32_32x32x16_bf16 v[112:127], v[60:63], v[188:191], v[112:127]
    ds_read_b64_tr_b16 v[44:45], v10 offset:192
    ds_read_b64_tr_b16 v[46:47], v10 offset:1216
    buffer_load_dwordx4 v[220:223], v4, s[8:11], s30 offen offset:1536 sc1
    s_add_u32 s30, s30, 2048
    s_cmp_ge_u32 s30, 20480
    s_cselect_b32 s30, 0, s30
    s_waitcnt vmcnt(7)
    s_waitcnt lgkmcnt(6)
    v_mfma_f32_32x32x16_bf16 v[64:79], v[32:35], v[192:195], v[64:79]
    ds_read_b64_tr_b16 v[48:49], v10 offset:512
    ds_read_b64_tr_b16 v[50:51], v10 offset:1536
    s_waitcnt lgkmcnt(6)
    v_mfma_f32_32x32x16_bf16 v[80:95], v[36:39], v[192:195], v[80:95]
    ds_read_b64_tr_b16 v[52:53], v10 offset:576
    ds_read_b64_tr_b16 v[54:55], v10 offset:1600
    s_waitcnt lgkmcnt(6)
    v_mfma_f32_32x32x16_bf16 v[96:111], v[40:43], v[192:195], v[96:111]
    ds_read_b64_tr_b16 v[56:57], v10 offset:640
    ds_read_b64_tr_b16 v[58:59], v10 offset:1664
    s_waitcnt lgkmcnt(6)
    v_mfma_f32_32x32x16_bf16 v[112:127], v[44:47], v[192:195], v[112:127]
    ds_read_b64_tr_b16 v[60:61], v10 offset:704
    ds_read_b64_tr_b16 v[62:63], v10 offset:1728
    buffer_load_dwordx4 v[224:227], v4, s[8:11], s30 offen offset:0 sc1
    s_waitcnt vmcnt(7)
    s_waitcnt lgkmcnt(6)
    v_mfma_f32_32x32x16_bf16 v[64:79], v[48:51], v[196:199], v[64:79]
    ds_read_b64_tr_b16 v[32:33], v10 offset:2048
    ds_read_b64_tr_b16 v[34:35], v10 offset:3072
    s_waitcnt lgkmcnt(6)
    v_mfma_f32_32x32x16_bf16 v[80:95], v[52:55], v[196:199], v[80:95]
    ds_read_b64_tr_b16 v[36:37], v10 offset:2112
    ds_read_b64_tr_b16 v[38:39], v10 offset:3136
    s_waitcnt lgkmcnt(6)
    v_mfma_f32_32x32x16_bf16 v[96:111], v[56:59], v[196:199], v[96:111]
    ds_read_b64_tr_b16 v[40:41], v10 offset:2176
    ds_read_b64_tr_b16 v[42:43], v10 offset:3200
    s_waitcnt lgkmcnt(6)
    v_mfma_f32_32x32x16_bf16 v[112:127], v[60:63], v[196:199], v[112:127]
    ds_read_b64_tr_b16 v[44:45], v10 offset:2240
    ds_read_b64_tr_b16 v[46:47], v10 offset:3264
    buffer_load_dwordx4 v[228:231], v4, s[8:11], s30 offen offset:512 sc1
    s_waitcnt vmcnt(7)
    s_waitcnt lgkmcnt(6)
    v_mfma_f32_32x32x16_bf16 v[64:79], v[32:35], v[200:203], v[64:79]
    ds_read_b64_tr_b16 v[48:49], v10 offset:2560
    ds_read_b64_tr_b16 v[50:51], v10 offset:3584
    s_waitcnt lgkmcnt(6)
    v_mfma_f32_32x32x16_bf16 v[80:95], v[36:39], v[200:203], v[80:95]
    ds_read_b64_tr_b16 v[52:53], v10 offset:2624
    ds_read_b64_tr_b16 v[54:55], v10 offset:3648
    s_waitcnt lgkmcnt(6)
    v_mfma_f32_32x32x16_bf16 v[96:111], v[40:43], v[200:203], v[96:111]
    ds_read_b64_tr_b16 v[56:57], v10 offset:2688
    ds_read_b64_tr_b16 v[58:59], v10 offset:3712
    s_waitcnt lgkmcnt(6)
    v_mfma_f32_32x32x16_bf16 v[112:127], v[44:47], v[200:203], v[112:127]
    ds_read_b64_tr_b16 v[60:61], v10 offset:2752
    ds_read_b64_tr_b16 v[62:63], v10 offset:3776
    buffer_load_dwordx4 v[232:235], v4, s[8:11], s30 offen offset:1024 sc1
    s_barrier
    s_waitcnt vmcnt(7)
    s_waitcnt lgkmcnt(6)
    v_mfma_f32_32x32x16_bf16 v[64:79], v[48:51], v[204:207], v[64:79]
    ds_read_b64_tr_b16 v[32:33], v10 offset:16640
    ds_read_b64_tr_b16 v[34:35], v10 offset:17664
    s_waitcnt lgkmcnt(6)
    v_mfma_f32_32x32x16_bf16 v[80:95], v[52:55], v[204:207], v[80:95]
    ds_read_b64_tr_b16 v[36:37], v10 offset:16704
    ds_read_b64_tr_b16 v[38:39], v10 offset:17728
    s_waitcnt lgkmcnt(6)
    v_mfma_f32_32x32x16_bf16 v[96:111], v[56:59], v[204:207], v[96:111]
    ds_read_b64_tr_b16 v[40:41], v10 offset:16768
    ds_read_b64_tr_b16 v[42:43], v10 offset:17792
    s_waitcnt lgkmcnt(6)
    v_mfma_f32_32x32x16_bf16 v[112:127], v[60:63], v[204:207], v[112:127]
    ds_read_b64_tr_b16 v[44:45], v10 offset:16832
    ds_read_b64_tr_b16 v[46:47], v10 offset:17856
    buffer_load_dwordx4 v[236:239], v4, s[8:11], s30 offen offset:1536 sc1
    s_add_u32 s30, s30, 2048
    s_cmp_ge_u32 s30, 20480
    s_cselect_b32 s30, 0, s30
    s_waitcnt vmcnt(7)
    s_waitcnt lgkmcnt(6)
    v_mfma_f32_32x32x16_bf16 v[64:79], v[32:35], v[208:211], v[64:79]
    ds_read_b64_tr_b16 v[48:49], v10 offset:17152
    ds_read_b64_tr_b16 v[50:51], v10 offset:18176
    s_waitcnt lgkmcnt(6)
    v_mfma_f32_32x32x16_bf16 v[80:95], v[36:39], v[208:211], v[80:95]
    ds_read_b64_tr_b16 v[52:53], v10 offset:17216
    ds_read_b64_tr_b16 v[54:55], v10 offset:18240
    s_waitcnt lgkmcnt(6)
    v_mfma_f32_32x32x16_bf16 v[96:111], v[40:43], v[208:211], v[96:111]
    ds_read_b64_tr_b16 v[56:57], v10 offset:17280
    ds_read_b64_tr_b16 v[58:59], v10 offset:18304
    s_waitcnt lgkmcnt(6)
    v_mfma_f32_32x32x16_bf16 v[112:127], v[44:47], v[208:211], v[112:127]
    ds_read_b64_tr_b16 v[60:61], v10 offset:17344
    ds_read_b64_tr_b16 v[62:63], v10 offset:18368
    buffer_load_dwordx4 v[144:147], v4, s[8:11], s30 offen offset:0 sc1
    s_waitcnt vmcnt(7)
    s_waitcnt lgkmcnt(6)
    v_mfma_f32_32x32x16_bf16 v[64:79], v[48:51], v[212:215], v[64:79]
    ds_read_b64_tr_b16 v[32:33], v10 offset:18688
    ds_read_b64_tr_b16 v[34:35], v10 offset:19712
    s_waitcnt lgkmcnt(6)
    v_mfma_f32_32x32x16_bf16 v[80:95], v[52:55], v[212:215], v[80:95]
    ds_read_b64_tr_b16 v[36:37], v10 offset:18752
    ds_read_b64_tr_b16 v[38:39], v10 offset:19776
    s_waitcnt lgkmcnt(6)
    v_mfma_f32_32x32x16_bf16 v[96:111], v[56:59], v[212:215], v[96:111]
    ds_read_b64_tr_b16 v[40:41], v10 offset:18816
    ds_read_b64_tr_b16 v[42:43], v10 offset:19840
    s_waitcnt lgkmcnt(6)
    v_mfma_f32_32x32x16_bf16 v[112:127], v[60:63], v[212:215], v[112:127]
    ds_read_b64_tr_b16 v[44:45], v10 offset:18880
    ds_read_b64_tr_b16 v[46:47], v10 offset:19904
    buffer_load_dwordx4 v[148:151], v4, s[8:11], s30 offen offset:512 sc1
    s_waitcnt vmcnt(7)
    s_waitcnt lgkmcnt(6)
    v_mfma_f32_32x32x16_bf16 v[64:79], v[32:35], v[216:219], v[64:79]
    ds_read_b64_tr_b16 v[48:49], v10 offset:19200
    ds_read_b64_tr_b16 v[50:51], v10 offset:20224
    s_waitcnt lgkmcnt(6)
    v_mfma_f32_32x32x16_bf16 v[80:95], v[36:39], v[216:219], v[80:95]
    ds_read_b64_tr_b16 v[52:53], v10 offset:19264
    ds_read_b64_tr_b16 v[54:55], v10 offset:20288
    s_waitcnt lgkmcnt(6)
    v_mfma_f32_32x32x16_bf16 v[96:111], v[40:43], v[216:219], v[96:111]
    ds_read_b64_tr_b16 v[56:57], v10 offset:19328
    ds_read_b64_tr_b16 v[58:59], v10 offset:20352
    s_waitcnt lgkmcnt(6)
    v_mfma_f32_32x32x16_bf16 v[112:127], v[44:47], v[216:219], v[112:127]
    ds_read_b64_tr_b16 v[60:61], v10 offset:19392
    ds_read_b64_tr_b16 v[62:63], v10 offset:20416
    buffer_load_dwordx4 v[152:155], v4, s[8:11], s30 offen offset:1024 sc1
    s_barrier
    s_waitcnt vmcnt(7)
    s_waitcnt lgkmcnt(6)
    v_mfma_f32_32x32x16_bf16 v[64:79], v[48:51], v[220:223], v[64:79]
    ds_read_b64_tr_b16 v[32:33], v10 offset:33280
    ds_read_b64_tr_b16 v[34:35], v10 offset:34304
    s_waitcnt lgkmcnt(6)
    v_mfma_f32_32x32x16_bf16 v[80:95], v[52:55], v[220:223], v[80:95]
    ds_read_b64_tr_b16 v[36:37], v10 offset:33344
    ds_read_b64_tr_b16 v[38:39], v10 offset:34368
    s_waitcnt lgkmcnt(6)
    v_mfma_f32_32x32x16_bf16 v[96:111], v[56:59], v[220:223], v[96:111]
    ds_read_b64_tr_b16 v[40:41], v10 offset:33408
    ds_read_b64_tr_b16 v[42:43], v10 offset:34432
    s_waitcnt lgkmcnt(6)
    v_mfma_f32_32x32x16_bf16 v[112:127], v[60:63], v[220:223], v[112:127]
    ds_read_b64_tr_b16 v[44:45], v10 offset:33472
    ds_read_b64_tr_b16 v[46:47], v10 offset:34496
    buffer_load_dwordx4 v[156:159], v4, s[8:11], s30 offen offset:1536 sc1
    s_add_u32 s30, s30, 2048
    s_cmp_ge_u32 s30, 20480
    s_cselect_b32 s30, 0, s30
    s_waitcnt vmcnt(7)
    s_waitcnt lgkmcnt(6)
    v_mfma_f32_32x32x16_bf16 v[64:79], v[32:35], v[224:227], v[64:79]
    ds_read_b64_tr_b16 v[48:49], v10 offset:33792
    ds_read_b64_tr_b16 v[50:51], v10 offset:34816
    s_waitcnt lgkmcnt(6)
    v_mfma_f32_32x32x16_bf16 v[80:95], v[36:39], v[224:227], v[80:95]
    ds_read_b64_tr_b16 v[52:53], v10 offset:33856
    ds_read_b64_tr_b16 v[54:55], v10 offset:34880
    s_waitcnt lgkmcnt(6)
    v_mfma_f32_32x32x16_bf16 v[96:111], v[40:43], v[224:227], v[96:111]
    ds_read_b64_tr_b16 v[56:57], v10 offset:33920
    ds_read_b64_tr_b16 v[58:59], v10 offset:34944
    s_waitcnt lgkmcnt(6)
    v_mfma_f32_32x32x16_bf16 v[112:127], v[44:47], v[224:227], v[112:127]
    ds_read_b64_tr_b16 v[60:61], v10 offset:33984
    ds_read_b64_tr_b16 v[62:63], v10 offset:35008
    buffer_load_dwordx4 v[160:163], v4, s[8:11], s30 offen offset:0 sc1
    s_waitcnt vmcnt(7)
    s_waitcnt lgkmcnt(6)
    v_mfma_f32_32x32x16_bf16 v[64:79], v[48:51], v[228:231], v[64:79]
    ds_read_b64_tr_b16 v[32:33], v10 offset:35328
    ds_read_b64_tr_b16 v[34:35], v10 offset:36352
    s_waitcnt lgkmcnt(6)
    v_mfma_f32_32x32x16_bf16 v[80:95], v[52:55], v[228:231], v[80:95]
    ds_read_b64_tr_b16 v[36:37], v10 offset:35392
    ds_read_b64_tr_b16 v[38:39], v10 offset:36416
    s_waitcnt lgkmcnt(6)
    v_mfma_f32_32x32x16_bf16 v[96:111], v[56:59], v[228:231], v[96:111]
    ds_read_b64_tr_b16 v[40:41], v10 offset:35456
    ds_read_b64_tr_b16 v[42:43], v10 offset:36480
    s_waitcnt lgkmcnt(6)
    v_mfma_f32_32x32x16_bf16 v[112:127], v[60:63], v[228:231], v[112:127]
    ds_read_b64_tr_b16 v[44:45], v10 offset:35520
    ds_read_b64_tr_b16 v[46:47], v10 offset:36544
    buffer_load_dwordx4 v[164:167], v4, s[8:11], s30 offen offset:512 sc1
    s_waitcnt vmcnt(7)
    s_waitcnt lgkmcnt(6)
    v_mfma_f32_32x32x16_bf16 v[64:79], v[32:35], v[232:235], v[64:79]
    ds_read_b64_tr_b16 v[48:49], v10 offset:35840
    ds_read_b64_tr_b16 v[50:51], v10 offset:36864
    s_waitcnt lgkmcnt(6)
    v_mfma_f32_32x32x16_bf16 v[80:95], v[36:39], v[232:235], v[80:95]
    ds_read_b64_tr_b16 v[52:53], v10 offset:35904
    ds_read_b64_tr_b16 v[54:55], v10 offset:36928
    s_waitcnt lgkmcnt(6)
    v_mfma_f32_32x32x16_bf16 v[96:111], v[40:43], v[232:235], v[96:111]
    ds_read_b64_tr_b16 v[56:57], v10 offset:35968
    ds_read_b64_tr_b16 v[58:59], v10 offset:36992
    s_waitcnt lgkmcnt(6)
    v_mfma_f32_32x32x16_bf16 v[112:127], v[44:47], v[232:235], v[112:127]
    ds_read_b64_tr_b16 v[60:61], v10 offset:36032
    ds_read_b64_tr_b16 v[62:63], v10 offset:37056
    buffer_load_dwordx4 v[168:171], v4, s[8:11], s30 offen offset:1024 sc1
    s_barrier
    s_waitcnt vmcnt(7)
    s_waitcnt lgkmcnt(6)
    v_mfma_f32_32x32x16_bf16 v[64:79], v[48:51], v[236:239], v[64:79]
    ds_read_b64_tr_b16 v[32:33], v11 offset:0
    ds_read_b64_tr_b16 v[34:35], v11 offset:1024
    s_waitcnt lgkmcnt(6)
    v_mfma_f32_32x32x16_bf16 v[80:95], v[52:55], v[236:239], v[80:95]
    ds_read_b64_tr_b16 v[36:37], v11 offset:64
    ds_read_b64_tr_b16 v[38:39], v11 offset:1088
    s_waitcnt lgkmcnt(6)
    v_mfma_f32_32x32x16_bf16 v[96:111], v[56:59], v[236:239], v[96:111]
    ds_read_b64_tr_b16 v[40:41], v11 offset:128
    ds_read_b64_tr_b16 v[42:43], v11 offset:1152
    s_waitcnt lgkmcnt(6)
    v_mfma_f32_32x32x16_bf16 v[112:127], v[60:63], v[236:239], v[112:127]
    ds_read_b64_tr_b16 v[44:45], v11 offset:192
    ds_read_b64_tr_b16 v[46:47], v11 offset:1216
    buffer_load_dwordx4 v[172:175], v4, s[8:11], s30 offen offset:1536 sc1
    s_add_u32 s30, s30, 2048
    s_cmp_ge_u32 s30, 20480
    s_cselect_b32 s30, 0, s30
    s_waitcnt vmcnt(7)
    s_waitcnt lgkmcnt(6)
    v_mfma_f32_32x32x16_bf16 v[64:79], v[32:35], v[144:147], v[64:79]
    ds_read_b64_tr_b16 v[48:49], v11 offset:512
    ds_read_b64_tr_b16 v[50:51], v11 offset:1536
    s_waitcnt lgkmcnt(6)
    v_mfma_f32_32x32x16_bf16 v[80:95], v[36:39], v[144:147], v[80:95]
    ds_read_b64_tr_b16 v[52:53], v11 offset:576
    ds_read_b64_tr_b16 v[54:55], v11 offset:1600
    s_waitcnt lgkmcnt(6)
    v_mfma_f32_32x32x16_bf16 v[96:111], v[40:43], v[144:147], v[96:111]
    ds_read_b64_tr_b16 v[56:57], v11 offset:640
    ds_read_b64_tr_b16 v[58:59], v11 offset:1664
    s_waitcnt lgkmcnt(6)
    v_mfma_f32_32x32x16_bf16 v[112:127], v[44:47], v[144:147], v[112:127]
    ds_read_b64_tr_b16 v[60:61], v11 offset:704
    ds_read_b64_tr_b16 v[62:63], v11 offset:1728
    buffer_load_dwordx4 v[176:179], v4, s[8:11], s30 offen offset:0 sc1
    s_waitcnt vmcnt(7)
    s_waitcnt lgkmcnt(6)
    v_mfma_f32_32x32x16_bf16 v[64:79], v[48:51], v[148:151], v[64:79]
    ds_read_b64_tr_b16 v[32:33], v11 offset:2048
    ds_read_b64_tr_b16 v[34:35], v11 offset:3072
    s_waitcnt lgkmcnt(6)
    v_mfma_f32_32x32x16_bf16 v[80:95], v[52:55], v[148:151], v[80:95]
    ds_read_b64_tr_b16 v[36:37], v11 offset:2112
    ds_read_b64_tr_b16 v[38:39], v11 offset:3136
    s_waitcnt lgkmcnt(6)
    v_mfma_f32_32x32x16_bf16 v[96:111], v[56:59], v[148:151], v[96:111]
    ds_read_b64_tr_b16 v[40:41], v11 offset:2176
    ds_read_b64_tr_b16 v[42:43], v11 offset:3200
    s_waitcnt lgkmcnt(6)
    v_mfma_f32_32x32x16_bf16 v[112:127], v[60:63], v[148:151], v[112:127]
    ds_read_b64_tr_b16 v[44:45], v11 offset:2240
    ds_read_b64_tr_b16 v[46:47], v11 offset:3264
    buffer_load_dwordx4 v[180:183], v4, s[8:11], s30 offen offset:512 sc1
    s_waitcnt vmcnt(7)
    s_waitcnt lgkmcnt(6)
    v_mfma_f32_32x32x16_bf16 v[64:79], v[32:35], v[152:155], v[64:79]
    ds_read_b64_tr_b16 v[48:49], v11 offset:2560
    ds_read_b64_tr_b16 v[50:51], v11 offset:3584
    s_waitcnt lgkmcnt(6)
    v_mfma_f32_32x32x16_bf16 v[80:95], v[36:39], v[152:155], v[80:95]
    ds_read_b64_tr_b16 v[52:53], v11 offset:2624
    ds_read_b64_tr_b16 v[54:55], v11 offset:3648
    s_waitcnt lgkmcnt(6)
    v_mfma_f32_32x32x16_bf16 v[96:111], v[40:43], v[152:155], v[96:111]
    ds_read_b64_tr_b16 v[56:57], v11 offset:2688
    ds_read_b64_tr_b16 v[58:59], v11 offset:3712
    s_waitcnt lgkmcnt(6)
    v_mfma_f32_32x32x16_bf16 v[112:127], v[44:47], v[152:155], v[112:127]
    ds_read_b64_tr_b16 v[60:61], v11 offset:2752
    ds_read_b64_tr_b16 v[62:63], v11 offset:3776
    buffer_load_dwordx4 v[184:187], v4, s[8:11], s30 offen offset:1024 sc1
    s_barrier
    s_waitcnt vmcnt(7)
    s_waitcnt lgkmcnt(6)
    v_mfma_f32_32x32x16_bf16 v[64:79], v[48:51], v[156:159], v[64:79]
    ds_read_b64_tr_b16 v[32:33], v11 offset:16640
    ds_read_b64_tr_b16 v[34:35], v11 offset:17664
    s_waitcnt lgkmcnt(6)
    v_mfma_f32_32x32x16_bf16 v[80:95], v[52:55], v[156:159], v[80:95]
    ds_read_b64_tr_b16 v[36:37], v11 offset:16704
    ds_read_b64_tr_b16 v[38:39], v11 offset:17728
    s_waitcnt lgkmcnt(6)
    v_mfma_f32_32x32x16_bf16 v[96:111], v[56:59], v[156:159], v[96:111]
    ds_read_b64_tr_b16 v[40:41], v11 offset:16768
    ds_read_b64_tr_b16 v[42:43], v11 offset:17792
    s_waitcnt lgkmcnt(6)
    v_mfma_f32_32x32x16_bf16 v[112:127], v[60:63], v[156:159], v[112:127]
    ds_read_b64_tr_b16 v[44:45], v11 offset:16832
    ds_read_b64_tr_b16 v[46:47], v11 offset:17856
    buffer_load_dwordx4 v[188:191], v4, s[8:11], s30 offen offset:1536 sc1
    s_add_u32 s30, s30, 2048
    s_cmp_ge_u32 s30, 20480
    s_cselect_b32 s30, 0, s30
    s_waitcnt vmcnt(7)
    s_waitcnt lgkmcnt(6)
    v_mfma_f32_32x32x16_bf16 v[64:79], v[32:35], v[160:163], v[64:79]
    ds_read_b64_tr_b16 v[48:49], v11 offset:17152
    ds_read_b64_tr_b16 v[50:51], v11 offset:18176
    s_waitcnt lgkmcnt(6)
    v_mfma_f32_32x32x16_bf16 v[80:95], v[36:39], v[160:163], v[80:95]
    ds_read_b64_tr_b16 v[52:53], v11 offset:17216
    ds_read_b64_tr_b16 v[54:55], v11 offset:18240
    s_waitcnt lgkmcnt(6)
    v_mfma_f32_32x32x16_bf16 v[96:111], v[40:43], v[160:163], v[96:111]
    ds_read_b64_tr_b16 v[56:57], v11 offset:17280
    ds_read_b64_tr_b16 v[58:59], v11 offset:18304
    s_waitcnt lgkmcnt(6)
    v_mfma_f32_32x32x16_bf16 v[112:127], v[44:47], v[160:163], v[112:127]
    ds_read_b64_tr_b16 v[60:61], v11 offset:17344
    ds_read_b64_tr_b16 v[62:63], v11 offset:18368
    buffer_load_dwordx4 v[192:195], v4, s[8:11], s30 offen offset:0 sc1
    s_waitcnt vmcnt(7)
    s_waitcnt lgkmcnt(6)
    v_mfma_f32_32x32x16_bf16 v[64:79], v[48:51], v[164:167], v[64:79]
    ds_read_b64_tr_b16 v[32:33], v11 offset:18688
    ds_read_b64_tr_b16 v[34:35], v11 offset:19712
    s_waitcnt lgkmcnt(6)
    v_mfma_f32_32x32x16_bf16 v[80:95], v[52:55], v[164:167], v[80:95]
    ds_read_b64_tr_b16 v[36:37], v11 offset:18752
    ds_read_b64_tr_b16 v[38:39], v11 offset:19776
    s_waitcnt lgkmcnt(6)
    v_mfma_f32_32x32x16_bf16 v[96:111], v[56:59], v[164:167], v[96:111]
    ds_read_b64_tr_b16 v[40:41], v11 offset:18816
    ds_read_b64_tr_b16 v[42:43], v11 offset:19840
    s_waitcnt lgkmcnt(6)
    v_mfma_f32_32x32x16_bf16 v[112:127], v[60:63], v[164:167], v[112:127]
    ds_read_b64_tr_b16 v[44:45], v11 offset:18880
    ds_read_b64_tr_b16 v[46:47], v11 offset:19904
    buffer_load_dwordx4 v[196:199], v4, s[8:11], s30 offen offset:512 sc1
    s_waitcnt vmcnt(7)
    s_waitcnt lgkmcnt(6)
    v_mfma_f32_32x32x16_bf16 v[64:79], v[32:35], v[168:171], v[64:79]
    ds_read_b64_tr_b16 v[48:49], v11 offset:19200
    ds_read_b64_tr_b16 v[50:51], v11 offset:20224
    s_waitcnt lgkmcnt(6)
    v_mfma_f32_32x32x16_bf16 v[80:95], v[36:39], v[168:171], v[80:95]
    ds_read_b64_tr_b16 v[52:53], v11 offset:19264
    ds_read_b64_tr_b16 v[54:55], v11 offset:20288
    s_waitcnt lgkmcnt(6)
    v_mfma_f32_32x32x16_bf16 v[96:111], v[40:43], v[168:171], v[96:111]
    ds_read_b64_tr_b16 v[56:57], v11 offset:19328
    ds_read_b64_tr_b16 v[58:59], v11 offset:20352
    s_waitcnt lgkmcnt(6)
    v_mfma_f32_32x32x16_bf16 v[112:127], v[44:47], v[168:171], v[112:127]
    ds_read_b64_tr_b16 v[60:61], v11 offset:19392
    ds_read_b64_tr_b16 v[62:63], v11 offset:20416
    buffer_load_dwordx4 v[200:203], v4, s[8:11], s30 offen offset:1024 sc1
    s_barrier
    s_waitcnt vmcnt(7)
    s_waitcnt lgkmcnt(6)
    v_mfma_f32_32x32x16_bf16 v[64:79], v[48:51], v[172:175], v[64:79]
    ds_read_b64_tr_b16 v[32:33], v11 offset:33280
    ds_read_b64_tr_b16 v[34:35], v11 offset:34304
    s_waitcnt lgkmcnt(6)
    v_mfma_f32_32x32x16_bf16 v[80:95], v[52:55], v[172:175], v[80:95]
    ds_read_b64_tr_b16 v[36:37], v11 offset:33344
    ds_read_b64_tr_b16 v[38:39], v11 offset:34368
    s_waitcnt lgkmcnt(6)
    v_mfma_f32_32x32x16_bf16 v[96:111], v[56:59], v[172:175], v[96:111]
    ds_read_b64_tr_b16 v[40:41], v11 offset:33408
    ds_read_b64_tr_b16 v[42:43], v11 offset:34432
    s_waitcnt lgkmcnt(6)
    v_mfma_f32_32x32x16_bf16 v[112:127], v[60:63], v[172:175], v[112:127]
    ds_read_b64_tr_b16 v[44:45], v11 offset:33472
    ds_read_b64_tr_b16 v[46:47], v11 offset:34496
    buffer_load_dwordx4 v[204:207], v4, s[8:11], s30 offen offset:1536 sc1
    s_waitcnt vmcnt(7)
    s_waitcnt lgkmcnt(6)
    v_mfma_f32_32x32x16_bf16 v[64:79], v[32:35], v[176:179], v[64:79]
    ds_read_b64_tr_b16 v[48:49], v11 offset:33792
    ds_read_b64_tr_b16 v[50:51], v11 offset:34816
    s_waitcnt lgkmcnt(6)
    v_mfma_f32_32x32x16_bf16 v[80:95], v[36:39], v[176:179], v[80:95]
    ds_read_b64_tr_b16 v[52:53], v11 offset:33856
    ds_read_b64_tr_b16 v[54:55], v11 offset:34880
    s_waitcnt lgkmcnt(6)
    v_mfma_f32_32x32x16_bf16 v[96:111], v[40:43], v[176:179], v[96:111]
    ds_read_b64_tr_b16 v[56:57], v11 offset:33920
    ds_read_b64_tr_b16 v[58:59], v11 offset:34944
    s_waitcnt lgkmcnt(6)
    v_mfma_f32_32x32x16_bf16 v[112:127], v[44:47], v[176:179], v[112:127]
    ds_read_b64_tr_b16 v[60:61], v11 offset:33984
    ds_read_b64_tr_b16 v[62:63], v11 offset:35008
    s_waitcnt vmcnt(6)
    s_waitcnt lgkmcnt(6)
    v_mfma_f32_32x32x16_bf16 v[64:79], v[48:51], v[180:183], v[64:79]
    ds_read_b64_tr_b16 v[32:33], v11 offset:35328
    ds_read_b64_tr_b16 v[34:35], v11 offset:36352
    s_waitcnt lgkmcnt(6)
    v_mfma_f32_32x32x16_bf16 v[80:95], v[52:55], v[180:183], v[80:95]
    ds_read_b64_tr_b16 v[36:37], v11 offset:35392
    ds_read_b64_tr_b16 v[38:39], v11 offset:36416
    s_waitcnt lgkmcnt(6)
    v_mfma_f32_32x32x16_bf16 v[96:111], v[56:59], v[180:183], v[96:111]
    ds_read_b64_tr_b16 v[40:41], v11 offset:35456
    ds_read_b64_tr_b16 v[42:43], v11 offset:36480
    s_waitcnt lgkmcnt(6)
    v_mfma_f32_32x32x16_bf16 v[112:127], v[60:63], v[180:183], v[112:127]
    ds_read_b64_tr_b16 v[44:45], v11 offset:35520
    ds_read_b64_tr_b16 v[46:47], v11 offset:36544
    s_waitcnt vmcnt(5)
    s_waitcnt lgkmcnt(6)
    v_mfma_f32_32x32x16_bf16 v[64:79], v[32:35], v[184:187], v[64:79]
    ds_read_b64_tr_b16 v[48:49], v11 offset:35840
    ds_read_b64_tr_b16 v[50:51], v11 offset:36864
    s_waitcnt lgkmcnt(6)
    v_mfma_f32_32x32x16_bf16 v[80:95], v[36:39], v[184:187], v[80:95]
    ds_read_b64_tr_b16 v[52:53], v11 offset:35904
    ds_read_b64_tr_b16 v[54:55], v11 offset:36928
    s_waitcnt lgkmcnt(6)
    v_mfma_f32_32x32x16_bf16 v[96:111], v[40:43], v[184:187], v[96:111]
    ds_read_b64_tr_b16 v[56:57], v11 offset:35968
    ds_read_b64_tr_b16 v[58:59], v11 offset:36992
    s_waitcnt lgkmcnt(6)
    v_mfma_f32_32x32x16_bf16 v[112:127], v[44:47], v[184:187], v[112:127]
    ds_read_b64_tr_b16 v[60:61], v11 offset:36032
    ds_read_b64_tr_b16 v[62:63], v11 offset:37056
    s_barrier
    s_waitcnt vmcnt(4)
    s_waitcnt lgkmcnt(6)
    v_mfma_f32_32x32x16_bf16 v[64:79], v[48:51], v[188:191], v[64:79]
    ds_read_b64_tr_b16 v[32:33], v9 offset:0
    ds_read_b64_tr_b16 v[34:35], v9 offset:1024
    s_waitcnt lgkmcnt(6)
    v_mfma_f32_32x32x16_bf16 v[80:95], v[52:55], v[188:191], v[80:95]
    ds_read_b64_tr_b16 v[36:37], v9 offset:64
    ds_read_b64_tr_b16 v[38:39], v9 offset:1088
    s_waitcnt lgkmcnt(6)
    v_mfma_f32_32x32x16_bf16 v[96:111], v[56:59], v[188:191], v[96:111]
    ds_read_b64_tr_b16 v[40:41], v9 offset:128
    ds_read_b64_tr_b16 v[42:43], v9 offset:1152
    s_waitcnt lgkmcnt(6)
    v_mfma_f32_32x32x16_bf16 v[112:127], v[60:63], v[188:191], v[112:127]
    ds_read_b64_tr_b16 v[44:45], v9 offset:192
    ds_read_b64_tr_b16 v[46:47], v9 offset:1216
    s_waitcnt vmcnt(3)
    s_waitcnt lgkmcnt(6)
    v_mfma_f32_32x32x16_bf16 v[64:79], v[32:35], v[192:195], v[64:79]
    ds_read_b64_tr_b16 v[48:49], v9 offset:512
    ds_read_b64_tr_b16 v[50:51], v9 offset:1536
    s_waitcnt lgkmcnt(6)
    v_mfma_f32_32x32x16_bf16 v[80:95], v[36:39], v[192:195], v[80:95]
    ds_read_b64_tr_b16 v[52:53], v9 offset:576
    ds_read_b64_tr_b16 v[54:55], v9 offset:1600
    s_waitcnt lgkmcnt(6)
    v_mfma_f32_32x32x16_bf16 v[96:111], v[40:43], v[192:195], v[96:111]
    ds_read_b64_tr_b16 v[56:57], v9 offset:640
    ds_read_b64_tr_b16 v[58:59], v9 offset:1664
    s_waitcnt lgkmcnt(6)
    v_mfma_f32_32x32x16_bf16 v[112:127], v[44:47], v[192:195], v[112:127]
    ds_read_b64_tr_b16 v[60:61], v9 offset:704
    ds_read_b64_tr_b16 v[62:63], v9 offset:1728
    s_waitcnt vmcnt(2)
    s_waitcnt lgkmcnt(6)
    v_mfma_f32_32x32x16_bf16 v[64:79], v[48:51], v[196:199], v[64:79]
    ds_read_b64_tr_b16 v[32:33], v9 offset:2048
    ds_read_b64_tr_b16 v[34:35], v9 offset:3072
    s_waitcnt lgkmcnt(6)
    v_mfma_f32_32x32x16_bf16 v[80:95], v[52:55], v[196:199], v[80:95]
    ds_read_b64_tr_b16 v[36:37], v9 offset:2112
    ds_read_b64_tr_b16 v[38:39], v9 offset:3136
    s_waitcnt lgkmcnt(6)
    v_mfma_f32_32x32x16_bf16 v[96:111], v[56:59], v[196:199], v[96:111]
    ds_read_b64_tr_b16 v[40:41], v9 offset:2176
    ds_read_b64_tr_b16 v[42:43], v9 offset:3200
    s_waitcnt lgkmcnt(6)
    v_mfma_f32_32x32x16_bf16 v[112:127], v[60:63], v[196:199], v[112:127]
    ds_read_b64_tr_b16 v[44:45], v9 offset:2240
    ds_read_b64_tr_b16 v[46:47], v9 offset:3264
    s_waitcnt vmcnt(1)
    s_waitcnt lgkmcnt(6)
    v_mfma_f32_32x32x16_bf16 v[64:79], v[32:35], v[200:203], v[64:79]
    ds_read_b64_tr_b16 v[48:49], v9 offset:2560
    ds_read_b64_tr_b16 v[50:51], v9 offset:3584
    s_waitcnt lgkmcnt(6)
    v_mfma_f32_32x32x16_bf16 v[80:95], v[36:39], v[200:203], v[80:95]
    ds_read_b64_tr_b16 v[52:53], v9 offset:2624
    ds_read_b64_tr_b16 v[54:55], v9 offset:3648
    s_waitcnt lgkmcnt(6)
    v_mfma_f32_32x32x16_bf16 v[96:111], v[40:43], v[200:203], v[96:111]
    ds_read_b64_tr_b16 v[56:57], v9 offset:2688
    ds_read_b64_tr_b16 v[58:59], v9 offset:3712
    s_waitcnt lgkmcnt(6)
    v_mfma_f32_32x32x16_bf16 v[112:127], v[44:47], v[200:203], v[112:127]
    ds_read_b64_tr_b16 v[60:61], v9 offset:2752
    ds_read_b64_tr_b16 v[62:63], v9 offset:3776
    s_waitcnt vmcnt(0)
    s_waitcnt lgkmcnt(6)
    v_mfma_f32_32x32x16_bf16 v[64:79], v[48:51], v[204:207], v[64:79]
    s_waitcnt lgkmcnt(4)
    v_mfma_f32_32x32x16_bf16 v[80:95], v[52:55], v[204:207], v[80:95]
    s_waitcnt lgkmcnt(2)
    v_mfma_f32_32x32x16_bf16 v[96:111], v[56:59], v[204:207], v[96:111]
    s_waitcnt lgkmcnt(0)
    v_mfma_f32_32x32x16_bf16 v[112:127], v[60:63], v[204:207], v[112:127]
L_p1_epi:
    s_barrier
    ds_read_b64 v[16:17], v12
    ds_read_b128 v[128:131], v13 offset:0
    ds_read_b128 v[132:135], v13 offset:32
    ds_read_b128 v[136:139], v13 offset:64
    ds_read_b128 v[140:143], v13 offset:96
    ds_read_b128 v[48:51], v13 offset:128
    ds_read_b128 v[52:55], v13 offset:160
    ds_read_b128 v[56:59], v13 offset:192
    ds_read_b128 v[60:63], v13 offset:224
    ds_read_b128 v[32:35], v13 offset:256
    ds_read_b128 v[36:39], v13 offset:288
    ds_read_b128 v[40:43], v13 offset:320
    ds_read_b128 v[44:47], v13 offset:352
    s_lshr_b32 s29, s24, 5
    s_mul_i32 s24, s18, 480
    s_lshl_b32 s25, s28, 5
    s_add_u32 s24, s24, s25
    s_lshl_b32 s24, s24, 11
    s_waitcnt lgkmcnt(10)
    v_pk_fma_f32 v[64:65], v[128:129], v[16:17], v[64:65] op_sel_hi:[1,0,1]
    v_pk_fma_f32 v[66:67], v[130:131], v[16:17], v[66:67] op_sel_hi:[1,0,1]
    v_pk_fma_f32 v[68:69], v[132:133], v[16:17], v[68:69] op_sel_hi:[1,0,1]
    v_pk_fma_f32 v[70:71], v[134:135], v[16:17], v[70:71] op_sel_hi:[1,0,1]
    v_pk_mul_f32 v[64:65], v[64:65], v[16:17] op_sel:[0,1] op_sel_hi:[1,1]
    v_pk_mul_f32 v[66:67], v[66:67], v[16:17] op_sel:[0,1] op_sel_hi:[1,1]
    v_pk_mul_f32 v[68:69], v[68:69], v[16:17] op_sel:[0,1] op_sel_hi:[1,1]
    v_pk_mul_f32 v[70:71], v[70:71], v[16:17] op_sel:[0,1] op_sel_hi:[1,1]
    v_cvt_pk_bf16_f32 v64, v64, v65
    v_cvt_pk_bf16_f32 v65, v66, v67
    v_cvt_pk_bf16_f32 v66, v68, v69
    v_cvt_pk_bf16_f32 v67, v70, v71
    s_add_u32 s21, s24, 0
    v_permlane16_swap_b32 v64, v66
    v_permlane16_swap_b32 v65, v67
    buffer_store_dwordx4 v[64:67], v14, s[80:83], s21 offen sc1
    s_waitcnt lgkmcnt(8)
    v_pk_fma_f32 v[72:73], v[136:137], v[16:17], v[72:73] op_sel_hi:[1,0,1]
    v_pk_fma_f32 v[74:75], v[138:139], v[16:17], v[74:75] op_sel_hi:[1,0,1]
    v_pk_fma_f32 v[76:77], v[140:141], v[16:17], v[76:77] op_sel_hi:[1,0,1]
    v_pk_fma_f32 v[78:79], v[142:143], v[16:17], v[78:79] op_sel_hi:[1,0,1]
    v_pk_mul_f32 v[72:73], v[72:73], v[16:17] op_sel:[0,1] op_sel_hi:[1,1]
    v_pk_mul_f32 v[74:75], v[74:75], v[16:17] op_sel:[0,1] op_sel_hi:[1,1]
    v_pk_mul_f32 v[76:77], v[76:77], v[16:17] op_sel:[0,1] op_sel_hi:[1,1]
    v_pk_mul_f32 v[78:79], v[78:79], v[16:17] op_sel:[0,1] op_sel_hi:[1,1]
    v_cvt_pk_bf16_f32 v72, v72, v73
    v_cvt_pk_bf16_f32 v73, v74, v75
    v_cvt_pk_bf16_f32 v74, v76, v77
    v_cvt_pk_bf16_f32 v75, v78, v79
    s_add_u32 s21, s24, 8192
    v_permlane16_swap_b32 v72, v74
    v_permlane16_swap_b32 v73, v75
    buffer_store_dwordx4 v[72:75], v14, s[80:83], s21 offen sc1
    s_waitcnt lgkmcnt(6)
    v_pk_fma_f32 v[80:81], v[48:49], v[16:17], v[80:81] op_sel_hi:[1,0,1]
    v_pk_fma_f32 v[82:83], v[50:51], v[16:17], v[82:83] op_sel_hi:[1,0,1]
    v_pk_fma_f32 v[84:85], v[52:53], v[16:17], v[84:85] op_sel_hi:[1,0,1]
    v_pk_fma_f32 v[86:87], v[54:55], v[16:17], v[86:87] op_sel_hi:[1,0,1]
    v_pk_mul_f32 v[80:81], v[80:81], v[16:17] op_sel:[0,1] op_sel_hi:[1,1]
    v_pk_mul_f32 v[82:83], v[82:83], v[16:17] op_sel:[0,1] op_sel_hi:[1,1]
    v_pk_mul_f32 v[84:85], v[84:85], v[16:17] op_sel:[0,1] op_sel_hi:[1,1]
    v_pk_mul_f32 v[86:87], v[86:87], v[16:17] op_sel:[0,1] op_sel_hi:[1,1]
    v_cvt_pk_bf16_f32 v80, v80, v81
    v_cvt_pk_bf16_f32 v81, v82, v83
    v_cvt_pk_bf16_f32 v82, v84, v85
    v_cvt_pk_bf16_f32 v83, v86, v87
    s_add_u32 s21, s24, 16384
    v_permlane16_swap_b32 v80, v82
    v_permlane16_swap_b32 v81, v83
    buffer_store_dwordx4 v[80:83], v14, s[80:83], s21 offen sc1
    s_waitcnt lgkmcnt(4)
    v_pk_fma_f32 v[88:89], v[56:57], v[16:17], v[88:89] op_sel_hi:[1,0,1]
    v_pk_fma_f32 v[90:91], v[58:59], v[16:17], v[90:91] op_sel_hi:[1,0,1]
    v_pk_fma_f32 v[92:93], v[60:61], v[16:17], v[92:93] op_sel_hi:[1,0,1]
    v_pk_fma_f32 v[94:95], v[62:63], v[16:17], v[94:95] op_sel_hi:[1,0,1]
    v_pk_mul_f32 v[88:89], v[88:89], v[16:17] op_sel:[0,1] op_sel_hi:[1,1]
    v_pk_mul_f32 v[90:91], v[90:91], v[16:17] op_sel:[0,1] op_sel_hi:[1,1]
    v_pk_mul_f32 v[92:93], v[92:93], v[16:17] op_sel:[0,1] op_sel_hi:[1,1]
    v_pk_mul_f32 v[94:95], v[94:95], v[16:17] op_sel:[0,1] op_sel_hi:[1,1]
    v_cvt_pk_bf16_f32 v88, v88, v89
    v_cvt_pk_bf16_f32 v89, v90, v91
    v_cvt_pk_bf16_f32 v90, v92, v93
    v_cvt_pk_bf16_f32 v91, v94, v95
    s_add_u32 s21, s24, 24576
    v_permlane16_swap_b32 v88, v90
    v_permlane16_swap_b32 v89, v91
    buffer_store_dwordx4 v[88:91], v14, s[80:83], s21 offen sc1
    ds_read_b128 v[48:51], v13 offset:384
    ds_read_b128 v[52:55], v13 offset:416
    ds_read_b128 v[56:59], v13 offset:448
    ds_read_b128 v[60:63], v13 offset:480
    s_waitcnt lgkmcnt(6)
    v_pk_fma_f32 v[96:97], v[32:33], v[16:17], v[96:97] op_sel_hi:[1,0,1]
    v_pk_fma_f32 v[98:99], v[34:35], v[16:17], v[98:99] op_sel_hi:[1,0,1]
    v_pk_fma_f32 v[100:101], v[36:37], v[16:17], v[100:101] op_sel_hi:[1,0,1]
    v_pk_fma_f32 v[102:103], v[38:39], v[16:17], v[102:103] op_sel_hi:[1,0,1]
    v_pk_mul_f32 v[96:97], v[96:97], v[16:17] op_sel:[0,1] op_sel_hi:[1,1]
    v_pk_mul_f32 v[98:99], v[98:99], v[16:17] op_sel:[0,1] op_sel_hi:[1,1]
    v_pk_mul_f32 v[100:101], v[100:101], v[16:17] op_sel:[0,1] op_sel_hi:[1,1]
    v_pk_mul_f32 v[102:103], v[102:103], v[16:17] op_sel:[0,1] op_sel_hi:[1,1]
    v_cvt_pk_bf16_f32 v96, v96, v97
    v_cvt_pk_bf16_f32 v97, v98, v99
    v_cvt_pk_bf16_f32 v98, v100, v101
    v_cvt_pk_bf16_f32 v99, v102, v103
    s_add_u32 s21, s24, 32768
    v_permlane16_swap_b32 v96, v98
    v_permlane16_swap_b32 v97, v99
    buffer_store_dwordx4 v[96:99], v14, s[80:83], s21 offen sc1
    s_waitcnt lgkmcnt(4)
    v_pk_fma_f32 v[104:105], v[40:41], v[16:17], v[104:105] op_sel_hi:[1,0,1]
    v_pk_fma_f32 v[106:107], v[42:43], v[16:17], v[106:107] op_sel_hi:[1,0,1]
    v_pk_fma_f32 v[108:109], v[44:45], v[16:17], v[108:109] op_sel_hi:[1,0,1]
    v_pk_fma_f32 v[110:111], v[46:47], v[16:17], v[110:111] op_sel_hi:[1,0,1]
    v_pk_mul_f32 v[104:105], v[104:105], v[16:17] op_sel:[0,1] op_sel_hi:[1,1]
    v_pk_mul_f32 v[106:107], v[106:107], v[16:17] op_sel:[0,1] op_sel_hi:[1,1]
    v_pk_mul_f32 v[108:109], v[108:109], v[16:17] op_sel:[0,1] op_sel_hi:[1,1]
    v_pk_mul_f32 v[110:111], v[110:111], v[16:17] op_sel:[0,1] op_sel_hi:[1,1]
    v_cvt_pk_bf16_f32 v104, v104, v105
    v_cvt_pk_bf16_f32 v105, v106, v107
    v_cvt_pk_bf16_f32 v106, v108, v109
    v_cvt_pk_bf16_f32 v107, v110, v111
    s_add_u32 s21, s24, 40960
    v_permlane16_swap_b32 v104, v106
    v_permlane16_swap_b32 v105, v107
    buffer_store_dwordx4 v[104:107], v14, s[80:83], s21 offen sc1
    s_waitcnt lgkmcnt(2)
    v_pk_fma_f32 v[112:113], v[48:49], v[16:17], v[112:113] op_sel_hi:[1,0,1]
    v_pk_fma_f32 v[114:115], v[50:51], v[16:17], v[114:115] op_sel_hi:[1,0,1]
    v_pk_fma_f32 v[116:117], v[52:53], v[16:17], v[116:117] op_sel_hi:[1,0,1]
    v_pk_fma_f32 v[118:119], v[54:55], v[16:17], v[118:119] op_sel_hi:[1,0,1]
    v_pk_mul_f32 v[112:113], v[112:113], v[16:17] op_sel:[0,1] op_sel_hi:[1,1]
    v_pk_mul_f32 v[114:115], v[114:115], v[16:17] op_sel:[0,1] op_sel_hi:[1,1]
    v_pk_mul_f32 v[116:117], v[116:117], v[16:17] op_sel:[0,1] op_sel_hi:[1,1]
    v_pk_mul_f32 v[118:119], v[118:119], v[16:17] op_sel:[0,1] op_sel_hi:[1,1]
    v_cvt_pk_bf16_f32 v112, v112, v113
    v_cvt_pk_bf16_f32 v113, v114, v115
    v_cvt_pk_bf16_f32 v114, v116, v117
    v_cvt_pk_bf16_f32 v115, v118, v119
    s_add_u32 s21, s24, 49152
    v_permlane16_swap_b32 v112, v114
    v_permlane16_swap_b32 v113, v115
    buffer_store_dwordx4 v[112:115], v14, s[80:83], s21 offen sc1
    s_waitcnt lgkmcnt(0)
    v_pk_fma_f32 v[120:121], v[56:57], v[16:17], v[120:121] op_sel_hi:[1,0,1]
    v_pk_fma_f32 v[122:123], v[58:59], v[16:17], v[122:123] op_sel_hi:[1,0,1]
    v_pk_fma_f32 v[124:125], v[60:61], v[16:17], v[124:125] op_sel_hi:[1,0,1]
    v_pk_fma_f32 v[126:127], v[62:63], v[16:17], v[126:127] op_sel_hi:[1,0,1]
    v_pk_mul_f32 v[120:121], v[120:121], v[16:17] op_sel:[0,1] op_sel_hi:[1,1]
    v_pk_mul_f32 v[122:123], v[122:123], v[16:17] op_sel:[0,1] op_sel_hi:[1,1]
    v_pk_mul_f32 v[124:125], v[124:125], v[16:17] op_sel:[0,1] op_sel_hi:[1,1]
    v_pk_mul_f32 v[126:127], v[126:127], v[16:17] op_sel:[0,1] op_sel_hi:[1,1]
    v_cvt_pk_bf16_f32 v120, v120, v121
    v_cvt_pk_bf16_f32 v121, v122, v123
    v_cvt_pk_bf16_f32 v122, v124, v125
    v_cvt_pk_bf16_f32 v123, v126, v127
    s_add_u32 s21, s24, 57344
    v_permlane16_swap_b32 v120, v122
    v_permlane16_swap_b32 v121, v123
    buffer_store_dwordx4 v[120:123], v14, s[80:83], s21 offen sc1
    v_mov_b32 v20, 162816
    ds_read_b32 v20, v20
    s_waitcnt lgkmcnt(0)
    v_readfirstlane_b32 s17, v20
    s_lshl_b32 s21, s16, 3
    s_add_u32 s21, s21, s18
    s_lshl_b32 s21, s21, 5
    s_add_u32 s21, s21, s19
    s_lshl_b32 s21, s21, 7
    s_add_u32 s21, s21, s20
    s_add_u32 s21, s21, 0x10000
    v_mov_b32 v20, s21
    v_mov_b32 v21, 1
    s_waitcnt vmcnt(0)
    s_mov_b64 exec, 1
    buffer_store_byte v21, v20, s[72:75], 0 offen sc1
    s_mov_b64 exec, -1
    s_lshl_b32 s21, s16, 3
    s_add_u32 s21, s21, 4
    s_lshl_b32 s21, s21, 3
    s_add_u32 s21, s21, s18
    s_lshl_b32 s21, s21, 3
    s_add_u32 s21, s21, s29
    s_lshl_b32 s21, s21, 5
    s_add_u32 s21, s21, s28
    v_mov_b32 v22, s21
    v_mov_b32 v23, 1
    s_mov_b64 exec, 1
    s_cmp_eq_u32 s17, 0
    s_cbranch_scc1 L_sigslow_14
    buffer_store_byte v23, v22, s[72:75], 0 offen
    s_branch L_sigdone_15
L_sigslow_14:
    buffer_store_byte v23, v22, s[72:75], 0 offen sc1
L_sigdone_15:
    s_mov_b64 exec, -1
L_p1_done:
    s_mul_i32 s25, s19, 5
    v_lshlrev_b32 v4, 4, v1
    s_add_u32 s8, s6, 0x1000000
    s_addc_u32 s9, s7, 0
    s_mov_b32 s10, 0x780000
    s_mov_b32 s11, 0x20000
    s_lshl_b32 s24, s20, 5
    v_and_b32 v18, 15, v1
    v_bfe_u32 v19, v1, 4, 1
    v_lshlrev_b32 v8, 4, v18
    v_lshl_add_u32 v8, v19, 3, v8
    s_lshl_b32 s21, s20, 8
    v_add_u32 v8, s21, v8
    v_lshl_add_u32 v7, v3, 12, v8
    v_add_u32 v6, 24576, v8
    v_lshl_add_u32 v5, v3, 11, v6
    s_add_u32 s12, s6, 0x600000
    s_addc_u32 s13, s7, 0
    s_mov_b32 s14, 0x300000
    s_mov_b32 s15, 0x20000
    v_mov_b32 v16, 0x3f803f80
    v_mov_b32 v17, 0x3f803f80
    v_lshlrev_b32 v15, 3, v0
    v_add_u32 v14, 51200, v15
    ds_write_b64 v14, v[16:17] offset:20800
    s_lshr_b32 s22, s20, 2
    s_add_u32 s22, s22, s18
    s_cmp_eq_u32 s22, 0
    s_cselect_b32 s22, 0xf149, 0
    v_mov_b32 v20, s22
    v_mov_b32 v21, 0
    ds_write_b64 v15, v[20:21] offset:20480
    v_and_b32 v14, 3, v1
    v_lshl_add_u32 v15, v19, 2, v14
    v_min_u32 v15, 5, v15
    v_mul_u32_u24 v9, 4160, v15
    v_bfe_u32 v15, v1, 2, 2
    v_lshl_add_u32 v15, v3, 2, v15
    v_lshl_add_u32 v9, v15, 4, v9
    v_add_u32 v9, s21, v9
    v_add_u32 v9, 51200, v9
    s_lshl_b32 s21, s18, 4
    s_lshl_b32 s22, s20, 1
    s_add_u32 s21, s21, s22
    v_add_u32 v15, s21, v19
    v_mul_u32_u24 v15, 20480, v15
    v_lshl_add_u32 v15, v18, 4, v15
    s_lshl_b32 s21, s19, 9
    v_add_u32 v10, s21, v15
    v_lshl_add_u32 v10, v3, 8, v10
    s_lshr_b32 s21, s19, 1
    s_lshl_b32 s21, s21, 8
    s_and_b32 s22, s19, 1
    s_lshl_b32 s22, s22, 3
    s_add_u32 s21, s21, s22
    s_add_u32 s21, s21, 16384
    s_lshl_b32 s21, s18, 3
    s_add_u32 s21, s21, s20
    s_lshl_b32 s21, s21, 5
    s_add_u32 s21, s21, s19
    s_lshl_b32 s21, s21, 8
    s_add_u32 s21, s21, 2621440
    v_lshlrev_b32 v15, 3, v2
    v_add_u32 v11, s21, v15
    v_lshl_add_u32 v11, v3, 31, v11
    s_mul_i32 s28, s19, 171
    s_lshr_b32 s28, s28, 9
    s_and_b32 s26, s20, 3
    s_lshr_b32 s27, s20, 2
    v_bfe_u32 v14, v1, 3, 1
    v_mul_u32_u24 v15, 5, v19
    v_add_u32 v14, v14, v15
    v_lshl_add_u32 v14, v3, 1, v14
    s_mul_i32 s21, s27, 10
    v_add_u32 v14, s21, v14
    v_bfe_u32 v15, v1, 3, 2
    v_mul_u32_u24 v15, 10, v15
    v_mul_u32_u24 v16, 5, v3
    v_add_u32 v15, v15, v16
    s_mul_i32 s21, s27, 40
    s_add_u32 s21, s21, 4
    v_add_u32 v15, s21, v15
    v_and_b32 v16, 7, v1
    v_lshlrev_b32 v16, 4, v16
    s_mul_i32 s21, s26, 1280
    s_lshl_b32 s22, s28, 7
    s_add_u32 s21, s21, s22
    s_cmp_ge_u32 s19, 30
    s_cselect_b32 s21, 0x80000000, s21
    v_add_u32 v16, s21, v16
    v_mul_u32_u24 v12, 5120, v14
    v_add_u32 v12, v12, v16
    v_mul_u32_u24 v13, 5120, v15
    v_add_u32 v13, v13, v16
    s_mul_i32 s32, s26, 2112
    s_lshl_b32 s21, s27, 10
    s_add_u32 s32, s32, s21
    s_add_u32 s32, s32, 76288
    s_add_u32 s34, s32, 84480
    s_mov_b32 s21, 8
    s_sub_u32 s21, 10, s21
    s_cmp_eq_u32 s21, 10
    s_cselect_b32 s21, 0, s21
    s_mul_i32 s21, s21, 8448
    s_add_u32 s29, s32, s21
    s_add_u32 s36, s88, 0x0
    s_addc_u32 s37, s89, 0
    s_mov_b32 s38, 0xc8000
    s_mov_b32 s39, 0x20000
    s_lshl_b32 s25, s19, 7
    s_cmp_ge_u32 s19, 27
    s_cselect_b32 s25, 0x80000000, s25
    v_lshrrev_b32 v14, 3, v1
    v_lshlrev_b32 v14, 2, v14
    v_add_u32 v14, s26, v14
    v_mul_u32_u24 v14, 3456, v14
    v_and_b32 v15, 7, v1
    v_lshl_add_u32 v14, v15, 4, v14
    v_add_u32 v252, s25, v14
    v_add_u32 v253, 110592, v252
    s_mul_i32 s21, s18, 10
    s_lshr_b32 s21, s21, 3
    s_lshl_b32 s30, s21, 11
    s_mul_i32 s31, s21, 221184
    s_cmp_eq_u32 s27, 0
    s_cselect_b32 s22, s92, s94
    s_cselect_b32 s23, s93, s95
    s_add_u32 s76, s22, 0x0
    s_addc_u32 s77, s23, 0
    s_mov_b32 s78, 0x21c000
    s_mov_b32 s79, 0x20000
    s_mul_i32 s30, s26, 2112
    s_mul_i32 s21, s27, 8480
    s_add_u32 s30, s30, s21
    s_mov_b32 s40, 0xffffffff
    s_mov_b32 s41, 0xfffffff0
    s_mov_b32 s42, 0xfffffffe
    s_mov_b32 s43, 0xffffffe0
    s_mov_b32 s44, 0xfffffffc
    s_mov_b32 s45, 0xffffffc0
    s_mov_b32 s46, 0xfffffff8
    s_mov_b32 s47, 0xffffff80
    s_mov_b32 s48, 0xffffff00
    s_mov_b32 s49, 0xfffff000
    s_mov_b32 s50, 0xfffffe00
    s_mov_b32 s51, 0xffffe000
    s_mov_b32 s52, 0xfffffc00
    s_mov_b32 s53, 0xffffc000
    s_mov_b32 s54, 0xfffff800
    s_mov_b32 s55, 0xffff8000
    s_mov_b32 s56, 0xffff0000
    s_mov_b32 s57, 0xfff00000
    s_mov_b32 s58, 0xfffe0000
    s_mov_b32 s59, 0xffe00000
    s_mov_b32 s60, 0xfffc0000
    s_mov_b32 s61, 0xffc00000
    s_mov_b32 s62, 0xfff80000
    s_mov_b32 s63, 0xff800000
    s_mov_b32 s64, 0xff000000
    s_mov_b32 s65, 0xf0000000
    s_mov_b32 s66, 0xfe000000
    s_mov_b32 s67, 0xe0000000
    s_mov_b32 s68, 0xfc000000
    s_mov_b32 s69, 0xc0000000
    s_mov_b32 s70, 0xf8000000
    s_mov_b32 s71, 0x80000000
    v_mov_b32 v18, 0xffff
    v_mov_b32 v19, 0xffff0000
    v_cndmask_b32 v26, 0, v18, s[40:41]
    v_cndmask_b32 v15, 0, v19, s[42:43]
    v_or_b32 v26, v26, v15
    v_cndmask_b32 v27, 0, v18, s[44:45]
    v_cndmask_b32 v15, 0, v19, s[46:47]
    v_or_b32 v27, v27, v15
    v_cndmask_b32 v28, 0, v18, s[48:49]
    v_cndmask_b32 v15, 0, v19, s[50:51]
    v_or_b32 v28, v28, v15
    v_cndmask_b32 v29, 0, v18, s[52:53]
    v_cndmask_b32 v15, 0, v19, s[54:55]
    v_or_b32 v29, v29, v15
    v_cndmask_b32 v30, 0, v18, s[56:57]
    v_cndmask_b32 v15, 0, v19, s[58:59]
    v_or_b32 v30, v30, v15
    v_cndmask_b32 v31, 0, v18, s[60:61]
    v_cndmask_b32 v15, 0, v19, s[62:63]
    v_or_b32 v31, v31, v15
    v_cndmask_b32 v32, 0, v18, s[64:65]
    v_cndmask_b32 v15, 0, v19, s[66:67]
    v_or_b32 v32, v32, v15
    v_cndmask_b32 v33, 0, v18, s[68:69]
    v_cndmask_b32 v15, 0, v19, s[70:71]
    v_or_b32 v33, v33, v15
    s_sub_u32 s21, s20, 4
    s_cmp_ge_u32 s21, 3
    s_cbranch_scc1 L_p2_setup
    s_mul_i32 s25, s19, 5
    s_mul_i32 s80, s18, 480
    s_add_u32 s80, s80, s25
    s_lshl_b32 s80, s80, 11
    s_add_u32 s81, s80, 655360
    s_cmp_eq_u32 s20, 6
    s_cbranch_scc1 L_p2_halo
    s_cmp_eq_u32 s20, 4
    s_cselect_b32 s22, 0, 327680
    s_cselect_b32 s82, 24576, 0
    s_cselect_b32 s83, 0, 1
    s_add_u32 s80, s80, s22
    s_lshl_b32 s83, s83, 11
    s_add_u32 s82, s82, s83
    s_add_u32 s83, s83, 2048
    s_mov_b32 s33, 53248
    v_and_b32 v35, 7, v1
    v_lshlrev_b32 v36, 5, v35
    v_mov_b32 v34, 0
    v_cmp_eq_u32 vcc, 3, v35
    v_mov_b32 v36, 0x10101
    s_nop 0
    v_cndmask_b32 v34, v34, v36, vcc
    v_subrev_u32 v36, 0, v35
    v_cmp_gt_u32 vcc, 3, v36
    v_mov_b32 v36, 0x01010101
    s_nop 0
    v_cndmask_b32 v34, v34, v36, vcc
    v_lshlrev_b32 v35, 2, v1
    s_add_u32 s21, s16, 0x0
    s_lshl_b32 s21, s21, 3
    s_add_u32 s21, s21, 4
    s_lshl_b32 s21, s21, 3
    s_add_u32 s21, s21, s18
    s_lshl_b32 s21, s21, 3
    s_lshl_b32 s21, s21, 5
    s_mov_b32 s35, 0
L_wl_16:
    buffer_load_dword v36, v35, s[72:75], s21 offen sc1
    s_waitcnt vmcnt(0)
    v_and_b32 v36, v36, v34
    v_cmp_ne_u32 vcc, v36, v34
    s_add_u32 s35, s35, 1
    s_cmp_gt_u32 s35, 65536
    s_cbranch_scc1 L_wlx_17
    s_cbranch_vccz L_wlx_17
    s_sleep 1
    s_branch L_wl_16
L_wlx_17:
    s_cmp_lg_u32 s17, 0
    s_cbranch_scc1 L_acq_18
    buffer_inv sc1
    s_waitcnt vmcnt(0)
L_acq_18:
    s_branch L_p2_ld
L_p2_halo:
    s_sub_u32 s80, s80, 655360
    s_sub_u32 s81, s81, 983040
    s_mov_b32 s82, 0
    s_mov_b32 s83, 4096
    s_mov_b32 s33, 51200
    s_cmp_eq_u32 s18, 0
    s_cselect_b32 s80, 0x80000000, s80
    s_cselect_b32 s81, 0x80000000, s81
    s_cbranch_scc1 L_p2_ld
    v_min_u32 v34, 19, v1
    v_lshlrev_b32 v34, 7, v34
    s_lshl_b32 s21, s16, 3
    s_add_u32 s21, s21, s18
    s_lshl_b32 s21, s21, 12
    s_add_u32 s21, s21, 62720
    v_add_u32 v34, s21, v34
    v_mov_b32 v35, 0x01010101
    s_mov_b32 s35, 0
    s_nop 0
L_p1w_19:
    buffer_load_dword v36, v34, s[72:75], 0 offen sc1
    s_waitcnt vmcnt(0)
    v_cmp_ne_u32 vcc, v36, v35
    s_add_u32 s35, s35, 1
    s_cmp_gt_u32 s35, 65536
    s_cbranch_scc1 L_p1wx_20
    s_cbranch_vccz L_p1wx_20
    s_sleep 1
    s_branch L_p1w_19
L_p1wx_20:
L_p2_ld:
    s_add_u32 m0, s82, 0
    s_nop 0
    buffer_load_dwordx4 v4, s[8:11], s80 offen sc1 lds
    s_add_u32 s80, s80, 1024
    s_add_u32 m0, s82, 1024
    s_nop 0
    buffer_load_dwordx4 v4, s[8:11], s80 offen sc1 lds
    s_add_u32 s80, s80, 1024
    s_add_u32 s82, s82, s83
    s_add_u32 m0, s82, 0
    s_nop 0
    buffer_load_dwordx4 v4, s[8:11], s80 offen sc1 lds
    s_add_u32 s80, s80, 1024
    s_add_u32 m0, s82, 1024
    s_nop 0
    buffer_load_dwordx4 v4, s[8:11], s80 offen sc1 lds
    s_add_u32 s80, s80, 1024
    s_add_u32 s82, s82, s83
    s_add_u32 m0, s82, 0
    s_nop 0
    buffer_load_dwordx4 v4, s[8:11], s80 offen sc1 lds
    s_add_u32 s80, s80, 1024
    s_add_u32 m0, s82, 1024
    s_nop 0
    buffer_load_dwordx4 v4, s[8:11], s80 offen sc1 lds
    s_add_u32 s80, s80, 1024
    s_add_u32 s82, s82, s83
    s_add_u32 m0, s82, 0
    s_nop 0
    buffer_load_dwordx4 v4, s[8:11], s80 offen sc1 lds
    s_add_u32 s80, s80, 1024
    s_add_u32 m0, s82, 1024
    s_nop 0
    buffer_load_dwordx4 v4, s[8:11], s80 offen sc1 lds
    s_add_u32 s80, s80, 1024
    s_add_u32 s82, s82, s83
    s_add_u32 m0, s82, 0
    s_nop 0
    buffer_load_dwordx4 v4, s[8:11], s80 offen sc1 lds
    s_add_u32 s80, s80, 1024
    s_add_u32 m0, s82, 1024
    s_nop 0
    buffer_load_dwordx4 v4, s[8:11], s80 offen sc1 lds
    s_add_u32 s80, s80, 1024
    s_add_u32 s82, s82, s83
    s_cmp_eq_u32 s20, 5
    s_cbranch_scc1 L_p2_w5
    s_add_u32 m0, s33, 0
    s_nop 0
    buffer_load_dwordx4 v4, s[8:11], s81 offen sc1 lds
    s_add_u32 s81, s81, 1024
    s_add_u32 m0, s33, 1024
    s_nop 0
    buffer_load_dwordx4 v4, s[8:11], s81 offen sc1 lds
    s_add_u32 s81, s81, 1024
    s_add_u32 m0, s33, 4160
    s_nop 0
    buffer_load_dwordx4 v4, s[8:11], s81 offen sc1 lds
    s_add_u32 s81, s81, 1024
    s_add_u32 m0, s33, 5184
    s_nop 0
    buffer_load_dwordx4 v4, s[8:11], s81 offen sc1 lds
    s_add_u32 s81, s81, 1024
    s_add_u32 m0, s33, 8320
    s_nop 0
    buffer_load_dwordx4 v4, s[8:11], s81 offen sc1 lds
    s_add_u32 s81, s81, 1024
    s_add_u32 m0, s33, 9344
    s_nop 0
    buffer_load_dwordx4 v4, s[8:11], s81 offen sc1 lds
    s_add_u32 s81, s81, 1024
    s_add_u32 m0, s33, 12480
    s_nop 0
    buffer_load_dwordx4 v4, s[8:11], s81 offen sc1 lds
    s_add_u32 s81, s81, 1024
    s_add_u32 m0, s33, 13504
    s_nop 0
    buffer_load_dwordx4 v4, s[8:11], s81 offen sc1 lds
    s_add_u32 s81, s81, 1024
    s_add_u32 m0, s33, 16640
    s_nop 0
    buffer_load_dwordx4 v4, s[8:11], s81 offen sc1 lds
    s_add_u32 s81, s81, 1024
    s_add_u32 m0, s33, 17664
    s_nop 0
    buffer_load_dwordx4 v4, s[8:11], s81 offen sc1 lds
    s_add_u32 s81, s81, 1024
    s_branch L_p2_setup
L_p2_w5:
    s_waitcnt vmcnt(0)
L_p2_setup:
    s_waitcnt vmcnt(10)
    s_waitcnt lgkmcnt(0)
    s_barrier
    ds_read_b64 v[20:21], v5
    ds_read_b64 v[22:23], v5 offset:4096
    ds_read_b64 v[24:25], v6 offset:8192
    ds_read_b64 v[34:35], v7 offset:0
    ds_read_b64 v[36:37], v7 offset:8192
    ds_read_b64 v[38:39], v7 offset:16384
    ds_read_b64 v[40:41], v7 offset:2048
    ds_read_b64 v[42:43], v7 offset:10240
    ds_read_b64 v[44:45], v7 offset:18432
    ds_read_b64 v[46:47], v7 offset:256
    ds_read_b64 v[48:49], v7 offset:8448
    ds_read_b64 v[50:51], v7 offset:16640
    s_waitcnt lgkmcnt(6)
    s_mov_b32 s22, -1
    s_mov_b32 s23, 0
    v_mov_b32 v246, 0x3f80
    v_cndmask_b32 v24, v246, v24, s[22:23]
    v_cndmask_b32 v25, 0, v25, s[22:23]
    v_mfma_f32_32x32x16_bf16 v[100:115], v[34:37], v[20:23], 0
    s_nop 0
    v_mfma_f32_32x32x8_bf16 v[100:115], v[38:39], v[24:25], v[100:115]
    ds_read_b64 v[34:35], v7 offset:512
    ds_read_b64 v[36:37], v7 offset:8704
    ds_read_b64 v[38:39], v7 offset:16896
    s_waitcnt lgkmcnt(6)
    v_mfma_f32_32x32x16_bf16 v[228:243], v[40:43], v[20:23], 0
    v_mfma_f32_32x32x8_bf16 v[228:243], v[44:45], v[24:25], v[228:243]
    ds_read_b64 v[40:41], v7 offset:768
    ds_read_b64 v[42:43], v7 offset:8960
    ds_read_b64 v[44:45], v7 offset:17152
    s_waitcnt lgkmcnt(6)
    v_mfma_f32_32x32x16_bf16 v[116:131], v[46:49], v[20:23], 0
    v_mfma_f32_32x32x8_bf16 v[116:131], v[50:51], v[24:25], v[116:131]
    ds_read_b64 v[46:47], v7 offset:1024
    ds_read_b64 v[48:49], v7 offset:9216
    ds_read_b64 v[50:51], v7 offset:17408
    s_waitcnt lgkmcnt(6)
    v_mfma_f32_32x32x16_bf16 v[132:147], v[34:37], v[20:23], 0
    s_nop 0
    v_cndmask_b32 v100, v100, v228, s[40:41]
    v_cndmask_b32 v101, v101, v229, s[42:43]
    v_cndmask_b32 v102, v102, v230, s[44:45]
    v_cndmask_b32 v103, v103, v231, s[46:47]
    v_cndmask_b32 v104, v104, v232, s[48:49]
    v_cndmask_b32 v105, v105, v233, s[50:51]
    v_mfma_f32_32x32x8_bf16 v[132:147], v[38:39], v[24:25], v[132:147]
    v_cndmask_b32 v106, v106, v234, s[52:53]
    v_cndmask_b32 v107, v107, v235, s[54:55]
    v_cndmask_b32 v108, v108, v236, s[56:57]
    v_cndmask_b32 v109, v109, v237, s[58:59]
    v_cndmask_b32 v110, v110, v238, s[60:61]
    v_cndmask_b32 v111, v111, v239, s[62:63]
    ds_read_b64 v[34:35], v7 offset:1280
    ds_read_b64 v[36:37], v7 offset:9472
    ds_read_b64 v[38:39], v7 offset:17664
    s_waitcnt lgkmcnt(6)
    v_mfma_f32_32x32x16_bf16 v[148:163], v[40:43], v[20:23], 0
    v_cndmask_b32 v112, v112, v240, s[64:65]
    v_cndmask_b32 v113, v113, v241, s[66:67]
    v_cndmask_b32 v114, v114, v242, s[68:69]
    v_cndmask_b32 v115, v115, v243, s[70:71]
    v_max_f32 v244, v100, v101
    v_max_f32 v245, v102, v103
    v_mfma_f32_32x32x8_bf16 v[148:163], v[44:45], v[24:25], v[148:163]
    v_max3_f32 v244, v244, v104, v105
    v_max3_f32 v245, v245, v106, v107
    v_max3_f32 v244, v244, v108, v109
    v_max3_f32 v245, v245, v110, v111
    v_max3_f32 v244, v244, v112, v113
    v_max3_f32 v245, v245, v114, v115
    ds_read_b64 v[40:41], v7 offset:1536
    ds_read_b64 v[42:43], v7 offset:9728
    ds_read_b64 v[44:45], v7 offset:17920
    s_waitcnt lgkmcnt(6)
    v_mfma_f32_32x32x16_bf16 v[164:179], v[46:49], v[20:23], 0
    v_max3_f32 v244, v244, v116, v117
    v_max3_f32 v245, v245, v118, v119
    v_max3_f32 v244, v244, v120, v121
    v_max3_f32 v245, v245, v122, v123
    v_max3_f32 v244, v244, v124, v125
    v_max3_f32 v245, v245, v126, v127
    v_mfma_f32_32x32x8_bf16 v[164:179], v[50:51], v[24:25], v[164:179]
    v_max3_f32 v244, v244, v128, v129
    v_max3_f32 v245, v245, v130, v131
    v_max3_f32 v244, v244, v132, v133
    v_max3_f32 v245, v245, v134, v135
    v_max3_f32 v244, v244, v136, v137
    v_max3_f32 v245, v245, v138, v139
    ds_read_b64 v[46:47], v7 offset:1792
    ds_read_b64 v[48:49], v7 offset:9984
    ds_read_b64 v[50:51], v7 offset:18176
    s_waitcnt lgkmcnt(6)
    v_mfma_f32_32x32x16_bf16 v[180:195], v[34:37], v[20:23], 0
    v_max3_f32 v244, v244, v140, v141
    v_max3_f32 v245, v245, v142, v143
    v_max3_f32 v244, v244, v144, v145
    v_max3_f32 v245, v245, v146, v147
    v_max3_f32 v244, v244, v148, v149
    v_max3_f32 v245, v245, v150, v151
    v_mfma_f32_32x32x8_bf16 v[180:195], v[38:39], v[24:25], v[180:195]
    v_max3_f32 v244, v244, v152, v153
    v_max3_f32 v245, v245, v154, v155
    v_max3_f32 v244, v244, v156, v157
    v_max3_f32 v245, v245, v158, v159
    v_max3_f32 v244, v244, v160, v161
    v_max3_f32 v245, v245, v162, v163
    s_waitcnt lgkmcnt(3)
    v_mfma_f32_32x32x16_bf16 v[196:211], v[40:43], v[20:23], 0
    v_max3_f32 v244, v244, v164, v165
    v_max3_f32 v245, v245, v166, v167
    v_max3_f32 v244, v244, v168, v169
    v_max3_f32 v245, v245, v170, v171
    v_max3_f32 v244, v244, v172, v173
    v_max3_f32 v245, v245, v174, v175
    v_mfma_f32_32x32x8_bf16 v[196:211], v[44:45], v[24:25], v[196:211]
    v_max3_f32 v244, v244, v176, v177
    v_max3_f32 v245, v245, v178, v179
    s_waitcnt lgkmcnt(0)
    v_mfma_f32_32x32x16_bf16 v[212:227], v[46:49], v[20:23], 0
    v_max3_f32 v244, v244, v180, v181
    v_max3_f32 v245, v245, v182, v183
    v_max3_f32 v244, v244, v184, v185
    v_max3_f32 v245, v245, v186, v187
    v_max3_f32 v244, v244, v188, v189
    v_max3_f32 v245, v245, v190, v191
    v_mfma_f32_32x32x8_bf16 v[212:227], v[50:51], v[24:25], v[212:227]
    v_max3_f32 v244, v244, v192, v193
    v_max3_f32 v245, v245, v194, v195
    v_max3_f32 v244, v244, v196, v197
    v_max3_f32 v245, v245, v198, v199
    v_max3_f32 v244, v244, v200, v201
    v_max3_f32 v245, v245, v202, v203
    v_max3_f32 v244, v244, v204, v205
    v_max3_f32 v245, v245, v206, v207
    v_max3_f32 v244, v244, v208, v209
    v_max3_f32 v245, v245, v210, v211
    s_nop 1
    v_max3_f32 v244, v244, v212, v213
    v_max3_f32 v245, v245, v214, v215
    v_max3_f32 v244, v244, v216, v217
    v_max3_f32 v245, v245, v218, v219
    v_max3_f32 v244, v244, v220, v221
    v_max3_f32 v245, v245, v222, v223
    v_max3_f32 v244, v244, v224, v225
    v_max3_f32 v245, v245, v226, v227
    v_max_f32 v244, v244, v245
    v_mov_b32 v245, v244
    s_nop 1
    v_permlane32_swap_b32 v244, v245
    v_max_f32 v244, v244, v245
    s_waitcnt vmcnt(0)
    s_barrier
    ds_read_b64_tr_b16 v[52:53], v9 offset:0
    ds_read_b64_tr_b16 v[54:55], v9 offset:128
    ds_read_b64_tr_b16 v[56:57], v9 offset:8
    ds_read_b64_tr_b16 v[58:59], v9 offset:136
    ds_read_b64_tr_b16 v[60:61], v9 offset:2048
    ds_read_b64_tr_b16 v[62:63], v9 offset:2176
    ds_read_b64_tr_b16 v[64:65], v9 offset:2056
    ds_read_b64_tr_b16 v[66:67], v9 offset:2184
    v_pk_add_f32 v[100:101], v[100:101], v[244:245] op_sel_hi:[1,0] neg_lo:[0,1] neg_hi:[0,1]
    v_pk_add_f32 v[102:103], v[102:103], v[244:245] op_sel_hi:[1,0] neg_lo:[0,1] neg_hi:[0,1]
    v_pk_add_f32 v[104:105], v[104:105], v[244:245] op_sel_hi:[1,0] neg_lo:[0,1] neg_hi:[0,1]
    v_pk_add_f32 v[106:107], v[106:107], v[244:245] op_sel_hi:[1,0] neg_lo:[0,1] neg_hi:[0,1]
    v_pk_add_f32 v[108:109], v[108:109], v[244:245] op_sel_hi:[1,0] neg_lo:[0,1] neg_hi:[0,1]
    v_pk_add_f32 v[110:111], v[110:111], v[244:245] op_sel_hi:[1,0] neg_lo:[0,1] neg_hi:[0,1]
    v_pk_add_f32 v[112:113], v[112:113], v[244:245] op_sel_hi:[1,0] neg_lo:[0,1] neg_hi:[0,1]
    v_pk_add_f32 v[114:115], v[114:115], v[244:245] op_sel_hi:[1,0] neg_lo:[0,1] neg_hi:[0,1]
    v_exp_f32 v100, v100
    v_exp_f32 v101, v101
    v_exp_f32 v102, v102
    v_exp_f32 v103, v103
    s_mov_b32 m0, s29
    s_mov_b32 s21, 0
    buffer_load_dwordx4 v12, s[36:39], s21 offen lds
    s_add_u32 s29, s29, 8448
    s_cmp_ge_u32 s29, s34
    s_cselect_b32 s29, s32, s29
    v_exp_f32 v104, v104
    v_exp_f32 v105, v105
    v_exp_f32 v106, v106
    v_exp_f32 v107, v107
    s_mov_b32 m0, s29
    s_mov_b32 s21, 102400
    buffer_load_dwordx4 v12, s[36:39], s21 offen lds
    s_add_u32 s29, s29, 8448
    s_cmp_ge_u32 s29, s34
    s_cselect_b32 s29, s32, s29
    v_exp_f32 v108, v108
    v_exp_f32 v109, v109
    v_exp_f32 v110, v110
    v_exp_f32 v111, v111
    s_mov_b32 m0, s29
    s_mov_b32 s21, 204800
    buffer_load_dwordx4 v12, s[36:39], s21 offen lds
    s_add_u32 s29, s29, 8448
    s_cmp_ge_u32 s29, s34
    s_cselect_b32 s29, s32, s29
    v_exp_f32 v112, v112
    v_exp_f32 v113, v113
    ds_read_b64_tr_b16 v[84:85], v9 offset:256
    ds_read_b64_tr_b16 v[86:87], v9 offset:384
    ds_read_b64_tr_b16 v[88:89], v9 offset:264
    ds_read_b64_tr_b16 v[90:91], v9 offset:392
    v_exp_f32 v114, v114
    v_exp_f32 v115, v115
    v_cvt_pk_bf16_f32 v100, v100, v101
    v_cvt_pk_bf16_f32 v101, v102, v103
    v_cvt_pk_bf16_f32 v102, v104, v105
    v_cvt_pk_bf16_f32 v103, v106, v107
    v_cvt_pk_bf16_f32 v104, v108, v109
    v_cvt_pk_bf16_f32 v105, v110, v111
    v_cvt_pk_bf16_f32 v106, v112, v113
    v_cvt_pk_bf16_f32 v107, v114, v115
    v_and_b32 v228, v100, v26
    v_and_b32 v229, v101, v27
    v_and_b32 v230, v102, v28
    v_and_b32 v231, v103, v29
    v_and_b32 v232, v104, v30
    v_and_b32 v233, v105, v31
    v_and_b32 v234, v106, v32
    v_and_b32 v235, v107, v33
    v_bfi_b32 v100, v26, 0, v100
    v_bfi_b32 v101, v27, 0, v101
    v_bfi_b32 v102, v28, 0, v102
    v_bfi_b32 v103, v29, 0, v103
    v_bfi_b32 v104, v30, 0, v104
    v_bfi_b32 v105, v31, 0, v105
    v_bfi_b32 v106, v32, 0, v106
    v_bfi_b32 v107, v33, 0, v107
    v_pk_add_f32 v[116:117], v[116:117], v[244:245] op_sel_hi:[1,0] neg_lo:[0,1] neg_hi:[0,1]
    v_pk_add_f32 v[118:119], v[118:119], v[244:245] op_sel_hi:[1,0] neg_lo:[0,1] neg_hi:[0,1]
    v_pk_add_f32 v[120:121], v[120:121], v[244:245] op_sel_hi:[1,0] neg_lo:[0,1] neg_hi:[0,1]
    v_pk_add_f32 v[122:123], v[122:123], v[244:245] op_sel_hi:[1,0] neg_lo:[0,1] neg_hi:[0,1]
    v_pk_add_f32 v[124:125], v[124:125], v[244:245] op_sel_hi:[1,0] neg_lo:[0,1] neg_hi:[0,1]
    v_pk_add_f32 v[126:127], v[126:127], v[244:245] op_sel_hi:[1,0] neg_lo:[0,1] neg_hi:[0,1]
    v_pk_add_f32 v[128:129], v[128:129], v[244:245] op_sel_hi:[1,0] neg_lo:[0,1] neg_hi:[0,1]
    v_pk_add_f32 v[130:131], v[130:131], v[244:245] op_sel_hi:[1,0] neg_lo:[0,1] neg_hi:[0,1]
    v_exp_f32 v116, v116
    v_exp_f32 v117, v117
    s_waitcnt lgkmcnt(8)
    v_mfma_f32_32x32x16_bf16 v[68:83], v[52:55], v[100:103], 0
    v_exp_f32 v118, v118
    v_exp_f32 v119, v119
    s_mov_b32 m0, s29
    s_mov_b32 s21, 307200
    buffer_load_dwordx4 v12, s[36:39], s21 offen lds
    s_add_u32 s29, s29, 8448
    s_cmp_ge_u32 s29, s34
    s_cselect_b32 s29, s32, s29
    v_exp_f32 v120, v120
    v_exp_f32 v121, v121
    v_exp_f32 v122, v122
    v_mfma_f32_32x32x16_bf16 v[68:83], v[56:59], v[104:107], v[68:83]
    v_exp_f32 v123, v123
    s_mov_b32 m0, s29
    s_mov_b32 s21, 409600
    buffer_load_dwordx4 v12, s[36:39], s21 offen lds
    s_add_u32 s29, s29, 8448
    s_cmp_ge_u32 s29, s34
    s_cselect_b32 s29, s32, s29
    v_exp_f32 v124, v124
    v_exp_f32 v125, v125
    v_exp_f32 v126, v126
    v_exp_f32 v127, v127
    s_waitcnt lgkmcnt(4)
    v_mfma_f32_32x32x16_bf16 v[68:83], v[60:63], v[228:231], v[68:83]
    s_mov_b32 m0, s29
    s_mov_b32 s21, 512000
    buffer_load_dwordx4 v12, s[36:39], s21 offen lds
    s_add_u32 s29, s29, 8448
    s_cmp_ge_u32 s29, s34
    s_cselect_b32 s29, s32, s29
    v_exp_f32 v128, v128
    v_exp_f32 v129, v129
    ds_read_b64_tr_b16 v[92:93], v9 offset:512
    ds_read_b64_tr_b16 v[94:95], v9 offset:640
    ds_read_b64_tr_b16 v[96:97], v9 offset:520
    ds_read_b64_tr_b16 v[98:99], v9 offset:648
    v_exp_f32 v130, v130
    v_exp_f32 v131, v131
    v_cvt_pk_bf16_f32 v116, v116, v117
    v_cvt_pk_bf16_f32 v117, v118, v119
    v_cvt_pk_bf16_f32 v118, v120, v121
    v_cvt_pk_bf16_f32 v119, v122, v123
    v_cvt_pk_bf16_f32 v120, v124, v125
    v_cvt_pk_bf16_f32 v121, v126, v127
    v_cvt_pk_bf16_f32 v122, v128, v129
    v_cvt_pk_bf16_f32 v123, v130, v131
    v_pk_add_f32 v[132:133], v[132:133], v[244:245] op_sel_hi:[1,0] neg_lo:[0,1] neg_hi:[0,1]
    v_pk_add_f32 v[134:135], v[134:135], v[244:245] op_sel_hi:[1,0] neg_lo:[0,1] neg_hi:[0,1]
    v_pk_add_f32 v[136:137], v[136:137], v[244:245] op_sel_hi:[1,0] neg_lo:[0,1] neg_hi:[0,1]
    v_pk_add_f32 v[138:139], v[138:139], v[244:245] op_sel_hi:[1,0] neg_lo:[0,1] neg_hi:[0,1]
    v_pk_add_f32 v[140:141], v[140:141], v[244:245] op_sel_hi:[1,0] neg_lo:[0,1] neg_hi:[0,1]
    v_pk_add_f32 v[142:143], v[142:143], v[244:245] op_sel_hi:[1,0] neg_lo:[0,1] neg_hi:[0,1]
    v_pk_add_f32 v[144:145], v[144:145], v[244:245] op_sel_hi:[1,0] neg_lo:[0,1] neg_hi:[0,1]
    v_pk_add_f32 v[146:147], v[146:147], v[244:245] op_sel_hi:[1,0] neg_lo:[0,1] neg_hi:[0,1]
    v_exp_f32 v132, v132
    v_exp_f32 v133, v133
    v_mfma_f32_32x32x16_bf16 v[68:83], v[64:67], v[232:235], v[68:83]
    v_exp_f32 v134, v134
    v_exp_f32 v135, v135
    s_mov_b32 m0, s29
    s_mov_b32 s21, 614400
    buffer_load_dwordx4 v12, s[36:39], s21 offen lds
    s_add_u32 s29, s29, 8448
    s_cmp_ge_u32 s29, s34
    s_cselect_b32 s29, s32, s29
    v_exp_f32 v136, v136
    v_exp_f32 v137, v137
    v_exp_f32 v138, v138
    s_waitcnt lgkmcnt(4)
    v_mfma_f32_32x32x16_bf16 v[68:83], v[84:87], v[116:119], v[68:83]
    v_exp_f32 v139, v139
    s_mov_b32 m0, s29
    s_mov_b32 s21, 716800
    buffer_load_dwordx4 v12, s[36:39], s21 offen lds
    s_add_u32 s29, s29, 8448
    s_cmp_ge_u32 s29, s34
    s_cselect_b32 s29, s32, s29
    v_exp_f32 v140, v140
    v_exp_f32 v141, v141
    v_exp_f32 v142, v142
    v_exp_f32 v143, v143
    v_mfma_f32_32x32x16_bf16 v[68:83], v[88:91], v[120:123], v[68:83]
    s_mov_b32 m0, s29
    s_mov_b32 s21, 0
    buffer_load_dwordx4 v13, s[36:39], s21 offen lds
    s_add_u32 s29, s29, 8448
    s_cmp_ge_u32 s29, s34
    s_cselect_b32 s29, s32, s29
    v_exp_f32 v144, v144
    v_exp_f32 v145, v145
    ds_read_b64_tr_b16 v[52:53], v9 offset:768
    ds_read_b64_tr_b16 v[54:55], v9 offset:896
    ds_read_b64_tr_b16 v[56:57], v9 offset:776
    ds_read_b64_tr_b16 v[58:59], v9 offset:904
    v_exp_f32 v146, v146
    v_exp_f32 v147, v147
    v_cvt_pk_bf16_f32 v132, v132, v133
    v_cvt_pk_bf16_f32 v133, v134, v135
    v_cvt_pk_bf16_f32 v134, v136, v137
    v_cvt_pk_bf16_f32 v135, v138, v139
    v_cvt_pk_bf16_f32 v136, v140, v141
    v_cvt_pk_bf16_f32 v137, v142, v143
    v_cvt_pk_bf16_f32 v138, v144, v145
    v_cvt_pk_bf16_f32 v139, v146, v147
    v_pk_add_f32 v[148:149], v[148:149], v[244:245] op_sel_hi:[1,0] neg_lo:[0,1] neg_hi:[0,1]
    v_pk_add_f32 v[150:151], v[150:151], v[244:245] op_sel_hi:[1,0] neg_lo:[0,1] neg_hi:[0,1]
    v_pk_add_f32 v[152:153], v[152:153], v[244:245] op_sel_hi:[1,0] neg_lo:[0,1] neg_hi:[0,1]
    v_pk_add_f32 v[154:155], v[154:155], v[244:245] op_sel_hi:[1,0] neg_lo:[0,1] neg_hi:[0,1]
    v_pk_add_f32 v[156:157], v[156:157], v[244:245] op_sel_hi:[1,0] neg_lo:[0,1] neg_hi:[0,1]
    v_pk_add_f32 v[158:159], v[158:159], v[244:245] op_sel_hi:[1,0] neg_lo:[0,1] neg_hi:[0,1]
    v_pk_add_f32 v[160:161], v[160:161], v[244:245] op_sel_hi:[1,0] neg_lo:[0,1] neg_hi:[0,1]
    v_pk_add_f32 v[162:163], v[162:163], v[244:245] op_sel_hi:[1,0] neg_lo:[0,1] neg_hi:[0,1]
    v_exp_f32 v148, v148
    v_exp_f32 v149, v149
    s_waitcnt lgkmcnt(4)
    v_mfma_f32_32x32x16_bf16 v[68:83], v[92:95], v[132:135], v[68:83]
    v_exp_f32 v150, v150
    v_exp_f32 v151, v151
    s_mov_b32 m0, s29
    s_mov_b32 s21, 409600
    buffer_load_dwordx4 v13, s[36:39], s21 offen lds
    s_add_u32 s29, s29, 8448
    s_cmp_ge_u32 s29, s34
    s_cselect_b32 s29, s32, s29
    v_exp_f32 v152, v152
    v_exp_f32 v153, v153
    v_exp_f32 v154, v154
    v_mfma_f32_32x32x16_bf16 v[68:83], v[96:99], v[136:139], v[68:83]
    v_exp_f32 v155, v155
    s_add_u32 m0, s30, 0
    s_nop 0
    buffer_load_dwordx4 v252, s[76:79], s31 offen lds
    v_exp_f32 v156, v156
    v_exp_f32 v157, v157
    v_exp_f32 v158, v158
    v_exp_f32 v159, v159
    s_add_u32 m0, s30, 1024
    s_nop 0
    buffer_load_dwordx4 v253, s[76:79], s31 offen lds
    s_add_u32 s31, s31, 221184
    s_cmp_ge_u32 s31, 2211840
    s_cselect_b32 s31, 0, s31
    v_exp_f32 v160, v160
    v_exp_f32 v161, v161
    ds_read_b64_tr_b16 v[60:61], v9 offset:1024
    ds_read_b64_tr_b16 v[62:63], v9 offset:1152
    ds_read_b64_tr_b16 v[64:65], v9 offset:1032
    ds_read_b64_tr_b16 v[66:67], v9 offset:1160
    v_exp_f32 v162, v162
    v_exp_f32 v163, v163
    v_cvt_pk_bf16_f32 v148, v148, v149
    v_cvt_pk_bf16_f32 v149, v150, v151
    v_cvt_pk_bf16_f32 v150, v152, v153
    v_cvt_pk_bf16_f32 v151, v154, v155
    v_cvt_pk_bf16_f32 v152, v156, v157
    v_cvt_pk_bf16_f32 v153, v158, v159
    v_cvt_pk_bf16_f32 v154, v160, v161
    v_cvt_pk_bf16_f32 v155, v162, v163
    v_pk_add_f32 v[164:165], v[164:165], v[244:245] op_sel_hi:[1,0] neg_lo:[0,1] neg_hi:[0,1]
    v_pk_add_f32 v[166:167], v[166:167], v[244:245] op_sel_hi:[1,0] neg_lo:[0,1] neg_hi:[0,1]
    v_pk_add_f32 v[168:169], v[168:169], v[244:245] op_sel_hi:[1,0] neg_lo:[0,1] neg_hi:[0,1]
    v_pk_add_f32 v[170:171], v[170:171], v[244:245] op_sel_hi:[1,0] neg_lo:[0,1] neg_hi:[0,1]
    v_pk_add_f32 v[172:173], v[172:173], v[244:245] op_sel_hi:[1,0] neg_lo:[0,1] neg_hi:[0,1]
    v_pk_add_f32 v[174:175], v[174:175], v[244:245] op_sel_hi:[1,0] neg_lo:[0,1] neg_hi:[0,1]
    v_pk_add_f32 v[176:177], v[176:177], v[244:245] op_sel_hi:[1,0] neg_lo:[0,1] neg_hi:[0,1]
    v_pk_add_f32 v[178:179], v[178:179], v[244:245] op_sel_hi:[1,0] neg_lo:[0,1] neg_hi:[0,1]
    v_exp_f32 v164, v164
    v_exp_f32 v165, v165
    s_waitcnt lgkmcnt(4)
    v_mfma_f32_32x32x16_bf16 v[68:83], v[52:55], v[148:151], v[68:83]
    v_exp_f32 v166, v166
    v_exp_f32 v167, v167
    s_add_u32 m0, s30, 16960
    s_nop 0
    buffer_load_dwordx4 v252, s[76:79], s31 offen lds
    v_exp_f32 v168, v168
    v_exp_f32 v169, v169
    v_exp_f32 v170, v170
    v_mfma_f32_32x32x16_bf16 v[68:83], v[56:59], v[152:155], v[68:83]
    v_exp_f32 v171, v171
    s_add_u32 m0, s30, 17984
    s_nop 0
    buffer_load_dwordx4 v253, s[76:79], s31 offen lds
    s_add_u32 s31, s31, 221184
    s_cmp_ge_u32 s31, 2211840
    s_cselect_b32 s31, 0, s31
    v_exp_f32 v172, v172
    v_exp_f32 v173, v173
    v_exp_f32 v174, v174
    v_exp_f32 v175, v175
    v_exp_f32 v176, v176
    v_exp_f32 v177, v177
    ds_read_b64_tr_b16 v[84:85], v9 offset:1280
    ds_read_b64_tr_b16 v[86:87], v9 offset:1408
    ds_read_b64_tr_b16 v[88:89], v9 offset:1288
    ds_read_b64_tr_b16 v[90:91], v9 offset:1416
    v_exp_f32 v178, v178
    v_exp_f32 v179, v179
    v_cvt_pk_bf16_f32 v164, v164, v165
    v_cvt_pk_bf16_f32 v165, v166, v167
    v_cvt_pk_bf16_f32 v166, v168, v169
    v_cvt_pk_bf16_f32 v167, v170, v171
    v_cvt_pk_bf16_f32 v168, v172, v173
    v_cvt_pk_bf16_f32 v169, v174, v175
    v_cvt_pk_bf16_f32 v170, v176, v177
    v_cvt_pk_bf16_f32 v171, v178, v179
    v_pk_add_f32 v[180:181], v[180:181], v[244:245] op_sel_hi:[1,0] neg_lo:[0,1] neg_hi:[0,1]
    v_pk_add_f32 v[182:183], v[182:183], v[244:245] op_sel_hi:[1,0] neg_lo:[0,1] neg_hi:[0,1]
    v_pk_add_f32 v[184:185], v[184:185], v[244:245] op_sel_hi:[1,0] neg_lo:[0,1] neg_hi:[0,1]
    v_pk_add_f32 v[186:187], v[186:187], v[244:245] op_sel_hi:[1,0] neg_lo:[0,1] neg_hi:[0,1]
    v_pk_add_f32 v[188:189], v[188:189], v[244:245] op_sel_hi:[1,0] neg_lo:[0,1] neg_hi:[0,1]
    v_pk_add_f32 v[190:191], v[190:191], v[244:245] op_sel_hi:[1,0] neg_lo:[0,1] neg_hi:[0,1]
    v_pk_add_f32 v[192:193], v[192:193], v[244:245] op_sel_hi:[1,0] neg_lo:[0,1] neg_hi:[0,1]
    v_pk_add_f32 v[194:195], v[194:195], v[244:245] op_sel_hi:[1,0] neg_lo:[0,1] neg_hi:[0,1]
    v_exp_f32 v180, v180
    v_exp_f32 v181, v181
    s_waitcnt lgkmcnt(4)
    v_mfma_f32_32x32x16_bf16 v[68:83], v[60:63], v[164:167], v[68:83]
    v_exp_f32 v182, v182
    v_exp_f32 v183, v183
    v_exp_f32 v184, v184
    v_exp_f32 v185, v185
    v_exp_f32 v186, v186
    v_mfma_f32_32x32x16_bf16 v[68:83], v[64:67], v[168:171], v[68:83]
    v_exp_f32 v187, v187
    v_exp_f32 v188, v188
    v_exp_f32 v189, v189
    v_exp_f32 v190, v190
    v_exp_f32 v191, v191
    v_exp_f32 v192, v192
    v_exp_f32 v193, v193
    ds_read_b64_tr_b16 v[92:93], v9 offset:1536
    ds_read_b64_tr_b16 v[94:95], v9 offset:1664
    ds_read_b64_tr_b16 v[96:97], v9 offset:1544
    ds_read_b64_tr_b16 v[98:99], v9 offset:1672
    v_exp_f32 v194, v194
    v_exp_f32 v195, v195
    v_cvt_pk_bf16_f32 v180, v180, v181
    v_cvt_pk_bf16_f32 v181, v182, v183
    v_cvt_pk_bf16_f32 v182, v184, v185
    v_cvt_pk_bf16_f32 v183, v186, v187
    v_cvt_pk_bf16_f32 v184, v188, v189
    v_cvt_pk_bf16_f32 v185, v190, v191
    v_cvt_pk_bf16_f32 v186, v192, v193
    v_cvt_pk_bf16_f32 v187, v194, v195
    v_pk_add_f32 v[196:197], v[196:197], v[244:245] op_sel_hi:[1,0] neg_lo:[0,1] neg_hi:[0,1]
    v_pk_add_f32 v[198:199], v[198:199], v[244:245] op_sel_hi:[1,0] neg_lo:[0,1] neg_hi:[0,1]
    v_pk_add_f32 v[200:201], v[200:201], v[244:245] op_sel_hi:[1,0] neg_lo:[0,1] neg_hi:[0,1]
    v_pk_add_f32 v[202:203], v[202:203], v[244:245] op_sel_hi:[1,0] neg_lo:[0,1] neg_hi:[0,1]
    v_pk_add_f32 v[204:205], v[204:205], v[244:245] op_sel_hi:[1,0] neg_lo:[0,1] neg_hi:[0,1]
    v_pk_add_f32 v[206:207], v[206:207], v[244:245] op_sel_hi:[1,0] neg_lo:[0,1] neg_hi:[0,1]
    v_pk_add_f32 v[208:209], v[208:209], v[244:245] op_sel_hi:[1,0] neg_lo:[0,1] neg_hi:[0,1]
    v_pk_add_f32 v[210:211], v[210:211], v[244:245] op_sel_hi:[1,0] neg_lo:[0,1] neg_hi:[0,1]
    v_exp_f32 v196, v196
    v_exp_f32 v197, v197
    s_waitcnt lgkmcnt(4)
    v_mfma_f32_32x32x16_bf16 v[68:83], v[84:87], v[180:183], v[68:83]
    v_exp_f32 v198, v198
    v_exp_f32 v199, v199
    v_exp_f32 v200, v200
    v_exp_f32 v201, v201
    v_exp_f32 v202, v202
    v_mfma_f32_32x32x16_bf16 v[68:83], v[88:91], v[184:187], v[68:83]
    v_exp_f32 v203, v203
    v_exp_f32 v204, v204
    v_exp_f32 v205, v205
    v_exp_f32 v206, v206
    v_exp_f32 v207, v207
    v_exp_f32 v208, v208
    v_exp_f32 v209, v209
    ds_read_b64_tr_b16 v[52:53], v9 offset:1792
    ds_read_b64_tr_b16 v[54:55], v9 offset:1920
    ds_read_b64_tr_b16 v[56:57], v9 offset:1800
    ds_read_b64_tr_b16 v[58:59], v9 offset:1928
    v_exp_f32 v210, v210
    v_exp_f32 v211, v211
    v_cvt_pk_bf16_f32 v196, v196, v197
    v_cvt_pk_bf16_f32 v197, v198, v199
    v_cvt_pk_bf16_f32 v198, v200, v201
    v_cvt_pk_bf16_f32 v199, v202, v203
    v_cvt_pk_bf16_f32 v200, v204, v205
    v_cvt_pk_bf16_f32 v201, v206, v207
    v_cvt_pk_bf16_f32 v202, v208, v209
    v_cvt_pk_bf16_f32 v203, v210, v211
    v_pk_add_f32 v[212:213], v[212:213], v[244:245] op_sel_hi:[1,0] neg_lo:[0,1] neg_hi:[0,1]
    v_pk_add_f32 v[214:215], v[214:215], v[244:245] op_sel_hi:[1,0] neg_lo:[0,1] neg_hi:[0,1]
    v_pk_add_f32 v[216:217], v[216:217], v[244:245] op_sel_hi:[1,0] neg_lo:[0,1] neg_hi:[0,1]
    v_pk_add_f32 v[218:219], v[218:219], v[244:245] op_sel_hi:[1,0] neg_lo:[0,1] neg_hi:[0,1]
    v_pk_add_f32 v[220:221], v[220:221], v[244:245] op_sel_hi:[1,0] neg_lo:[0,1] neg_hi:[0,1]
    v_pk_add_f32 v[222:223], v[222:223], v[244:245] op_sel_hi:[1,0] neg_lo:[0,1] neg_hi:[0,1]
    v_pk_add_f32 v[224:225], v[224:225], v[244:245] op_sel_hi:[1,0] neg_lo:[0,1] neg_hi:[0,1]
    v_pk_add_f32 v[226:227], v[226:227], v[244:245] op_sel_hi:[1,0] neg_lo:[0,1] neg_hi:[0,1]
    v_exp_f32 v212, v212
    v_exp_f32 v213, v213
    s_waitcnt lgkmcnt(4)
    v_mfma_f32_32x32x16_bf16 v[68:83], v[92:95], v[196:199], v[68:83]
    v_exp_f32 v214, v214
    v_exp_f32 v215, v215
    v_exp_f32 v216, v216
    v_exp_f32 v217, v217
    v_exp_f32 v218, v218
    v_mfma_f32_32x32x16_bf16 v[68:83], v[96:99], v[200:203], v[68:83]
    v_exp_f32 v219, v219
    v_exp_f32 v220, v220
    v_exp_f32 v221, v221
    v_exp_f32 v222, v222
    v_exp_f32 v223, v223
    v_exp_f32 v224, v224
    v_exp_f32 v225, v225
    v_exp_f32 v226, v226
    v_exp_f32 v227, v227
    v_cvt_pk_bf16_f32 v212, v212, v213
    v_cvt_pk_bf16_f32 v213, v214, v215
    v_cvt_pk_bf16_f32 v214, v216, v217
    v_cvt_pk_bf16_f32 v215, v218, v219
    v_cvt_pk_bf16_f32 v216, v220, v221
    v_cvt_pk_bf16_f32 v217, v222, v223
    v_cvt_pk_bf16_f32 v218, v224, v225
    v_cvt_pk_bf16_f32 v219, v226, v227
    s_waitcnt lgkmcnt(0)
    v_mfma_f32_32x32x16_bf16 v[68:83], v[52:55], v[212:215], v[68:83]
    v_mfma_f32_32x32x16_bf16 v[68:83], v[56:59], v[216:219], v[68:83]
    s_nop 11
    v_rcp_f32 v244, v80
    s_nop 0
    v_pk_mul_f32 v[68:69], v[68:69], v[244:245] op_sel_hi:[1,0]
    v_pk_mul_f32 v[70:71], v[70:71], v[244:245] op_sel_hi:[1,0]
    v_pk_mul_f32 v[72:73], v[72:73], v[244:245] op_sel_hi:[1,0]
    v_pk_mul_f32 v[74:75], v[74:75], v[244:245] op_sel_hi:[1,0]
    v_pk_mul_f32 v[76:77], v[76:77], v[244:245] op_sel_hi:[1,0]
    v_pk_mul_f32 v[78:79], v[78:79], v[244:245] op_sel_hi:[1,0]
    v_cvt_pk_bf16_f32 v84, v68, v69
    v_cvt_pk_bf16_f32 v85, v70, v71
    v_cvt_pk_bf16_f32 v86, v72, v73
    v_cvt_pk_bf16_f32 v87, v74, v75
    v_cvt_pk_bf16_f32 v88, v76, v77
    v_cvt_pk_bf16_f32 v89, v78, v79
    buffer_store_dwordx4 v[84:87], v10, s[12:15], 0 offen sc1
    buffer_store_dwordx2 v[88:89], v11, s[12:15], 0 offen sc1
    s_lshl_b32 s21, s16, 3
    s_add_u32 s21, s21, 0
    s_lshl_b32 s21, s21, 3
    s_add_u32 s21, s21, s18
    s_lshl_b32 s21, s21, 3
    s_add_u32 s21, s21, s20
    s_lshl_b32 s21, s21, 5
    s_add_u32 s21, s21, s19
    v_mov_b32 v20, s21
    v_mov_b32 v21, 1
    s_waitcnt vmcnt(0)
    s_mov_b64 exec, 1
    s_cmp_eq_u32 s17, 0
    s_cbranch_scc1 L_sigslow_21
    buffer_store_byte v21, v20, s[72:75], 0 offen
    s_branch L_sigdone_22
L_sigslow_21:
    buffer_store_byte v21, v20, s[72:75], 0 offen sc1
L_sigdone_22:
    s_mov_b64 exec, -1
    s_cmp_ge_u32 s19, 30
    s_cbranch_scc1 L_p3_skip
    s_mul_i32 s28, s19, 171
    s_lshr_b32 s28, s28, 9
    s_mul_i32 s25, s28, 3
    s_sub_u32 s24, s19, s25
    s_and_b32 s26, s20, 3
    s_lshl_b32 s24, s24, 2
    s_add_u32 s24, s24, s26
    s_lshl_b32 s24, s24, 2
    s_mov_b32 s22, 0x86528410
    s_mov_b32 s23, 0x8873
    s_lshr_b64 s[22:23], s[22:23], s24
    s_and_b32 s29, s22, 15
    s_lshl_b32 s24, s29, 5
    s_lshl_b32 s27, s18, 8
    s_add_u32 s27, s27, s24
    s_lshl_b32 s21, s20, 1
    s_or_b32 s21, s21, s29
    s_cmp_lt_u32 s21, 8
    s_cbranch_scc1 L_p3_comp
    s_barrier
    s_cmp_lt_u32 s20, 4
    s_cbranch_scc1 L_p3_noblk
    s_cmp_ge_u32 s19, 27
    s_cbranch_scc1 L_p3_skip
    s_lshl_b32 s25, s19, 7
    v_lshrrev_b32 v16, 3, v1
    v_lshlrev_b32 v16, 2, v16
    v_add_u32 v16, s26, v16
    v_mul_u32_u24 v16, 3456, v16
    v_and_b32 v17, 7, v1
    v_lshl_add_u32 v16, v17, 4, v16
    v_add_u32 v6, s25, v16
    v_add_u32 v7, 110592, v6
    s_mul_i32 s32, s26, 2112
    s_mul_i32 s21, s18, 10
    s_lshr_b32 s21, s21, 3
    s_lshl_b32 s30, s21, 11
    s_add_u32 s21, s21, 2
    s_cmp_ge_u32 s21, 10
    s_cselect_b32 s22, 10, 0
    s_sub_u32 s21, s21, s22
    s_mul_i32 s31, s21, 221184
    s_add_u32 s12, s92, 0x0
    s_addc_u32 s13, s93, 0
    s_mov_b32 s14, 0x21c000
    s_mov_b32 s15, 0x20000
    s_add_u32 s36, s94, 0x0
    s_addc_u32 s37, s95, 0
    s_mov_b32 s38, 0x21c000
    s_mov_b32 s39, 0x20000
    s_add_u32 m0, s32, 33920
    s_nop 0
    buffer_load_dwordx4 v6, s[12:15], s31 offen lds
    s_waitcnt vmcnt(3)
    s_add_u32 m0, s32, 34944
    s_nop 0
    buffer_load_dwordx4 v7, s[12:15], s31 offen lds
    s_waitcnt vmcnt(3)
    s_add_u32 m0, s32, 42400
    s_nop 0
    buffer_load_dwordx4 v6, s[36:39], s31 offen lds
    s_waitcnt vmcnt(3)
    s_add_u32 m0, s32, 43424
    s_nop 0
    buffer_load_dwordx4 v7, s[36:39], s31 offen lds
    s_waitcnt vmcnt(3)
    s_add_u32 s31, s31, 221184
    s_cmp_ge_u32 s31, 2211840
    s_cselect_b32 s31, 0, s31
    s_add_u32 m0, s32, 50880
    s_nop 0
    buffer_load_dwordx4 v6, s[12:15], s31 offen lds
    s_waitcnt vmcnt(3)
    s_add_u32 m0, s32, 51904
    s_nop 0
    buffer_load_dwordx4 v7, s[12:15], s31 offen lds
    s_waitcnt vmcnt(3)
    s_add_u32 m0, s32, 59360
    s_nop 0
    buffer_load_dwordx4 v6, s[36:39], s31 offen lds
    s_waitcnt vmcnt(3)
    s_add_u32 m0, s32, 60384
    s_nop 0
    buffer_load_dwordx4 v7, s[36:39], s31 offen lds
    s_waitcnt vmcnt(3)
    s_add_u32 s31, s31, 221184
    s_cmp_ge_u32 s31, 2211840
    s_cselect_b32 s31, 0, s31
    s_waitcnt vmcnt(0)
    s_branch L_p3_done
L_p3_noblk:
L_p3_skip:
    s_branch L_p3_done
L_p3_comp:
    s_mov_b32 s21, 8
    s_lshl_b32 s30, s21, 11
    s_mul_i32 s31, s21, 81920
    v_lshrrev_b32 v16, 4, v2
    s_lshr_b32 s21, s27, 4
    v_add_u32 v16, s21, v16
    s_mov_b32 s21, 20480
    v_mul_lo_u32 v4, v16, s21
    v_lshl_add_u32 v4, v3, 8, v4
    v_and_b32 v16, 15, v2
    v_lshl_add_u32 v4, v16, 4, v4
    v_bfe_u32 v16, v1, 2, 2
    v_mul_u32_u24 v8, 2112, v16
    v_mul_u32_u24 v16, 128, v3
    v_add_u32 v8, v8, v16
    v_bfe_u32 v16, v1, 4, 1
    v_mul_u32_u24 v16, 32, v16
    v_add_u32 v8, v8, v16
    v_and_b32 v16, 3, v1
    v_lshl_add_u32 v8, v16, 3, v8
    v_add_u32 v8, 76288, v8
    v_add_u32 v9, 59136, v8
    v_add_u32 v13, 118272, v8
    v_lshrrev_b32 v16, 4, v2
    s_lshr_b32 s21, s27, 4
    v_add_u32 v16, s21, v16
    s_mov_b32 s21, 20480
    v_mul_lo_u32 v10, v16, s21
    v_lshl_add_u32 v10, v3, 8, v10
    v_and_b32 v16, 15, v2
    v_lshl_add_u32 v10, v16, 4, v10
    s_lshl_b32 s21, s28, 11
    v_add_u32 v10, s21, v10
    v_add_u32 v16, s27, v2
    v_mul_u32_u24 v12, 1280, v16
    s_lshl_b32 s21, s28, 7
    v_add_u32 v12, s21, v12
    v_lshl_add_u32 v12, v3, 3, v12
    v_add_u32 v16, s24, v2
    v_lshlrev_b32 v11, 3, v16
    s_mul_i32 s21, s18, 10
    s_add_u32 s21, s21, s28
    s_lshl_b32 s21, s21, 11
    v_add_u32 v11, s21, v11
    s_lshl_b32 s21, s27, 8
    v_lshlrev_b32 v14, 3, v2
    v_lshl_add_u32 v14, v3, 9, v14
    v_add_u32 v14, s21, v14
    s_add_u32 s8, s6, 0x600000
    s_addc_u32 s9, s7, 0
    s_mov_b32 s10, 0x300000
    s_mov_b32 s11, 0x20000
    s_add_u32 s36, s6, 0x0
    s_addc_u32 s37, s7, 0
    s_mov_b32 s38, 0x280000
    s_mov_b32 s39, 0x20000
    s_add_u32 s76, s6, 0x300000
    s_addc_u32 s77, s7, 0
    s_mov_b32 s78, 0x280000
    s_mov_b32 s79, 0x20000
    s_add_u32 s80, s6, 0x1840000
    s_addc_u32 s81, s7, 0
    s_mov_b32 s82, 0x28000
    s_mov_b32 s83, 0x20000
    s_cmp_lg_u32 s16, 0
    s_cbranch_scc1 L_p3_rescl
    s_add_u32 s36, s84, 0x0
    s_addc_u32 s37, s85, 0
    s_mov_b32 s38, 0x280000
    s_mov_b32 s39, 0x20000
    v_lshrrev_b32 v16, 3, v1
    v_add_u32 v16, s27, v16
    v_mul_u32_u24 v16, 1280, v16
    v_and_b32 v17, 7, v1
    v_lshl_add_u32 v16, v17, 4, v16
    s_lshl_b32 s22, s26, 12
    s_add_u32 s22, s22, 36864
    s_lshl_b32 s21, s28, 7
    s_add_u32 m0, s22, 0
    s_nop 0
    buffer_load_dwordx4 v16, s[36:39], s21 offen lds
    s_add_u32 s21, s21, 10240
    s_add_u32 m0, s22, 1024
    s_nop 0
    buffer_load_dwordx4 v16, s[36:39], s21 offen lds
    s_add_u32 s21, s21, 10240
    s_add_u32 m0, s22, 2048
    s_nop 0
    buffer_load_dwordx4 v16, s[36:39], s21 offen lds
    s_add_u32 s21, s21, 10240
    s_add_u32 m0, s22, 3072
    s_nop 0
    buffer_load_dwordx4 v16, s[36:39], s21 offen lds
    s_add_u32 s21, s21, 10240
    v_lshlrev_b32 v17, 7, v2
    v_lshl_add_u32 v17, v3, 3, v17
    v_add_u32 v17, s22, v17
    s_waitcnt vmcnt(0)
    ds_read_b64 v[80:81], v17 offset:0
    ds_read_b64 v[82:83], v17 offset:32
    ds_read_b64 v[84:85], v17 offset:16
    ds_read_b64 v[86:87], v17 offset:48
    ds_read_b64 v[88:89], v17 offset:64
    ds_read_b64 v[90:91], v17 offset:96
    ds_read_b64 v[92:93], v17 offset:80
    ds_read_b64 v[94:95], v17 offset:112
    s_waitcnt lgkmcnt(0)
    s_branch L_p3_resdone
L_p3_rescl:
    buffer_load_dwordx4 v[80:83], v10, s[36:39], 0 offen offset:0 sc1
    buffer_load_dwordx4 v[84:87], v10, s[36:39], 0 offen offset:512 sc1
    buffer_load_dwordx4 v[88:91], v10, s[36:39], 0 offen offset:1024 sc1
    buffer_load_dwordx4 v[92:95], v10, s[36:39], 0 offen offset:1536 sc1
L_p3_resdone:
    s_waitcnt vmcnt(0)
    v_lshlrev_b32 v48, 16, v80
    v_and_b32 v49, 0xffff0000, v80
    v_lshlrev_b32 v50, 16, v81
    v_and_b32 v51, 0xffff0000, v81
    v_lshlrev_b32 v56, 16, v82
    v_and_b32 v57, 0xffff0000, v82
    v_lshlrev_b32 v58, 16, v83
    v_and_b32 v59, 0xffff0000, v83
    v_lshlrev_b32 v52, 16, v84
    v_and_b32 v53, 0xffff0000, v84
    v_lshlrev_b32 v54, 16, v85
    v_and_b32 v55, 0xffff0000, v85
    v_lshlrev_b32 v60, 16, v86
    v_and_b32 v61, 0xffff0000, v86
    v_lshlrev_b32 v62, 16, v87
    v_and_b32 v63, 0xffff0000, v87
    v_lshlrev_b32 v64, 16, v88
    v_and_b32 v65, 0xffff0000, v88
    v_lshlrev_b32 v66, 16, v89
    v_and_b32 v67, 0xffff0000, v89
    v_lshlrev_b32 v72, 16, v90
    v_and_b32 v73, 0xffff0000, v90
    v_lshlrev_b32 v74, 16, v91
    v_and_b32 v75, 0xffff0000, v91
    v_lshlrev_b32 v68, 16, v92
    v_and_b32 v69, 0xffff0000, v92
    v_lshlrev_b32 v70, 16, v93
    v_and_b32 v71, 0xffff0000, v93
    v_lshlrev_b32 v76, 16, v94
    v_and_b32 v77, 0xffff0000, v94
    v_lshlrev_b32 v78, 16, v95
    v_and_b32 v79, 0xffff0000, v95
    v_and_b32 v17, 7, v1
    v_lshlrev_b32 v18, 5, v17
    v_mov_b32 v16, 0
    v_subrev_u32 v18, 0, v17
    v_cmp_gt_u32 vcc, 8, v18
    v_mov_b32 v18, 0x01010101
    s_nop 0
    v_cndmask_b32 v16, v16, v18, vcc
    v_lshlrev_b32 v17, 2, v17
    s_add_u32 s21, s16, 0x0
    s_lshl_b32 s21, s21, 3
    s_add_u32 s21, s21, 0
    s_lshl_b32 s21, s21, 3
    s_add_u32 s21, s21, s18
    s_lshl_b32 s21, s21, 3
    s_add_u32 s21, s21, s29
    s_lshl_b32 s21, s21, 5
    s_mov_b32 s35, 0
L_wl_23:
    buffer_load_dword v18, v17, s[72:75], s21 offen sc1
    s_waitcnt vmcnt(0)
    v_and_b32 v18, v18, v16
    v_cmp_ne_u32 vcc, v18, v16
    s_add_u32 s35, s35, 1
    s_cmp_gt_u32 s35, 65536
    s_cbranch_scc1 L_wlx_24
    s_cbranch_vccz L_wlx_24
    s_sleep 1
    s_branch L_wl_23
L_wlx_24:
    s_cmp_lg_u32 s17, 0
    s_cbranch_scc1 L_acq_25
    buffer_inv sc1
    s_waitcnt vmcnt(0)
L_acq_25:
    s_mov_b32 s21, 2621440
    buffer_load_dwordx2 v[96:97], v14, s[8:11], s21 offen offset:0 sc1
    buffer_load_dwordx2 v[98:99], v14, s[8:11], s21 offen offset:256 sc1
    s_mov_b32 s21, 2621440
    buffer_load_dwordx2 v[100:101], v14, s[8:11], s21 offen offset:1024 sc1
    buffer_load_dwordx2 v[102:103], v14, s[8:11], s21 offen offset:1280 sc1
    s_mov_b32 s21, 2621440
    buffer_load_dwordx2 v[104:105], v14, s[8:11], s21 offen offset:2048 sc1
    buffer_load_dwordx2 v[106:107], v14, s[8:11], s21 offen offset:2304 sc1
    s_mov_b32 s21, 2621440
    buffer_load_dwordx2 v[108:109], v14, s[8:11], s21 offen offset:3072 sc1
    buffer_load_dwordx2 v[110:111], v14, s[8:11], s21 offen offset:3328 sc1
    s_add_u32 s30, s30, 2048
    s_cmp_ge_u32 s30, 20480
    s_cselect_b32 s30, 0, s30
    s_mov_b32 s21, 2625536
    buffer_load_dwordx2 v[112:113], v14, s[8:11], s21 offen offset:0 sc1
    buffer_load_dwordx2 v[114:115], v14, s[8:11], s21 offen offset:256 sc1
    s_mov_b32 s21, 2625536
    buffer_load_dwordx2 v[116:117], v14, s[8:11], s21 offen offset:1024 sc1
    buffer_load_dwordx2 v[118:119], v14, s[8:11], s21 offen offset:1280 sc1
    s_mov_b32 s21, 2625536
    buffer_load_dwordx2 v[120:121], v14, s[8:11], s21 offen offset:2048 sc1
    buffer_load_dwordx2 v[122:123], v14, s[8:11], s21 offen offset:2304 sc1
    s_mov_b32 s21, 2625536
    buffer_load_dwordx2 v[124:125], v14, s[8:11], s21 offen offset:3072 sc1
    buffer_load_dwordx2 v[126:127], v14, s[8:11], s21 offen offset:3328 sc1
    s_add_u32 s30, s30, 2048
    s_cmp_ge_u32 s30, 20480
    s_cselect_b32 s30, 0, s30
    buffer_load_dwordx4 v[128:131], v4, s[8:11], s30 offen offset:0 sc1
    buffer_load_dwordx4 v[132:135], v4, s[8:11], s30 offen offset:512 sc1
    buffer_load_dwordx4 v[136:139], v4, s[8:11], s30 offen offset:1024 sc1
    buffer_load_dwordx4 v[140:143], v4, s[8:11], s30 offen offset:1536 sc1
    s_add_u32 s30, s30, 2048
    s_cmp_ge_u32 s30, 20480
    s_cselect_b32 s30, 0, s30
    buffer_load_dwordx4 v[144:147], v4, s[8:11], s30 offen offset:0 sc1
    buffer_load_dwordx4 v[148:151], v4, s[8:11], s30 offen offset:512 sc1
    buffer_load_dwordx4 v[152:155], v4, s[8:11], s30 offen offset:1024 sc1
    buffer_load_dwordx4 v[156:159], v4, s[8:11], s30 offen offset:1536 sc1
    s_add_u32 s30, s30, 2048
    s_cmp_ge_u32 s30, 20480
    s_cselect_b32 s30, 0, s30
    buffer_load_dwordx4 v[160:163], v4, s[8:11], s30 offen offset:0 sc1
    buffer_load_dwordx4 v[164:167], v4, s[8:11], s30 offen offset:512 sc1
    buffer_load_dwordx4 v[168:171], v4, s[8:11], s30 offen offset:1024 sc1
    buffer_load_dwordx4 v[172:175], v4, s[8:11], s30 offen offset:1536 sc1
    s_add_u32 s30, s30, 2048
    s_cmp_ge_u32 s30, 20480
    s_cselect_b32 s30, 0, s30
    buffer_load_dwordx4 v[176:179], v4, s[8:11], s30 offen offset:0 sc1
    buffer_load_dwordx4 v[180:183], v4, s[8:11], s30 offen offset:512 sc1
    buffer_load_dwordx4 v[184:187], v4, s[8:11], s30 offen offset:1024 sc1
    buffer_load_dwordx4 v[188:191], v4, s[8:11], s30 offen offset:1536 sc1
    s_add_u32 s30, s30, 2048
    s_cmp_ge_u32 s30, 20480
    s_cselect_b32 s30, 0, s30
    buffer_load_dwordx4 v[192:195], v4, s[8:11], s30 offen offset:0 sc1
    buffer_load_dwordx4 v[196:199], v4, s[8:11], s30 offen offset:512 sc1
    buffer_load_dwordx4 v[200:203], v4, s[8:11], s30 offen offset:1024 sc1
    buffer_load_dwordx4 v[204:207], v4, s[8:11], s30 offen offset:1536 sc1
    s_add_u32 s30, s30, 2048
    s_cmp_ge_u32 s30, 20480
    s_cselect_b32 s30, 0, s30
    buffer_load_dwordx4 v[208:211], v4, s[8:11], s30 offen offset:0 sc1
    buffer_load_dwordx4 v[212:215], v4, s[8:11], s30 offen offset:512 sc1
    buffer_load_dwordx4 v[216:219], v4, s[8:11], s30 offen offset:1024 sc1
    buffer_load_dwordx4 v[220:223], v4, s[8:11], s30 offen offset:1536 sc1
    s_add_u32 s30, s30, 2048
    s_cmp_ge_u32 s30, 20480
    s_cselect_b32 s30, 0, s30
    s_barrier
    ds_read_b64_tr_b16 v[24:25], v8 offset:0
    ds_read_b64_tr_b16 v[26:27], v8 offset:512
    ds_read_b64_tr_b16 v[28:29], v8 offset:64
    ds_read_b64_tr_b16 v[30:31], v8 offset:576
    ds_read_b64_tr_b16 v[32:33], v8 offset:256
    ds_read_b64_tr_b16 v[34:35], v8 offset:768
    ds_read_b64_tr_b16 v[36:37], v8 offset:320
    ds_read_b64_tr_b16 v[38:39], v8 offset:832
    s_waitcnt vmcnt(38)
    s_waitcnt lgkmcnt(6)
    v_mfma_f32_32x32x16_bf16 v[48:63], v[24:27], v[96:99], v[48:63]
    ds_read_b64_tr_b16 v[40:41], v8 offset:1024
    ds_read_b64_tr_b16 v[42:43], v8 offset:1536
    s_waitcnt lgkmcnt(6)
    v_mfma_f32_32x32x16_bf16 v[64:79], v[28:31], v[96:99], v[64:79]
    ds_read_b64_tr_b16 v[44:45], v8 offset:1088
    ds_read_b64_tr_b16 v[46:47], v8 offset:1600
    buffer_load_dwordx4 v[224:227], v4, s[8:11], s30 offen offset:0 sc1
    s_waitcnt vmcnt(37)
    s_waitcnt lgkmcnt(6)
    v_mfma_f32_32x32x16_bf16 v[48:63], v[32:35], v[100:103], v[48:63]
    ds_read_b64_tr_b16 v[24:25], v8 offset:1280
    ds_read_b64_tr_b16 v[26:27], v8 offset:1792
    s_waitcnt lgkmcnt(6)
    v_mfma_f32_32x32x16_bf16 v[64:79], v[36:39], v[100:103], v[64:79]
    ds_read_b64_tr_b16 v[28:29], v8 offset:1344
    ds_read_b64_tr_b16 v[30:31], v8 offset:1856
    buffer_load_dwordx4 v[228:231], v4, s[8:11], s30 offen offset:512 sc1
    s_waitcnt vmcnt(36)
    s_waitcnt lgkmcnt(6)
    v_mfma_f32_32x32x16_bf16 v[48:63], v[40:43], v[104:107], v[48:63]
    ds_read_b64_tr_b16 v[32:33], v8 offset:8448
    ds_read_b64_tr_b16 v[34:35], v8 offset:8960
    s_waitcnt lgkmcnt(6)
    v_mfma_f32_32x32x16_bf16 v[64:79], v[44:47], v[104:107], v[64:79]
    ds_read_b64_tr_b16 v[36:37], v8 offset:8512
    ds_read_b64_tr_b16 v[38:39], v8 offset:9024
    buffer_load_dwordx4 v[232:235], v4, s[8:11], s30 offen offset:1024 sc1
    s_waitcnt vmcnt(35)
    s_waitcnt lgkmcnt(6)
    v_mfma_f32_32x32x16_bf16 v[48:63], v[24:27], v[108:111], v[48:63]
    ds_read_b64_tr_b16 v[40:41], v8 offset:8704
    ds_read_b64_tr_b16 v[42:43], v8 offset:9216
    s_waitcnt lgkmcnt(6)
    v_mfma_f32_32x32x16_bf16 v[64:79], v[28:31], v[108:111], v[64:79]
    ds_read_b64_tr_b16 v[44:45], v8 offset:8768
    ds_read_b64_tr_b16 v[46:47], v8 offset:9280
    buffer_load_dwordx4 v[236:239], v4, s[8:11], s30 offen offset:1536 sc1
    s_add_u32 s30, s30, 2048
    s_cmp_ge_u32 s30, 20480
    s_cselect_b32 s30, 0, s30
    s_waitcnt vmcnt(34)
    s_waitcnt lgkmcnt(6)
    v_mfma_f32_32x32x16_bf16 v[48:63], v[32:35], v[112:115], v[48:63]
    ds_read_b64_tr_b16 v[24:25], v8 offset:9472
    ds_read_b64_tr_b16 v[26:27], v8 offset:9984
    s_waitcnt lgkmcnt(6)
    v_mfma_f32_32x32x16_bf16 v[64:79], v[36:39], v[112:115], v[64:79]
    ds_read_b64_tr_b16 v[28:29], v8 offset:9536
    ds_read_b64_tr_b16 v[30:31], v8 offset:10048
    buffer_load_dwordx4 v[96:99], v4, s[8:11], s30 offen offset:0 sc1
    s_waitcnt vmcnt(33)
    s_waitcnt lgkmcnt(6)
    v_mfma_f32_32x32x16_bf16 v[48:63], v[40:43], v[116:119], v[48:63]
    ds_read_b64_tr_b16 v[32:33], v8 offset:9728
    ds_read_b64_tr_b16 v[34:35], v8 offset:10240
    s_waitcnt lgkmcnt(6)
    v_mfma_f32_32x32x16_bf16 v[64:79], v[44:47], v[116:119], v[64:79]
    ds_read_b64_tr_b16 v[36:37], v8 offset:9792
    ds_read_b64_tr_b16 v[38:39], v8 offset:10304
    buffer_load_dwordx4 v[100:103], v4, s[8:11], s30 offen offset:512 sc1
    s_waitcnt vmcnt(32)
    s_waitcnt lgkmcnt(6)
    v_mfma_f32_32x32x16_bf16 v[48:63], v[24:27], v[120:123], v[48:63]
    ds_read_b64_tr_b16 v[40:41], v8 offset:16896
    ds_read_b64_tr_b16 v[42:43], v8 offset:17408
    s_waitcnt lgkmcnt(6)
    v_mfma_f32_32x32x16_bf16 v[64:79], v[28:31], v[120:123], v[64:79]
    ds_read_b64_tr_b16 v[44:45], v8 offset:16960
    ds_read_b64_tr_b16 v[46:47], v8 offset:17472
    buffer_load_dwordx4 v[104:107], v4, s[8:11], s30 offen offset:1024 sc1
    s_waitcnt vmcnt(31)
    s_waitcnt lgkmcnt(6)
    v_mfma_f32_32x32x16_bf16 v[48:63], v[32:35], v[124:127], v[48:63]
    ds_read_b64_tr_b16 v[24:25], v8 offset:17152
    ds_read_b64_tr_b16 v[26:27], v8 offset:17664
    s_waitcnt lgkmcnt(6)
    v_mfma_f32_32x32x16_bf16 v[64:79], v[36:39], v[124:127], v[64:79]
    ds_read_b64_tr_b16 v[28:29], v8 offset:17216
    ds_read_b64_tr_b16 v[30:31], v8 offset:17728
    buffer_load_dwordx4 v[108:111], v4, s[8:11], s30 offen offset:1536 sc1
    s_waitcnt vmcnt(31)
    s_waitcnt lgkmcnt(6)
    v_mfma_f32_32x32x16_bf16 v[48:63], v[40:43], v[128:131], v[48:63]
    ds_read_b64_tr_b16 v[32:33], v8 offset:17920
    ds_read_b64_tr_b16 v[34:35], v8 offset:18432
    s_waitcnt lgkmcnt(6)
    v_mfma_f32_32x32x16_bf16 v[64:79], v[44:47], v[128:131], v[64:79]
    ds_read_b64_tr_b16 v[36:37], v8 offset:17984
    ds_read_b64_tr_b16 v[38:39], v8 offset:18496
    s_waitcnt vmcnt(30)
    s_waitcnt lgkmcnt(6)
    v_mfma_f32_32x32x16_bf16 v[48:63], v[24:27], v[132:135], v[48:63]
    ds_read_b64_tr_b16 v[40:41], v8 offset:18176
    ds_read_b64_tr_b16 v[42:43], v8 offset:18688
    s_waitcnt lgkmcnt(6)
    v_mfma_f32_32x32x16_bf16 v[64:79], v[28:31], v[132:135], v[64:79]
    ds_read_b64_tr_b16 v[44:45], v8 offset:18240
    ds_read_b64_tr_b16 v[46:47], v8 offset:18752
    s_waitcnt vmcnt(29)
    s_waitcnt lgkmcnt(6)
    v_mfma_f32_32x32x16_bf16 v[48:63], v[32:35], v[136:139], v[48:63]
    ds_read_b64_tr_b16 v[24:25], v8 offset:25344
    ds_read_b64_tr_b16 v[26:27], v8 offset:25856
    s_waitcnt lgkmcnt(6)
    v_mfma_f32_32x32x16_bf16 v[64:79], v[36:39], v[136:139], v[64:79]
    ds_read_b64_tr_b16 v[28:29], v8 offset:25408
    ds_read_b64_tr_b16 v[30:31], v8 offset:25920
    s_waitcnt vmcnt(28)
    s_waitcnt lgkmcnt(6)
    v_mfma_f32_32x32x16_bf16 v[48:63], v[40:43], v[140:143], v[48:63]
    ds_read_b64_tr_b16 v[32:33], v8 offset:25600
    ds_read_b64_tr_b16 v[34:35], v8 offset:26112
    s_waitcnt lgkmcnt(6)
    v_mfma_f32_32x32x16_bf16 v[64:79], v[44:47], v[140:143], v[64:79]
    ds_read_b64_tr_b16 v[36:37], v8 offset:25664
    ds_read_b64_tr_b16 v[38:39], v8 offset:26176
    s_waitcnt vmcnt(27)
    s_waitcnt lgkmcnt(6)
    v_mfma_f32_32x32x16_bf16 v[48:63], v[24:27], v[144:147], v[48:63]
    ds_read_b64_tr_b16 v[40:41], v8 offset:26368
    ds_read_b64_tr_b16 v[42:43], v8 offset:26880
    s_waitcnt lgkmcnt(6)
    v_mfma_f32_32x32x16_bf16 v[64:79], v[28:31], v[144:147], v[64:79]
    ds_read_b64_tr_b16 v[44:45], v8 offset:26432
    ds_read_b64_tr_b16 v[46:47], v8 offset:26944
    s_waitcnt vmcnt(26)
    s_waitcnt lgkmcnt(6)
    v_mfma_f32_32x32x16_bf16 v[48:63], v[32:35], v[148:151], v[48:63]
    ds_read_b64_tr_b16 v[24:25], v8 offset:26624
    ds_read_b64_tr_b16 v[26:27], v8 offset:27136
    s_waitcnt lgkmcnt(6)
    v_mfma_f32_32x32x16_bf16 v[64:79], v[36:39], v[148:151], v[64:79]
    ds_read_b64_tr_b16 v[28:29], v8 offset:26688
    ds_read_b64_tr_b16 v[30:31], v8 offset:27200
    s_waitcnt vmcnt(25)
    s_waitcnt lgkmcnt(6)
    v_mfma_f32_32x32x16_bf16 v[48:63], v[40:43], v[152:155], v[48:63]
    ds_read_b64_tr_b16 v[32:33], v8 offset:33792
    ds_read_b64_tr_b16 v[34:35], v8 offset:34304
    s_waitcnt lgkmcnt(6)
    v_mfma_f32_32x32x16_bf16 v[64:79], v[44:47], v[152:155], v[64:79]
    ds_read_b64_tr_b16 v[36:37], v8 offset:33856
    ds_read_b64_tr_b16 v[38:39], v8 offset:34368
    s_waitcnt vmcnt(24)
    s_waitcnt lgkmcnt(6)
    v_mfma_f32_32x32x16_bf16 v[48:63], v[24:27], v[156:159], v[48:63]
    ds_read_b64_tr_b16 v[40:41], v8 offset:34048
    ds_read_b64_tr_b16 v[42:43], v8 offset:34560
    s_waitcnt lgkmcnt(6)
    v_mfma_f32_32x32x16_bf16 v[64:79], v[28:31], v[156:159], v[64:79]
    ds_read_b64_tr_b16 v[44:45], v8 offset:34112
    ds_read_b64_tr_b16 v[46:47], v8 offset:34624
    s_waitcnt vmcnt(23)
    s_waitcnt lgkmcnt(6)
    v_mfma_f32_32x32x16_bf16 v[48:63], v[32:35], v[160:163], v[48:63]
    ds_read_b64_tr_b16 v[24:25], v8 offset:34816
    ds_read_b64_tr_b16 v[26:27], v8 offset:35328
    s_waitcnt lgkmcnt(6)
    v_mfma_f32_32x32x16_bf16 v[64:79], v[36:39], v[160:163], v[64:79]
    ds_read_b64_tr_b16 v[28:29], v8 offset:34880
    ds_read_b64_tr_b16 v[30:31], v8 offset:35392
    s_waitcnt vmcnt(22)
    s_waitcnt lgkmcnt(6)
    v_mfma_f32_32x32x16_bf16 v[48:63], v[40:43], v[164:167], v[48:63]
    ds_read_b64_tr_b16 v[32:33], v8 offset:35072
    ds_read_b64_tr_b16 v[34:35], v8 offset:35584
    s_waitcnt lgkmcnt(6)
    v_mfma_f32_32x32x16_bf16 v[64:79], v[44:47], v[164:167], v[64:79]
    ds_read_b64_tr_b16 v[36:37], v8 offset:35136
    ds_read_b64_tr_b16 v[38:39], v8 offset:35648
    s_waitcnt vmcnt(21)
    s_waitcnt lgkmcnt(6)
    v_mfma_f32_32x32x16_bf16 v[48:63], v[24:27], v[168:171], v[48:63]
    ds_read_b64_tr_b16 v[40:41], v8 offset:42240
    ds_read_b64_tr_b16 v[42:43], v8 offset:42752
    s_waitcnt lgkmcnt(6)
    v_mfma_f32_32x32x16_bf16 v[64:79], v[28:31], v[168:171], v[64:79]
    ds_read_b64_tr_b16 v[44:45], v8 offset:42304
    ds_read_b64_tr_b16 v[46:47], v8 offset:42816
    s_waitcnt vmcnt(20)
    s_waitcnt lgkmcnt(6)
    v_mfma_f32_32x32x16_bf16 v[48:63], v[32:35], v[172:175], v[48:63]
    ds_read_b64_tr_b16 v[24:25], v8 offset:42496
    ds_read_b64_tr_b16 v[26:27], v8 offset:43008
    s_waitcnt lgkmcnt(6)
    v_mfma_f32_32x32x16_bf16 v[64:79], v[36:39], v[172:175], v[64:79]
    ds_read_b64_tr_b16 v[28:29], v8 offset:42560
    ds_read_b64_tr_b16 v[30:31], v8 offset:43072
    s_waitcnt vmcnt(19)
    s_waitcnt lgkmcnt(6)
    v_mfma_f32_32x32x16_bf16 v[48:63], v[40:43], v[176:179], v[48:63]
    ds_read_b64_tr_b16 v[32:33], v8 offset:43264
    ds_read_b64_tr_b16 v[34:35], v8 offset:43776
    s_waitcnt lgkmcnt(6)
    v_mfma_f32_32x32x16_bf16 v[64:79], v[44:47], v[176:179], v[64:79]
    ds_read_b64_tr_b16 v[36:37], v8 offset:43328
    ds_read_b64_tr_b16 v[38:39], v8 offset:43840
    s_waitcnt vmcnt(18)
    s_waitcnt lgkmcnt(6)
    v_mfma_f32_32x32x16_bf16 v[48:63], v[24:27], v[180:183], v[48:63]
    ds_read_b64_tr_b16 v[40:41], v8 offset:43520
    ds_read_b64_tr_b16 v[42:43], v8 offset:44032
    s_waitcnt lgkmcnt(6)
    v_mfma_f32_32x32x16_bf16 v[64:79], v[28:31], v[180:183], v[64:79]
    ds_read_b64_tr_b16 v[44:45], v8 offset:43584
    ds_read_b64_tr_b16 v[46:47], v8 offset:44096
    s_waitcnt vmcnt(17)
    s_waitcnt lgkmcnt(6)
    v_mfma_f32_32x32x16_bf16 v[48:63], v[32:35], v[184:187], v[48:63]
    ds_read_b64_tr_b16 v[24:25], v8 offset:50688
    ds_read_b64_tr_b16 v[26:27], v8 offset:51200
    s_waitcnt lgkmcnt(6)
    v_mfma_f32_32x32x16_bf16 v[64:79], v[36:39], v[184:187], v[64:79]
    ds_read_b64_tr_b16 v[28:29], v8 offset:50752
    ds_read_b64_tr_b16 v[30:31], v8 offset:51264
    s_waitcnt vmcnt(16)
    s_waitcnt lgkmcnt(6)
    v_mfma_f32_32x32x16_bf16 v[48:63], v[40:43], v[188:191], v[48:63]
    ds_read_b64_tr_b16 v[32:33], v8 offset:50944
    ds_read_b64_tr_b16 v[34:35], v8 offset:51456
    s_waitcnt lgkmcnt(6)
    v_mfma_f32_32x32x16_bf16 v[64:79], v[44:47], v[188:191], v[64:79]
    ds_read_b64_tr_b16 v[36:37], v8 offset:51008
    ds_read_b64_tr_b16 v[38:39], v8 offset:51520
    s_waitcnt vmcnt(15)
    s_waitcnt lgkmcnt(6)
    v_mfma_f32_32x32x16_bf16 v[48:63], v[24:27], v[192:195], v[48:63]
    ds_read_b64_tr_b16 v[40:41], v8 offset:51712
    ds_read_b64_tr_b16 v[42:43], v8 offset:52224
    s_waitcnt lgkmcnt(6)
    v_mfma_f32_32x32x16_bf16 v[64:79], v[28:31], v[192:195], v[64:79]
    ds_read_b64_tr_b16 v[44:45], v8 offset:51776
    ds_read_b64_tr_b16 v[46:47], v8 offset:52288
    s_waitcnt vmcnt(14)
    s_waitcnt lgkmcnt(6)
    v_mfma_f32_32x32x16_bf16 v[48:63], v[32:35], v[196:199], v[48:63]
    ds_read_b64_tr_b16 v[24:25], v8 offset:51968
    ds_read_b64_tr_b16 v[26:27], v8 offset:52480
    s_waitcnt lgkmcnt(6)
    v_mfma_f32_32x32x16_bf16 v[64:79], v[36:39], v[196:199], v[64:79]
    ds_read_b64_tr_b16 v[28:29], v8 offset:52032
    ds_read_b64_tr_b16 v[30:31], v8 offset:52544
    s_waitcnt vmcnt(13)
    s_waitcnt lgkmcnt(6)
    v_mfma_f32_32x32x16_bf16 v[48:63], v[40:43], v[200:203], v[48:63]
    ds_read_b64_tr_b16 v[32:33], v9 offset:0
    ds_read_b64_tr_b16 v[34:35], v9 offset:512
    s_waitcnt lgkmcnt(6)
    v_mfma_f32_32x32x16_bf16 v[64:79], v[44:47], v[200:203], v[64:79]
    ds_read_b64_tr_b16 v[36:37], v9 offset:64
    ds_read_b64_tr_b16 v[38:39], v9 offset:576
    s_waitcnt vmcnt(12)
    s_waitcnt lgkmcnt(6)
    v_mfma_f32_32x32x16_bf16 v[48:63], v[24:27], v[204:207], v[48:63]
    ds_read_b64_tr_b16 v[40:41], v9 offset:256
    ds_read_b64_tr_b16 v[42:43], v9 offset:768
    s_waitcnt lgkmcnt(6)
    v_mfma_f32_32x32x16_bf16 v[64:79], v[28:31], v[204:207], v[64:79]
    ds_read_b64_tr_b16 v[44:45], v9 offset:320
    ds_read_b64_tr_b16 v[46:47], v9 offset:832
    s_waitcnt vmcnt(11)
    s_waitcnt lgkmcnt(6)
    v_mfma_f32_32x32x16_bf16 v[48:63], v[32:35], v[208:211], v[48:63]
    ds_read_b64_tr_b16 v[24:25], v9 offset:1024
    ds_read_b64_tr_b16 v[26:27], v9 offset:1536
    s_waitcnt lgkmcnt(6)
    v_mfma_f32_32x32x16_bf16 v[64:79], v[36:39], v[208:211], v[64:79]
    ds_read_b64_tr_b16 v[28:29], v9 offset:1088
    ds_read_b64_tr_b16 v[30:31], v9 offset:1600
    s_waitcnt vmcnt(10)
    s_waitcnt lgkmcnt(6)
    v_mfma_f32_32x32x16_bf16 v[48:63], v[40:43], v[212:215], v[48:63]
    ds_read_b64_tr_b16 v[32:33], v9 offset:1280
    ds_read_b64_tr_b16 v[34:35], v9 offset:1792
    s_waitcnt lgkmcnt(6)
    v_mfma_f32_32x32x16_bf16 v[64:79], v[44:47], v[212:215], v[64:79]
    ds_read_b64_tr_b16 v[36:37], v9 offset:1344
    ds_read_b64_tr_b16 v[38:39], v9 offset:1856
    s_waitcnt vmcnt(9)
    s_waitcnt lgkmcnt(6)
    v_mfma_f32_32x32x16_bf16 v[48:63], v[24:27], v[216:219], v[48:63]
    ds_read_b64_tr_b16 v[40:41], v9 offset:8448
    ds_read_b64_tr_b16 v[42:43], v9 offset:8960
    s_waitcnt lgkmcnt(6)
    v_mfma_f32_32x32x16_bf16 v[64:79], v[28:31], v[216:219], v[64:79]
    ds_read_b64_tr_b16 v[44:45], v9 offset:8512
    ds_read_b64_tr_b16 v[46:47], v9 offset:9024
    s_waitcnt vmcnt(8)
    s_waitcnt lgkmcnt(6)
    v_mfma_f32_32x32x16_bf16 v[48:63], v[32:35], v[220:223], v[48:63]
    ds_read_b64_tr_b16 v[24:25], v9 offset:8704
    ds_read_b64_tr_b16 v[26:27], v9 offset:9216
    s_waitcnt lgkmcnt(6)
    v_mfma_f32_32x32x16_bf16 v[64:79], v[36:39], v[220:223], v[64:79]
    ds_read_b64_tr_b16 v[28:29], v9 offset:8768
    ds_read_b64_tr_b16 v[30:31], v9 offset:9280
    s_waitcnt vmcnt(7)
    s_waitcnt lgkmcnt(6)
    v_mfma_f32_32x32x16_bf16 v[48:63], v[40:43], v[224:227], v[48:63]
    ds_read_b64_tr_b16 v[32:33], v9 offset:9472
    ds_read_b64_tr_b16 v[34:35], v9 offset:9984
    s_waitcnt lgkmcnt(6)
    v_mfma_f32_32x32x16_bf16 v[64:79], v[44:47], v[224:227], v[64:79]
    ds_read_b64_tr_b16 v[36:37], v9 offset:9536
    ds_read_b64_tr_b16 v[38:39], v9 offset:10048
    s_waitcnt vmcnt(6)
    s_waitcnt lgkmcnt(6)
    v_mfma_f32_32x32x16_bf16 v[48:63], v[24:27], v[228:231], v[48:63]
    ds_read_b64_tr_b16 v[40:41], v9 offset:9728
    ds_read_b64_tr_b16 v[42:43], v9 offset:10240
    s_waitcnt lgkmcnt(6)
    v_mfma_f32_32x32x16_bf16 v[64:79], v[28:31], v[228:231], v[64:79]
    ds_read_b64_tr_b16 v[44:45], v9 offset:9792
    ds_read_b64_tr_b16 v[46:47], v9 offset:10304
    s_waitcnt vmcnt(5)
    s_waitcnt lgkmcnt(6)
    v_mfma_f32_32x32x16_bf16 v[48:63], v[32:35], v[232:235], v[48:63]
    ds_read_b64_tr_b16 v[24:25], v9 offset:16896
    ds_read_b64_tr_b16 v[26:27], v9 offset:17408
    s_waitcnt lgkmcnt(6)
    v_mfma_f32_32x32x16_bf16 v[64:79], v[36:39], v[232:235], v[64:79]
    ds_read_b64_tr_b16 v[28:29], v9 offset:16960
    ds_read_b64_tr_b16 v[30:31], v9 offset:17472
    s_waitcnt vmcnt(4)
    s_waitcnt lgkmcnt(6)
    v_mfma_f32_32x32x16_bf16 v[48:63], v[40:43], v[236:239], v[48:63]
    ds_read_b64_tr_b16 v[32:33], v9 offset:17152
    ds_read_b64_tr_b16 v[34:35], v9 offset:17664
    s_waitcnt lgkmcnt(6)
    v_mfma_f32_32x32x16_bf16 v[64:79], v[44:47], v[236:239], v[64:79]
    ds_read_b64_tr_b16 v[36:37], v9 offset:17216
    ds_read_b64_tr_b16 v[38:39], v9 offset:17728
    s_waitcnt vmcnt(3)
    s_waitcnt lgkmcnt(6)
    v_mfma_f32_32x32x16_bf16 v[48:63], v[24:27], v[96:99], v[48:63]
    ds_read_b64_tr_b16 v[40:41], v9 offset:17920
    ds_read_b64_tr_b16 v[42:43], v9 offset:18432
    s_waitcnt lgkmcnt(6)
    v_mfma_f32_32x32x16_bf16 v[64:79], v[28:31], v[96:99], v[64:79]
    ds_read_b64_tr_b16 v[44:45], v9 offset:17984
    ds_read_b64_tr_b16 v[46:47], v9 offset:18496
    s_waitcnt vmcnt(2)
    s_waitcnt lgkmcnt(6)
    v_mfma_f32_32x32x16_bf16 v[48:63], v[32:35], v[100:103], v[48:63]
    ds_read_b64_tr_b16 v[24:25], v9 offset:18176
    ds_read_b64_tr_b16 v[26:27], v9 offset:18688
    s_waitcnt lgkmcnt(6)
    v_mfma_f32_32x32x16_bf16 v[64:79], v[36:39], v[100:103], v[64:79]
    ds_read_b64_tr_b16 v[28:29], v9 offset:18240
    ds_read_b64_tr_b16 v[30:31], v9 offset:18752
    s_waitcnt vmcnt(1)
    s_waitcnt lgkmcnt(6)
    v_mfma_f32_32x32x16_bf16 v[48:63], v[40:43], v[104:107], v[48:63]
    s_waitcnt lgkmcnt(4)
    v_mfma_f32_32x32x16_bf16 v[64:79], v[44:47], v[104:107], v[64:79]
    s_waitcnt vmcnt(0)
    s_waitcnt lgkmcnt(2)
    v_mfma_f32_32x32x16_bf16 v[48:63], v[24:27], v[108:111], v[48:63]
    s_waitcnt lgkmcnt(0)
    v_mfma_f32_32x32x16_bf16 v[64:79], v[28:31], v[108:111], v[64:79]
    s_nop 9
    v_cvt_pk_bf16_f32 v80, v48, v49
    v_cvt_pk_bf16_f32 v81, v50, v51
    v_cvt_pk_bf16_f32 v82, v56, v57
    v_cvt_pk_bf16_f32 v83, v58, v59
    v_cvt_pk_bf16_f32 v84, v52, v53
    v_cvt_pk_bf16_f32 v85, v54, v55
    v_cvt_pk_bf16_f32 v86, v60, v61
    v_cvt_pk_bf16_f32 v87, v62, v63
    v_cvt_pk_bf16_f32 v88, v64, v65
    v_cvt_pk_bf16_f32 v89, v66, v67
    v_cvt_pk_bf16_f32 v90, v72, v73
    v_cvt_pk_bf16_f32 v91, v74, v75
    v_cvt_pk_bf16_f32 v92, v68, v69
    v_cvt_pk_bf16_f32 v93, v70, v71
    v_cvt_pk_bf16_f32 v94, v76, v77
    v_cvt_pk_bf16_f32 v95, v78, v79
    buffer_store_dwordx4 v[80:83], v10, s[76:79], 0 offen offset:0 sc1
    buffer_store_dwordx4 v[84:87], v10, s[76:79], 0 offen offset:512 sc1
    buffer_store_dwordx4 v[88:91], v10, s[76:79], 0 offen offset:1024 sc1
    buffer_store_dwordx4 v[92:95], v10, s[76:79], 0 offen offset:1536 sc1
    v_mov_b32 v16, 0
    v_mov_b32 v17, 0
    v_mov_b32 v18, 0
    v_mov_b32 v19, 0
    v_mov_b32 v20, 0x3f803f80
    v_dot2_f32_bf16 v16, v80, v20, v16
    v_dot2_f32_bf16 v17, v80, v80, v17
    v_dot2_f32_bf16 v18, v81, v20, v18
    v_dot2_f32_bf16 v19, v81, v81, v19
    v_dot2_f32_bf16 v16, v82, v20, v16
    v_dot2_f32_bf16 v17, v82, v82, v17
    v_dot2_f32_bf16 v18, v83, v20, v18
    v_dot2_f32_bf16 v19, v83, v83, v19
    v_dot2_f32_bf16 v16, v84, v20, v16
    v_dot2_f32_bf16 v17, v84, v84, v17
    v_dot2_f32_bf16 v18, v85, v20, v18
    v_dot2_f32_bf16 v19, v85, v85, v19
    v_dot2_f32_bf16 v16, v86, v20, v16
    v_dot2_f32_bf16 v17, v86, v86, v17
    v_dot2_f32_bf16 v18, v87, v20, v18
    v_dot2_f32_bf16 v19, v87, v87, v19
    v_dot2_f32_bf16 v16, v88, v20, v16
    v_dot2_f32_bf16 v17, v88, v88, v17
    v_dot2_f32_bf16 v18, v89, v20, v18
    v_dot2_f32_bf16 v19, v89, v89, v19
    v_dot2_f32_bf16 v16, v90, v20, v16
    v_dot2_f32_bf16 v17, v90, v90, v17
    v_dot2_f32_bf16 v18, v91, v20, v18
    v_dot2_f32_bf16 v19, v91, v91, v19
    v_dot2_f32_bf16 v16, v92, v20, v16
    v_dot2_f32_bf16 v17, v92, v92, v17
    v_dot2_f32_bf16 v18, v93, v20, v18
    v_dot2_f32_bf16 v19, v93, v93, v19
    v_dot2_f32_bf16 v16, v94, v20, v16
    v_dot2_f32_bf16 v17, v94, v94, v17
    v_dot2_f32_bf16 v18, v95, v20, v18
    v_dot2_f32_bf16 v19, v95, v95, v19
    s_nop 3
    v_pk_add_f32 v[16:17], v[16:17], v[18:19]
    v_mov_b32 v18, v16
    v_mov_b32 v19, v17
    s_nop 0
    v_permlane32_swap_b32 v16, v18
    v_permlane32_swap_b32 v17, v19
    v_pk_add_f32 v[16:17], v[16:17], v[18:19]
    buffer_store_dwordx2 v[16:17], v11, s[80:83], 0 offen sc1
    s_lshl_b32 s21, s16, 3
    s_add_u32 s21, s21, 1
    s_lshl_b32 s21, s21, 3
    s_add_u32 s21, s21, s18
    s_lshl_b32 s21, s21, 3
    s_add_u32 s21, s21, s29
    s_lshl_b32 s21, s21, 5
    s_add_u32 s21, s21, s28
    v_mov_b32 v20, s21
    v_mov_b32 v21, 1
    s_waitcnt vmcnt(0)
    s_mov_b64 exec, 1
    s_cmp_eq_u32 s17, 0
    s_cbranch_scc1 L_sigslow_26
    buffer_store_byte v21, v20, s[72:75], 0 offen
    s_branch L_sigdone_27
L_sigslow_26:
    buffer_store_byte v21, v20, s[72:75], 0 offen sc1
L_sigdone_27:
    s_mov_b64 exec, -1
L_p3_done:
    s_cmp_lt_u32 s19, 27
    s_cbranch_scc1 L_p4_go
    s_barrier
    s_cmp_lg_u32 s16, 0
    s_cbranch_scc1 L_wc4_28
    s_cmp_lt_u32 s19, 31
    s_cbranch_scc1 L_wc_29
    s_getpc_b64 s[22:23]
L_pc_30:
    s_sub_u32 s22, s22, L_pc_30-interleave_layers__sliding_block__glu_gated_geglu__prompt_kernel
    s_subb_u32 s23, s23, 0
    v_lshlrev_b32 v6, 4, v0
L_wcl_31:
    v_min_u32 v7, L_code_end-interleave_layers__sliding_block__glu_gated_geglu__prompt_kernel-16, v6
    v_mov_b32 v5, s23
    v_add_co_u32 v4, vcc, s22, v7
    s_nop 1
    v_addc_co_u32 v5, vcc, 0, v5, vcc
    global_load_dwordx4 v[8:11], v[4:5], off
    v_add_u32 v6, 8192, v6
    s_nop 0
    v_readfirstlane_b32 s21, v6
    s_cmp_lt_u32 s21, L_code_end-interleave_layers__sliding_block__glu_gated_geglu__prompt_kernel
    s_cbranch_scc1 L_wcl_31
    s_waitcnt vmcnt(0)
    s_nop 1
L_wc_29:
L_wc4_28:
    s_branch L_p4_done
L_p4_go:
    s_xor_b32 s28, s20, 0
    s_lshl_b32 s24, s28, 5
    s_lshl_b32 s27, s18, 8
    s_add_u32 s27, s27, s24
    s_and_b32 s26, s20, 3
    s_lshr_b32 s29, s20, 2
    v_lshrrev_b32 v24, 4, v2
    s_lshr_b32 s21, s27, 4
    v_add_u32 v24, s21, v24
    s_mov_b32 s21, 20480
    v_mul_lo_u32 v4, v24, s21
    v_lshl_add_u32 v4, v3, 8, v4
    v_and_b32 v24, 15, v2
    v_lshl_add_u32 v4, v24, 4, v4
    s_lshl_b32 s25, s19, 7
    v_lshrrev_b32 v24, 3, v1
    v_lshlrev_b32 v24, 2, v24
    v_add_u32 v24, s26, v24
    v_mul_u32_u24 v24, 3456, v24
    v_and_b32 v25, 7, v1
    v_lshl_add_u32 v24, v25, 4, v24
    v_add_u32 v6, s25, v24
    v_add_u32 v7, 110592, v6
    v_bfe_u32 v24, v1, 2, 2
    v_mul_u32_u24 v8, 2112, v24
    v_mul_u32_u24 v24, 128, v3
    v_add_u32 v8, v8, v24
    v_bfe_u32 v24, v1, 4, 1
    v_mul_u32_u24 v24, 8480, v24
    v_add_u32 v8, v8, v24
    v_and_b32 v24, 3, v1
    v_lshl_add_u32 v8, v24, 3, v8
    v_add_u32 v9, 50880, v8
    v_add_u32 v10, 101760, v8
    v_add_u32 v24, s24, v2
    v_lshlrev_b32 v11, 3, v24
    v_mul_u32_u24 v24, 10240, v3
    v_add_u32 v11, v11, v24
    s_mul_i32 s21, s18, 20480
    v_add_u32 v11, s21, v11
    v_lshrrev_b32 v24, 4, v2
    s_lshr_b32 s21, s27, 4
    v_add_u32 v24, s21, v24
    s_mov_b32 s21, 55296
    v_mul_lo_u32 v13, v24, s21
    v_lshl_add_u32 v13, v3, 8, v13
    v_and_b32 v24, 15, v2
    v_lshl_add_u32 v13, v24, 4, v13
    s_lshl_b32 s21, s19, 11
    v_add_u32 v13, s21, v13
    v_lshlrev_b32 v12, 4, v3
    v_add_u32 v12, 162304, v12
    s_mul_i32 s32, s26, 2112
    s_mul_i32 s21, s29, 8480
    s_add_u32 s32, s32, s21
    s_lshl_b32 s21, s26, 5
    s_mul_i32 s22, s29, 1024
    s_add_u32 s21, s21, s22
    v_add_u32 v144, s21, v8
    v_add_u32 v145, 50880, v144
    v_add_u32 v146, 101760, v144
    v_mov_b32 v148, 0
    v_mov_b32 v149, 0
    v_mov_b32 v164, 0x3f803f80
    s_mul_i32 s21, s18, 10
    s_lshr_b32 s21, s21, 3
    s_lshl_b32 s30, s21, 11
    s_add_u32 s21, s21, 4
    s_cmp_ge_u32 s21, 10
    s_cselect_b32 s22, 10, 0
    s_sub_u32 s21, s21, s22
    s_mul_i32 s31, s21, 221184
    s_cmp_eq_u32 s29, 0
    s_cselect_b32 s22, s92, s94
    s_cselect_b32 s23, s93, s95
    s_add_u32 s12, s22, 0x0
    s_addc_u32 s13, s23, 0
    s_mov_b32 s14, 0x21c000
    s_mov_b32 s15, 0x20000
    s_add_u32 s8, s6, 0x300000
    s_addc_u32 s9, s7, 0
    s_mov_b32 s10, 0x280000
    s_mov_b32 s11, 0x20000
    s_add_u32 s36, s6, 0x1840000
    s_addc_u32 s37, s7, 0
    s_mov_b32 s38, 0x28000
    s_mov_b32 s39, 0x20000
    s_add_u32 s80, s6, 0x900000
    s_addc_u32 s81, s7, 0
    s_mov_b32 s82, 0x6c0000
    s_mov_b32 s83, 0x20000
    s_cmp_ge_u32 s20, 4
    s_cbranch_scc1 L_prio_32
    s_setprio 1
L_prio_32:
    v_and_b32 v25, 7, v1
    v_lshlrev_b32 v26, 5, v25
    v_mov_b32 v24, 0
    v_cmp_eq_u32 vcc, 2, v25
    v_mov_b32 v26, 0x101
    s_nop 0
    v_cndmask_b32 v24, v24, v26, vcc
    v_subrev_u32 v26, 0, v25
    v_cmp_gt_u32 vcc, 2, v26
    v_mov_b32 v26, 0x01010101
    s_nop 0
    v_cndmask_b32 v24, v24, v26, vcc
    v_lshlrev_b32 v25, 2, v25
    s_add_u32 s21, s16, 0x0
    s_lshl_b32 s21, s21, 3
    s_add_u32 s21, s21, 1
    s_lshl_b32 s21, s21, 3
    s_add_u32 s21, s21, s18
    s_lshl_b32 s21, s21, 3
    s_add_u32 s21, s21, s28
    s_lshl_b32 s21, s21, 5
    s_mov_b32 s35, 0
L_wl_33:
    buffer_load_dword v26, v25, s[72:75], s21 offen sc1
    s_waitcnt vmcnt(0)
    v_and_b32 v26, v26, v24
    v_cmp_ne_u32 vcc, v26, v24
    s_add_u32 s35, s35, 1
    s_cmp_gt_u32 s35, 65536
    s_cbranch_scc1 L_wlx_34
    s_cbranch_vccz L_wlx_34
    s_sleep 2
    s_branch L_wl_33
L_wlx_34:
    s_cmp_lg_u32 s17, 0
    s_cbranch_scc1 L_acq_35
    buffer_inv sc1
    s_waitcnt vmcnt(0)
L_acq_35:
    buffer_load_dwordx4 v[168:171], v4, s[8:11], s30 offen offset:0 sc1
    buffer_load_dwordx4 v[172:175], v4, s[8:11], s30 offen offset:512 sc1
    buffer_load_dwordx4 v[176:179], v4, s[8:11], s30 offen offset:1024 sc1
    buffer_load_dwordx4 v[180:183], v4, s[8:11], s30 offen offset:1536 sc1
    s_add_u32 s30, s30, 2048
    s_cmp_ge_u32 s30, 20480
    s_cselect_b32 s30, 0, s30
    s_barrier
    s_add_u32 m0, s32, 67840
    s_nop 0
    buffer_load_dwordx4 v6, s[12:15], s31 offen lds
    s_add_u32 m0, s32, 68864
    s_nop 0
    buffer_load_dwordx4 v7, s[12:15], s31 offen lds
    s_add_u32 s31, s31, 221184
    s_cmp_ge_u32 s31, 2211840
    s_cselect_b32 s31, 0, s31
    ds_read_b64_tr_b16 v[40:41], v8 offset:0
    ds_read_b64_tr_b16 v[42:43], v8 offset:512
    ds_read_b64_tr_b16 v[44:45], v8 offset:32
    ds_read_b64_tr_b16 v[46:47], v8 offset:544
    ds_read_b64_tr_b16 v[48:49], v8 offset:64
    ds_read_b64_tr_b16 v[50:51], v8 offset:576
    ds_read_b64_tr_b16 v[52:53], v8 offset:96
    ds_read_b64_tr_b16 v[54:55], v8 offset:608
    s_waitcnt vmcnt(5)
    s_waitcnt lgkmcnt(6)
    v_mfma_f32_32x32x16_bf16 v[72:87], v[40:43], v[168:171], 0
    ds_read_b64_tr_b16 v[56:57], v8 offset:256
    ds_read_b64_tr_b16 v[58:59], v8 offset:768
    s_waitcnt lgkmcnt(6)
    v_mfma_f32_32x32x16_bf16 v[88:103], v[44:47], v[168:171], 0
    ds_read_b64_tr_b16 v[60:61], v8 offset:288
    ds_read_b64_tr_b16 v[62:63], v8 offset:800
    s_waitcnt lgkmcnt(6)
    v_mfma_f32_32x32x16_bf16 v[104:119], v[48:51], v[168:171], 0
    ds_read_b64_tr_b16 v[64:65], v8 offset:320
    ds_read_b64_tr_b16 v[66:67], v8 offset:832
    buffer_load_dwordx4 v[184:187], v4, s[8:11], s30 offen offset:0 sc1
    s_waitcnt lgkmcnt(6)
    v_mfma_f32_32x32x16_bf16 v[120:135], v[52:55], v[168:171], 0
    ds_read_b64_tr_b16 v[68:69], v8 offset:352
    ds_read_b64_tr_b16 v[70:71], v8 offset:864
    s_waitcnt vmcnt(5)
    s_waitcnt lgkmcnt(6)
    v_mfma_f32_32x32x16_bf16 v[72:87], v[56:59], v[172:175], v[72:87]
    ds_read_b64_tr_b16 v[40:41], v8 offset:1024
    ds_read_b64_tr_b16 v[42:43], v8 offset:1536
    buffer_load_dwordx4 v[188:191], v4, s[8:11], s30 offen offset:512 sc1
    s_waitcnt lgkmcnt(6)
    v_mfma_f32_32x32x16_bf16 v[88:103], v[60:63], v[172:175], v[88:103]
    ds_read_b64_tr_b16 v[44:45], v8 offset:1056
    ds_read_b64_tr_b16 v[46:47], v8 offset:1568
    s_waitcnt lgkmcnt(6)
    v_mfma_f32_32x32x16_bf16 v[104:119], v[64:67], v[172:175], v[104:119]
    ds_read_b64_tr_b16 v[48:49], v8 offset:1088
    ds_read_b64_tr_b16 v[50:51], v8 offset:1600
    buffer_load_dwordx4 v[192:195], v4, s[8:11], s30 offen offset:1024 sc1
    s_waitcnt lgkmcnt(6)
    v_mfma_f32_32x32x16_bf16 v[120:135], v[68:71], v[172:175], v[120:135]
    ds_read_b64_tr_b16 v[52:53], v8 offset:1120
    ds_read_b64_tr_b16 v[54:55], v8 offset:1632
    s_waitcnt vmcnt(6)
    s_waitcnt lgkmcnt(6)
    v_mfma_f32_32x32x16_bf16 v[72:87], v[40:43], v[176:179], v[72:87]
    ds_read_b64_tr_b16 v[56:57], v8 offset:1280
    ds_read_b64_tr_b16 v[58:59], v8 offset:1792
    s_waitcnt lgkmcnt(6)
    v_mfma_f32_32x32x16_bf16 v[88:103], v[44:47], v[176:179], v[88:103]
    ds_read_b64_tr_b16 v[60:61], v8 offset:1312
    ds_read_b64_tr_b16 v[62:63], v8 offset:1824
    buffer_load_dwordx4 v[196:199], v4, s[8:11], s30 offen offset:1536 sc1
    s_add_u32 s30, s30, 2048
    s_cmp_ge_u32 s30, 20480
    s_cselect_b32 s30, 0, s30
    s_waitcnt lgkmcnt(6)
    v_mfma_f32_32x32x16_bf16 v[104:119], v[48:51], v[176:179], v[104:119]
    ds_read_b64_tr_b16 v[64:65], v8 offset:1344
    ds_read_b64_tr_b16 v[66:67], v8 offset:1856
    s_waitcnt lgkmcnt(6)
    v_mfma_f32_32x32x16_bf16 v[120:135], v[52:55], v[176:179], v[120:135]
    ds_read_b64_tr_b16 v[68:69], v8 offset:1376
    ds_read_b64_tr_b16 v[70:71], v8 offset:1888
    s_add_u32 m0, s32, 84800
    s_nop 0
    buffer_load_dwordx4 v6, s[12:15], s31 offen lds
    s_waitcnt vmcnt(7)
    s_waitcnt lgkmcnt(6)
    v_mfma_f32_32x32x16_bf16 v[72:87], v[56:59], v[180:183], v[72:87]
    ds_read_b64_tr_b16 v[40:41], v8 offset:16960
    ds_read_b64_tr_b16 v[42:43], v8 offset:17472
    s_waitcnt lgkmcnt(6)
    v_mfma_f32_32x32x16_bf16 v[88:103], v[60:63], v[180:183], v[88:103]
    ds_read_b64_tr_b16 v[44:45], v8 offset:16992
    ds_read_b64_tr_b16 v[46:47], v8 offset:17504
    s_add_u32 m0, s32, 85824
    s_nop 0
    buffer_load_dwordx4 v7, s[12:15], s31 offen lds
    s_add_u32 s31, s31, 221184
    s_cmp_ge_u32 s31, 2211840
    s_cselect_b32 s31, 0, s31
    s_waitcnt lgkmcnt(6)
    v_mfma_f32_32x32x16_bf16 v[104:119], v[64:67], v[180:183], v[104:119]
    ds_read_b64_tr_b16 v[48:49], v8 offset:17024
    ds_read_b64_tr_b16 v[50:51], v8 offset:17536
    s_waitcnt lgkmcnt(6)
    v_mfma_f32_32x32x16_bf16 v[120:135], v[68:71], v[180:183], v[120:135]
    ds_read_b64_tr_b16 v[52:53], v8 offset:17056
    ds_read_b64_tr_b16 v[54:55], v8 offset:17568
    buffer_load_dwordx4 v[200:203], v4, s[8:11], s30 offen offset:0 sc1
    s_cmp_lg_u32 s16, 0
    s_cbranch_scc1 L_p4cs_36
    ds_read_b64_tr_b16 v[156:157], v144 offset:0
    ds_read_b64_tr_b16 v[158:159], v144 offset:256
    ds_read_b64_tr_b16 v[160:161], v144 offset:512
    ds_read_b64_tr_b16 v[162:163], v144 offset:768
    s_waitcnt lgkmcnt(0)
    v_dot2_f32_bf16 v148, v156, v164, v148
    v_dot2_f32_bf16 v149, v157, v164, v149
    v_dot2_f32_bf16 v148, v158, v164, v148
    v_dot2_f32_bf16 v149, v159, v164, v149
    v_dot2_f32_bf16 v148, v160, v164, v148
    v_dot2_f32_bf16 v149, v161, v164, v149
    v_dot2_f32_bf16 v148, v162, v164, v148
    v_dot2_f32_bf16 v149, v163, v164, v149
    s_nop 1
L_p4cs_36:
    s_waitcnt vmcnt(6)
    s_waitcnt lgkmcnt(6)
    v_mfma_f32_32x32x16_bf16 v[72:87], v[40:43], v[184:187], v[72:87]
    ds_read_b64_tr_b16 v[56:57], v8 offset:17216
    ds_read_b64_tr_b16 v[58:59], v8 offset:17728
    s_waitcnt lgkmcnt(6)
    v_mfma_f32_32x32x16_bf16 v[88:103], v[44:47], v[184:187], v[88:103]
    ds_read_b64_tr_b16 v[60:61], v8 offset:17248
    ds_read_b64_tr_b16 v[62:63], v8 offset:17760
    s_waitcnt lgkmcnt(6)
    v_mfma_f32_32x32x16_bf16 v[104:119], v[48:51], v[184:187], v[104:119]
    ds_read_b64_tr_b16 v[64:65], v8 offset:17280
    ds_read_b64_tr_b16 v[66:67], v8 offset:17792
    buffer_load_dwordx4 v[204:207], v4, s[8:11], s30 offen offset:512 sc1
    s_waitcnt lgkmcnt(6)
    v_mfma_f32_32x32x16_bf16 v[120:135], v[52:55], v[184:187], v[120:135]
    ds_read_b64_tr_b16 v[68:69], v8 offset:17312
    ds_read_b64_tr_b16 v[70:71], v8 offset:17824
    s_waitcnt vmcnt(6)
    s_waitcnt lgkmcnt(6)
    v_mfma_f32_32x32x16_bf16 v[72:87], v[56:59], v[188:191], v[72:87]
    ds_read_b64_tr_b16 v[40:41], v8 offset:17984
    ds_read_b64_tr_b16 v[42:43], v8 offset:18496
    buffer_load_dwordx4 v[208:211], v4, s[8:11], s30 offen offset:1024 sc1
    s_waitcnt lgkmcnt(6)
    v_mfma_f32_32x32x16_bf16 v[88:103], v[60:63], v[188:191], v[88:103]
    ds_read_b64_tr_b16 v[44:45], v8 offset:18016
    ds_read_b64_tr_b16 v[46:47], v8 offset:18528
    s_waitcnt lgkmcnt(6)
    v_mfma_f32_32x32x16_bf16 v[104:119], v[64:67], v[188:191], v[104:119]
    ds_read_b64_tr_b16 v[48:49], v8 offset:18048
    ds_read_b64_tr_b16 v[50:51], v8 offset:18560
    buffer_load_dwordx4 v[212:215], v4, s[8:11], s30 offen offset:1536 sc1
    s_add_u32 s30, s30, 2048
    s_cmp_ge_u32 s30, 20480
    s_cselect_b32 s30, 0, s30
    s_waitcnt lgkmcnt(6)
    v_mfma_f32_32x32x16_bf16 v[120:135], v[68:71], v[188:191], v[120:135]
    ds_read_b64_tr_b16 v[52:53], v8 offset:18080
    ds_read_b64_tr_b16 v[54:55], v8 offset:18592
    s_waitcnt vmcnt(7)
    s_waitcnt lgkmcnt(6)
    v_mfma_f32_32x32x16_bf16 v[72:87], v[40:43], v[192:195], v[72:87]
    ds_read_b64_tr_b16 v[56:57], v8 offset:18240
    ds_read_b64_tr_b16 v[58:59], v8 offset:18752
    s_waitcnt lgkmcnt(6)
    v_mfma_f32_32x32x16_bf16 v[88:103], v[44:47], v[192:195], v[88:103]
    ds_read_b64_tr_b16 v[60:61], v8 offset:18272
    ds_read_b64_tr_b16 v[62:63], v8 offset:18784
    s_add_u32 m0, s32, 101760
    s_nop 0
    buffer_load_dwordx4 v6, s[12:15], s31 offen lds
    s_waitcnt lgkmcnt(6)
    v_mfma_f32_32x32x16_bf16 v[104:119], v[48:51], v[192:195], v[104:119]
    ds_read_b64_tr_b16 v[64:65], v8 offset:18304
    ds_read_b64_tr_b16 v[66:67], v8 offset:18816
    s_waitcnt lgkmcnt(6)
    v_mfma_f32_32x32x16_bf16 v[120:135], v[52:55], v[192:195], v[120:135]
    ds_read_b64_tr_b16 v[68:69], v8 offset:18336
    ds_read_b64_tr_b16 v[70:71], v8 offset:18848
    s_add_u32 m0, s32, 102784
    s_nop 0
    buffer_load_dwordx4 v7, s[12:15], s31 offen lds
    s_add_u32 s31, s31, 221184
    s_cmp_ge_u32 s31, 2211840
    s_cselect_b32 s31, 0, s31
    s_waitcnt vmcnt(8)
    s_waitcnt lgkmcnt(6)
    v_mfma_f32_32x32x16_bf16 v[72:87], v[56:59], v[196:199], v[72:87]
    ds_read_b64_tr_b16 v[40:41], v8 offset:33920
    ds_read_b64_tr_b16 v[42:43], v8 offset:34432
    s_waitcnt lgkmcnt(6)
    v_mfma_f32_32x32x16_bf16 v[88:103], v[60:63], v[196:199], v[88:103]
    ds_read_b64_tr_b16 v[44:45], v8 offset:33952
    ds_read_b64_tr_b16 v[46:47], v8 offset:34464
    s_mov_b32 s21, 0
    buffer_load_dwordx2 v[24:25], v11, s[36:39], s21 offen sc1
    s_waitcnt lgkmcnt(6)
    v_mfma_f32_32x32x16_bf16 v[104:119], v[64:67], v[196:199], v[104:119]
    ds_read_b64_tr_b16 v[48:49], v8 offset:33984
    ds_read_b64_tr_b16 v[50:51], v8 offset:34496
    s_mov_b32 s21, 2048
    buffer_load_dwordx2 v[26:27], v11, s[36:39], s21 offen sc1
    s_mov_b32 s21, 4096
    buffer_load_dwordx2 v[28:29], v11, s[36:39], s21 offen sc1
    s_waitcnt lgkmcnt(6)
    v_mfma_f32_32x32x16_bf16 v[120:135], v[68:71], v[196:199], v[120:135]
    ds_read_b64_tr_b16 v[52:53], v8 offset:34016
    ds_read_b64_tr_b16 v[54:55], v8 offset:34528
    s_mov_b32 s21, 6144
    buffer_load_dwordx2 v[30:31], v11, s[36:39], s21 offen sc1
    s_mov_b32 s21, 8192
    buffer_load_dwordx2 v[32:33], v11, s[36:39], s21 offen sc1
    s_cmp_lg_u32 s16, 0
    s_cbranch_scc1 L_p4cs_37
    ds_read_b64_tr_b16 v[156:157], v144 offset:16960
    ds_read_b64_tr_b16 v[158:159], v144 offset:17216
    ds_read_b64_tr_b16 v[160:161], v144 offset:17472
    ds_read_b64_tr_b16 v[162:163], v144 offset:17728
    s_waitcnt lgkmcnt(0)
    v_dot2_f32_bf16 v148, v156, v164, v148
    v_dot2_f32_bf16 v149, v157, v164, v149
    v_dot2_f32_bf16 v148, v158, v164, v148
    v_dot2_f32_bf16 v149, v159, v164, v149
    v_dot2_f32_bf16 v148, v160, v164, v148
    v_dot2_f32_bf16 v149, v161, v164, v149
    v_dot2_f32_bf16 v148, v162, v164, v148
    v_dot2_f32_bf16 v149, v163, v164, v149
    s_nop 1
L_p4cs_37:
    s_waitcnt vmcnt(10)
    s_waitcnt lgkmcnt(6)
    v_mfma_f32_32x32x16_bf16 v[72:87], v[40:43], v[200:203], v[72:87]
    ds_read_b64_tr_b16 v[56:57], v8 offset:34176
    ds_read_b64_tr_b16 v[58:59], v8 offset:34688
    buffer_load_dwordx4 v[216:219], v4, s[8:11], s30 offen offset:0 sc1
    s_waitcnt lgkmcnt(6)
    v_mfma_f32_32x32x16_bf16 v[88:103], v[44:47], v[200:203], v[88:103]
    ds_read_b64_tr_b16 v[60:61], v8 offset:34208
    ds_read_b64_tr_b16 v[62:63], v8 offset:34720
    s_waitcnt lgkmcnt(6)
    v_mfma_f32_32x32x16_bf16 v[104:119], v[48:51], v[200:203], v[104:119]
    ds_read_b64_tr_b16 v[64:65], v8 offset:34240
    ds_read_b64_tr_b16 v[66:67], v8 offset:34752
    buffer_load_dwordx4 v[220:223], v4, s[8:11], s30 offen offset:512 sc1
    s_waitcnt lgkmcnt(6)
    v_mfma_f32_32x32x16_bf16 v[120:135], v[52:55], v[200:203], v[120:135]
    ds_read_b64_tr_b16 v[68:69], v8 offset:34272
    ds_read_b64_tr_b16 v[70:71], v8 offset:34784
    s_waitcnt vmcnt(11)
    s_waitcnt lgkmcnt(6)
    v_mfma_f32_32x32x16_bf16 v[72:87], v[56:59], v[204:207], v[72:87]
    ds_read_b64_tr_b16 v[40:41], v8 offset:34944
    ds_read_b64_tr_b16 v[42:43], v8 offset:35456
    s_waitcnt lgkmcnt(6)
    v_mfma_f32_32x32x16_bf16 v[88:103], v[60:63], v[204:207], v[88:103]
    ds_read_b64_tr_b16 v[44:45], v8 offset:34976
    ds_read_b64_tr_b16 v[46:47], v8 offset:35488
    buffer_load_dwordx4 v[224:227], v4, s[8:11], s30 offen offset:1024 sc1
    s_waitcnt lgkmcnt(6)
    v_mfma_f32_32x32x16_bf16 v[104:119], v[64:67], v[204:207], v[104:119]
    ds_read_b64_tr_b16 v[48:49], v8 offset:35008
    ds_read_b64_tr_b16 v[50:51], v8 offset:35520
    s_waitcnt lgkmcnt(6)
    v_mfma_f32_32x32x16_bf16 v[120:135], v[68:71], v[204:207], v[120:135]
    ds_read_b64_tr_b16 v[52:53], v8 offset:35040
    ds_read_b64_tr_b16 v[54:55], v8 offset:35552
    buffer_load_dwordx4 v[228:231], v4, s[8:11], s30 offen offset:1536 sc1
    s_add_u32 s30, s30, 2048
    s_cmp_ge_u32 s30, 20480
    s_cselect_b32 s30, 0, s30
    s_waitcnt vmcnt(12)
    s_waitcnt lgkmcnt(6)
    v_mfma_f32_32x32x16_bf16 v[72:87], v[40:43], v[208:211], v[72:87]
    ds_read_b64_tr_b16 v[56:57], v8 offset:35200
    ds_read_b64_tr_b16 v[58:59], v8 offset:35712
    s_waitcnt lgkmcnt(6)
    v_mfma_f32_32x32x16_bf16 v[88:103], v[44:47], v[208:211], v[88:103]
    ds_read_b64_tr_b16 v[60:61], v8 offset:35232
    ds_read_b64_tr_b16 v[62:63], v8 offset:35744
    s_add_u32 m0, s32, 118720
    s_nop 0
    buffer_load_dwordx4 v6, s[12:15], s31 offen lds
    s_waitcnt lgkmcnt(6)
    v_mfma_f32_32x32x16_bf16 v[104:119], v[48:51], v[208:211], v[104:119]
    ds_read_b64_tr_b16 v[64:65], v8 offset:35264
    ds_read_b64_tr_b16 v[66:67], v8 offset:35776
    s_waitcnt lgkmcnt(6)
    v_mfma_f32_32x32x16_bf16 v[120:135], v[52:55], v[208:211], v[120:135]
    ds_read_b64_tr_b16 v[68:69], v8 offset:35296
    ds_read_b64_tr_b16 v[70:71], v8 offset:35808
    s_add_u32 m0, s32, 119744
    s_nop 0
    buffer_load_dwordx4 v7, s[12:15], s31 offen lds
    s_add_u32 s31, s31, 221184
    s_cmp_ge_u32 s31, 2211840
    s_cselect_b32 s31, 0, s31
    s_waitcnt vmcnt(13)
    s_waitcnt lgkmcnt(6)
    v_mfma_f32_32x32x16_bf16 v[72:87], v[56:59], v[212:215], v[72:87]
    ds_read_b64_tr_b16 v[40:41], v9 offset:0
    ds_read_b64_tr_b16 v[42:43], v9 offset:512
    s_waitcnt lgkmcnt(6)
    v_mfma_f32_32x32x16_bf16 v[88:103], v[60:63], v[212:215], v[88:103]
    ds_read_b64_tr_b16 v[44:45], v9 offset:32
    ds_read_b64_tr_b16 v[46:47], v9 offset:544
    s_waitcnt lgkmcnt(6)
    v_mfma_f32_32x32x16_bf16 v[104:119], v[64:67], v[212:215], v[104:119]
    ds_read_b64_tr_b16 v[48:49], v9 offset:64
    ds_read_b64_tr_b16 v[50:51], v9 offset:576
    buffer_load_dwordx4 v[232:235], v4, s[8:11], s30 offen offset:0 sc1
    s_waitcnt lgkmcnt(6)
    v_mfma_f32_32x32x16_bf16 v[120:135], v[68:71], v[212:215], v[120:135]
    ds_read_b64_tr_b16 v[52:53], v9 offset:96
    ds_read_b64_tr_b16 v[54:55], v9 offset:608
    s_cmp_lg_u32 s16, 0
    s_cbranch_scc1 L_p4cs_38
    ds_read_b64_tr_b16 v[156:157], v144 offset:33920
    ds_read_b64_tr_b16 v[158:159], v144 offset:34176
    ds_read_b64_tr_b16 v[160:161], v144 offset:34432
    ds_read_b64_tr_b16 v[162:163], v144 offset:34688
    s_waitcnt lgkmcnt(0)
    v_dot2_f32_bf16 v148, v156, v164, v148
    v_dot2_f32_bf16 v149, v157, v164, v149
    v_dot2_f32_bf16 v148, v158, v164, v148
    v_dot2_f32_bf16 v149, v159, v164, v149
    v_dot2_f32_bf16 v148, v160, v164, v148
    v_dot2_f32_bf16 v149, v161, v164, v149
    v_dot2_f32_bf16 v148, v162, v164, v148
    v_dot2_f32_bf16 v149, v163, v164, v149
    s_nop 1
L_p4cs_38:
    s_mov_b32 s34, s30
    s_mov_b32 s25, s31
    s_mul_i32 s21, s18, 27
    s_lshr_b32 s21, s21, 3
    s_lshl_b32 s30, s21, 11
    s_mul_i32 s31, s21, 81920
    s_mov_b32 s33, s31
    s_mov_b32 s30, s34
    s_mov_b32 s31, s25
    s_mul_i32 s25, s19, 171
    s_lshr_b32 s25, s25, 9
    s_lshl_b32 s25, s25, 7
    s_mul_i32 s21, s29, 40960
    s_add_u32 s25, s25, s21
    v_lshrrev_b32 v136, 3, v1
    v_lshlrev_b32 v136, 2, v136
    v_add_u32 v136, s26, v136
    v_mul_u32_u24 v136, 1280, v136
    v_and_b32 v137, 7, v1
    v_lshl_add_u32 v136, v137, 4, v136
    v_add_u32 v165, s25, v136
    s_mul_i32 s34, s26, 2112
    s_lshl_b32 s21, s29, 10
    s_add_u32 s34, s34, s21
    s_add_u32 s34, s34, 16960
    s_add_u32 s76, s96, 0x0
    s_addc_u32 s77, s97, 0
    s_mov_b32 s78, 0x21c000
    s_mov_b32 s79, 0x20000
    s_waitcnt vmcnt(6)
    s_waitcnt lgkmcnt(6)
    v_mfma_f32_32x32x16_bf16 v[72:87], v[40:43], v[216:219], v[72:87]
    ds_read_b64_tr_b16 v[56:57], v9 offset:256
    ds_read_b64_tr_b16 v[58:59], v9 offset:768
    buffer_load_dwordx4 v[236:239], v4, s[8:11], s30 offen offset:512 sc1
    s_waitcnt lgkmcnt(6)
    v_mfma_f32_32x32x16_bf16 v[88:103], v[44:47], v[216:219], v[88:103]
    ds_read_b64_tr_b16 v[60:61], v9 offset:288
    ds_read_b64_tr_b16 v[62:63], v9 offset:800
    s_waitcnt lgkmcnt(6)
    v_mfma_f32_32x32x16_bf16 v[104:119], v[48:51], v[216:219], v[104:119]
    ds_read_b64_tr_b16 v[64:65], v9 offset:320
    ds_read_b64_tr_b16 v[66:67], v9 offset:832
    buffer_load_dwordx4 v[240:243], v4, s[8:11], s30 offen offset:1024 sc1
    s_waitcnt lgkmcnt(6)
    v_mfma_f32_32x32x16_bf16 v[120:135], v[52:55], v[216:219], v[120:135]
    ds_read_b64_tr_b16 v[68:69], v9 offset:352
    ds_read_b64_tr_b16 v[70:71], v9 offset:864
    s_waitcnt vmcnt(7)
    s_waitcnt lgkmcnt(6)
    v_mfma_f32_32x32x16_bf16 v[72:87], v[56:59], v[220:223], v[72:87]
    ds_read_b64_tr_b16 v[40:41], v9 offset:1024
    ds_read_b64_tr_b16 v[42:43], v9 offset:1536
    s_waitcnt lgkmcnt(6)
    v_mfma_f32_32x32x16_bf16 v[88:103], v[60:63], v[220:223], v[88:103]
    ds_read_b64_tr_b16 v[44:45], v9 offset:1056
    ds_read_b64_tr_b16 v[46:47], v9 offset:1568
    buffer_load_dwordx4 v[244:247], v4, s[8:11], s30 offen offset:1536 sc1
    s_add_u32 s30, s30, 2048
    s_cmp_ge_u32 s30, 20480
    s_cselect_b32 s30, 0, s30
    s_waitcnt lgkmcnt(6)
    v_mfma_f32_32x32x16_bf16 v[104:119], v[64:67], v[220:223], v[104:119]
    ds_read_b64_tr_b16 v[48:49], v9 offset:1088
    ds_read_b64_tr_b16 v[50:51], v9 offset:1600
    s_waitcnt lgkmcnt(6)
    v_mfma_f32_32x32x16_bf16 v[120:135], v[68:71], v[220:223], v[120:135]
    ds_read_b64_tr_b16 v[52:53], v9 offset:1120
    ds_read_b64_tr_b16 v[54:55], v9 offset:1632
    s_add_u32 m0, s32, 135680
    s_nop 0
    buffer_load_dwordx4 v6, s[12:15], s31 offen lds
    s_waitcnt vmcnt(8)
    s_waitcnt lgkmcnt(6)
    v_mfma_f32_32x32x16_bf16 v[72:87], v[40:43], v[224:227], v[72:87]
    ds_read_b64_tr_b16 v[56:57], v9 offset:1280
    ds_read_b64_tr_b16 v[58:59], v9 offset:1792
    s_waitcnt lgkmcnt(6)
    v_mfma_f32_32x32x16_bf16 v[88:103], v[44:47], v[224:227], v[88:103]
    ds_read_b64_tr_b16 v[60:61], v9 offset:1312
    ds_read_b64_tr_b16 v[62:63], v9 offset:1824
    s_add_u32 m0, s32, 136704
    s_nop 0
    buffer_load_dwordx4 v7, s[12:15], s31 offen lds
    s_add_u32 s31, s31, 221184
    s_cmp_ge_u32 s31, 2211840
    s_cselect_b32 s31, 0, s31
    s_waitcnt lgkmcnt(6)
    v_mfma_f32_32x32x16_bf16 v[104:119], v[48:51], v[224:227], v[104:119]
    ds_read_b64_tr_b16 v[64:65], v9 offset:1344
    ds_read_b64_tr_b16 v[66:67], v9 offset:1856
    s_waitcnt lgkmcnt(6)
    v_mfma_f32_32x32x16_bf16 v[120:135], v[52:55], v[224:227], v[120:135]
    ds_read_b64_tr_b16 v[68:69], v9 offset:1376
    ds_read_b64_tr_b16 v[70:71], v9 offset:1888
    buffer_load_dwordx4 v[168:171], v4, s[8:11], s30 offen offset:0 sc1
    s_barrier
    s_waitcnt vmcnt(9)
    s_waitcnt lgkmcnt(6)
    v_mfma_f32_32x32x16_bf16 v[72:87], v[56:59], v[228:231], v[72:87]
    ds_read_b64_tr_b16 v[40:41], v9 offset:16960
    ds_read_b64_tr_b16 v[42:43], v9 offset:17472
    s_waitcnt lgkmcnt(6)
    v_mfma_f32_32x32x16_bf16 v[88:103], v[60:63], v[228:231], v[88:103]
    ds_read_b64_tr_b16 v[44:45], v9 offset:16992
    ds_read_b64_tr_b16 v[46:47], v9 offset:17504
    s_waitcnt lgkmcnt(6)
    v_mfma_f32_32x32x16_bf16 v[104:119], v[64:67], v[228:231], v[104:119]
    ds_read_b64_tr_b16 v[48:49], v9 offset:17024
    ds_read_b64_tr_b16 v[50:51], v9 offset:17536
    buffer_load_dwordx4 v[172:175], v4, s[8:11], s30 offen offset:512 sc1
    s_waitcnt lgkmcnt(6)
    v_mfma_f32_32x32x16_bf16 v[120:135], v[68:71], v[228:231], v[120:135]
    ds_read_b64_tr_b16 v[52:53], v9 offset:17056
    ds_read_b64_tr_b16 v[54:55], v9 offset:17568
    s_cmp_lg_u32 s16, 0
    s_cbranch_scc1 L_p4cs_39
    ds_read_b64_tr_b16 v[156:157], v145 offset:0
    ds_read_b64_tr_b16 v[158:159], v145 offset:256
    ds_read_b64_tr_b16 v[160:161], v145 offset:512
    ds_read_b64_tr_b16 v[162:163], v145 offset:768
    s_waitcnt lgkmcnt(0)
    v_dot2_f32_bf16 v148, v156, v164, v148
    v_dot2_f32_bf16 v149, v157, v164, v149
    v_dot2_f32_bf16 v148, v158, v164, v148
    v_dot2_f32_bf16 v149, v159, v164, v149
    v_dot2_f32_bf16 v148, v160, v164, v148
    v_dot2_f32_bf16 v149, v161, v164, v149
    v_dot2_f32_bf16 v148, v162, v164, v148
    v_dot2_f32_bf16 v149, v163, v164, v149
    s_nop 1
L_p4cs_39:
    s_waitcnt vmcnt(7)
    s_waitcnt lgkmcnt(6)
    v_mfma_f32_32x32x16_bf16 v[72:87], v[40:43], v[232:235], v[72:87]
    ds_read_b64_tr_b16 v[56:57], v9 offset:17216
    ds_read_b64_tr_b16 v[58:59], v9 offset:17728
    buffer_load_dwordx4 v[176:179], v4, s[8:11], s30 offen offset:1024 sc1
    s_waitcnt lgkmcnt(6)
    v_mfma_f32_32x32x16_bf16 v[88:103], v[44:47], v[232:235], v[88:103]
    ds_read_b64_tr_b16 v[60:61], v9 offset:17248
    ds_read_b64_tr_b16 v[62:63], v9 offset:17760
    s_waitcnt lgkmcnt(6)
    v_mfma_f32_32x32x16_bf16 v[104:119], v[48:51], v[232:235], v[104:119]
    ds_read_b64_tr_b16 v[64:65], v9 offset:17280
    ds_read_b64_tr_b16 v[66:67], v9 offset:17792
    buffer_load_dwordx4 v[180:183], v4, s[8:11], s30 offen offset:1536 sc1
    s_add_u32 s30, s30, 2048
    s_cmp_ge_u32 s30, 20480
    s_cselect_b32 s30, 0, s30
    s_waitcnt lgkmcnt(6)
    v_mfma_f32_32x32x16_bf16 v[120:135], v[52:55], v[232:235], v[120:135]
    ds_read_b64_tr_b16 v[68:69], v9 offset:17312
    ds_read_b64_tr_b16 v[70:71], v9 offset:17824
    s_waitcnt vmcnt(8)
    s_waitcnt lgkmcnt(6)
    v_mfma_f32_32x32x16_bf16 v[72:87], v[56:59], v[236:239], v[72:87]
    ds_read_b64_tr_b16 v[40:41], v9 offset:17984
    ds_read_b64_tr_b16 v[42:43], v9 offset:18496
    s_waitcnt lgkmcnt(6)
    v_mfma_f32_32x32x16_bf16 v[88:103], v[60:63], v[236:239], v[88:103]
    ds_read_b64_tr_b16 v[44:45], v9 offset:18016
    ds_read_b64_tr_b16 v[46:47], v9 offset:18528
    s_add_u32 m0, s32, 0
    s_nop 0
    buffer_load_dwordx4 v6, s[12:15], s31 offen lds
    s_waitcnt lgkmcnt(6)
    v_mfma_f32_32x32x16_bf16 v[104:119], v[64:67], v[236:239], v[104:119]
    ds_read_b64_tr_b16 v[48:49], v9 offset:18048
    ds_read_b64_tr_b16 v[50:51], v9 offset:18560
    s_waitcnt lgkmcnt(6)
    v_mfma_f32_32x32x16_bf16 v[120:135], v[68:71], v[236:239], v[120:135]
    ds_read_b64_tr_b16 v[52:53], v9 offset:18080
    ds_read_b64_tr_b16 v[54:55], v9 offset:18592
    s_add_u32 m0, s32, 1024
    s_nop 0
    buffer_load_dwordx4 v7, s[12:15], s31 offen lds
    s_waitcnt vmcnt(9)
    s_waitcnt lgkmcnt(6)
    v_mfma_f32_32x32x16_bf16 v[72:87], v[40:43], v[240:243], v[72:87]
    ds_read_b64_tr_b16 v[56:57], v9 offset:18240
    ds_read_b64_tr_b16 v[58:59], v9 offset:18752
    s_waitcnt lgkmcnt(6)
    v_mfma_f32_32x32x16_bf16 v[88:103], v[44:47], v[240:243], v[88:103]
    ds_read_b64_tr_b16 v[60:61], v9 offset:18272
    ds_read_b64_tr_b16 v[62:63], v9 offset:18784
    buffer_load_dwordx4 v[184:187], v4, s[8:11], s30 offen offset:0 sc1
    s_waitcnt lgkmcnt(6)
    v_mfma_f32_32x32x16_bf16 v[104:119], v[48:51], v[240:243], v[104:119]
    ds_read_b64_tr_b16 v[64:65], v9 offset:18304
    ds_read_b64_tr_b16 v[66:67], v9 offset:18816
    s_waitcnt lgkmcnt(6)
    v_mfma_f32_32x32x16_bf16 v[120:135], v[52:55], v[240:243], v[120:135]
    ds_read_b64_tr_b16 v[68:69], v9 offset:18336
    ds_read_b64_tr_b16 v[70:71], v9 offset:18848
    buffer_load_dwordx4 v[188:191], v4, s[8:11], s30 offen offset:512 sc1
    s_barrier
    s_waitcnt vmcnt(10)
    s_waitcnt lgkmcnt(6)
    v_mfma_f32_32x32x16_bf16 v[72:87], v[56:59], v[244:247], v[72:87]
    ds_read_b64_tr_b16 v[40:41], v9 offset:33920
    ds_read_b64_tr_b16 v[42:43], v9 offset:34432
    s_waitcnt lgkmcnt(6)
    v_mfma_f32_32x32x16_bf16 v[88:103], v[60:63], v[244:247], v[88:103]
    ds_read_b64_tr_b16 v[44:45], v9 offset:33952
    ds_read_b64_tr_b16 v[46:47], v9 offset:34464
    s_waitcnt lgkmcnt(6)
    v_mfma_f32_32x32x16_bf16 v[104:119], v[64:67], v[244:247], v[104:119]
    ds_read_b64_tr_b16 v[48:49], v9 offset:33984
    ds_read_b64_tr_b16 v[50:51], v9 offset:34496
    buffer_load_dwordx4 v[192:195], v4, s[8:11], s30 offen offset:1024 sc1
    s_waitcnt lgkmcnt(6)
    v_mfma_f32_32x32x16_bf16 v[120:135], v[68:71], v[244:247], v[120:135]
    ds_read_b64_tr_b16 v[52:53], v9 offset:34016
    ds_read_b64_tr_b16 v[54:55], v9 offset:34528
    s_cmp_lg_u32 s16, 0
    s_cbranch_scc1 L_p4cs_40
    ds_read_b64_tr_b16 v[156:157], v145 offset:16960
    ds_read_b64_tr_b16 v[158:159], v145 offset:17216
    ds_read_b64_tr_b16 v[160:161], v145 offset:17472
    ds_read_b64_tr_b16 v[162:163], v145 offset:17728
    s_waitcnt lgkmcnt(0)
    v_dot2_f32_bf16 v148, v156, v164, v148
    v_dot2_f32_bf16 v149, v157, v164, v149
    v_dot2_f32_bf16 v148, v158, v164, v148
    v_dot2_f32_bf16 v149, v159, v164, v149
    v_dot2_f32_bf16 v148, v160, v164, v148
    v_dot2_f32_bf16 v149, v161, v164, v149
    v_dot2_f32_bf16 v148, v162, v164, v148
    v_dot2_f32_bf16 v149, v163, v164, v149
    s_nop 1
L_p4cs_40:
    s_waitcnt vmcnt(8)
    s_waitcnt lgkmcnt(6)
    v_mfma_f32_32x32x16_bf16 v[72:87], v[40:43], v[168:171], v[72:87]
    ds_read_b64_tr_b16 v[56:57], v9 offset:34176
    ds_read_b64_tr_b16 v[58:59], v9 offset:34688
    buffer_load_dwordx4 v[196:199], v4, s[8:11], s30 offen offset:1536 sc1
    s_add_u32 s30, s30, 2048
    s_cmp_ge_u32 s30, 20480
    s_cselect_b32 s30, 0, s30
    s_waitcnt lgkmcnt(6)
    v_mfma_f32_32x32x16_bf16 v[88:103], v[44:47], v[168:171], v[88:103]
    ds_read_b64_tr_b16 v[60:61], v9 offset:34208
    ds_read_b64_tr_b16 v[62:63], v9 offset:34720
    s_waitcnt lgkmcnt(6)
    v_mfma_f32_32x32x16_bf16 v[104:119], v[48:51], v[168:171], v[104:119]
    ds_read_b64_tr_b16 v[64:65], v9 offset:34240
    ds_read_b64_tr_b16 v[66:67], v9 offset:34752
    buffer_load_dwordx4 v[200:203], v4, s[8:11], s30 offen offset:0 sc1
    s_waitcnt lgkmcnt(6)
    v_mfma_f32_32x32x16_bf16 v[120:135], v[52:55], v[168:171], v[120:135]
    ds_read_b64_tr_b16 v[68:69], v9 offset:34272
    ds_read_b64_tr_b16 v[70:71], v9 offset:34784
    s_waitcnt vmcnt(9)
    s_waitcnt lgkmcnt(6)
    v_mfma_f32_32x32x16_bf16 v[72:87], v[56:59], v[172:175], v[72:87]
    ds_read_b64_tr_b16 v[40:41], v9 offset:34944
    ds_read_b64_tr_b16 v[42:43], v9 offset:35456
    s_waitcnt lgkmcnt(6)
    v_mfma_f32_32x32x16_bf16 v[88:103], v[60:63], v[172:175], v[88:103]
    ds_read_b64_tr_b16 v[44:45], v9 offset:34976
    ds_read_b64_tr_b16 v[46:47], v9 offset:35488
    buffer_load_dwordx4 v[204:207], v4, s[8:11], s30 offen offset:512 sc1
    s_waitcnt lgkmcnt(6)
    v_mfma_f32_32x32x16_bf16 v[104:119], v[64:67], v[172:175], v[104:119]
    ds_read_b64_tr_b16 v[48:49], v9 offset:35008
    ds_read_b64_tr_b16 v[50:51], v9 offset:35520
    s_waitcnt lgkmcnt(6)
    v_mfma_f32_32x32x16_bf16 v[120:135], v[68:71], v[172:175], v[120:135]
    ds_read_b64_tr_b16 v[52:53], v9 offset:35040
    ds_read_b64_tr_b16 v[54:55], v9 offset:35552
    buffer_load_dwordx4 v[208:211], v4, s[8:11], s30 offen offset:1024 sc1
    s_waitcnt vmcnt(10)
    s_waitcnt lgkmcnt(6)
    v_mfma_f32_32x32x16_bf16 v[72:87], v[40:43], v[176:179], v[72:87]
    ds_read_b64_tr_b16 v[56:57], v9 offset:35200
    ds_read_b64_tr_b16 v[58:59], v9 offset:35712
    s_waitcnt lgkmcnt(6)
    v_mfma_f32_32x32x16_bf16 v[88:103], v[44:47], v[176:179], v[88:103]
    ds_read_b64_tr_b16 v[60:61], v9 offset:35232
    ds_read_b64_tr_b16 v[62:63], v9 offset:35744
    buffer_load_dwordx4 v[212:215], v4, s[8:11], s30 offen offset:1536 sc1
    s_add_u32 s30, s30, 2048
    s_cmp_ge_u32 s30, 20480
    s_cselect_b32 s30, 0, s30
    s_waitcnt lgkmcnt(6)
    v_mfma_f32_32x32x16_bf16 v[104:119], v[48:51], v[176:179], v[104:119]
    ds_read_b64_tr_b16 v[64:65], v9 offset:35264
    ds_read_b64_tr_b16 v[66:67], v9 offset:35776
    s_waitcnt lgkmcnt(6)
    v_mfma_f32_32x32x16_bf16 v[120:135], v[52:55], v[176:179], v[120:135]
    ds_read_b64_tr_b16 v[68:69], v9 offset:35296
    ds_read_b64_tr_b16 v[70:71], v9 offset:35808
    buffer_load_dwordx4 v[216:219], v4, s[8:11], s30 offen offset:0 sc1
    s_barrier
    s_waitcnt vmcnt(11)
    s_waitcnt lgkmcnt(6)
    v_mfma_f32_32x32x16_bf16 v[72:87], v[56:59], v[180:183], v[72:87]
    ds_read_b64_tr_b16 v[40:41], v10 offset:0
    ds_read_b64_tr_b16 v[42:43], v10 offset:512
    s_waitcnt lgkmcnt(6)
    v_mfma_f32_32x32x16_bf16 v[88:103], v[60:63], v[180:183], v[88:103]
    ds_read_b64_tr_b16 v[44:45], v10 offset:32
    ds_read_b64_tr_b16 v[46:47], v10 offset:544
    s_waitcnt lgkmcnt(6)
    v_mfma_f32_32x32x16_bf16 v[104:119], v[64:67], v[180:183], v[104:119]
    ds_read_b64_tr_b16 v[48:49], v10 offset:64
    ds_read_b64_tr_b16 v[50:51], v10 offset:576
    buffer_load_dwordx4 v[220:223], v4, s[8:11], s30 offen offset:512 sc1
    s_waitcnt lgkmcnt(6)
    v_mfma_f32_32x32x16_bf16 v[120:135], v[68:71], v[180:183], v[120:135]
    ds_read_b64_tr_b16 v[52:53], v10 offset:96
    ds_read_b64_tr_b16 v[54:55], v10 offset:608
    s_cmp_lg_u32 s16, 0
    s_cbranch_scc1 L_p4cs_41
    ds_read_b64_tr_b16 v[156:157], v145 offset:33920
    ds_read_b64_tr_b16 v[158:159], v145 offset:34176
    ds_read_b64_tr_b16 v[160:161], v145 offset:34432
    ds_read_b64_tr_b16 v[162:163], v145 offset:34688
    s_waitcnt lgkmcnt(0)
    v_dot2_f32_bf16 v148, v156, v164, v148
    v_dot2_f32_bf16 v149, v157, v164, v149
    v_dot2_f32_bf16 v148, v158, v164, v148
    v_dot2_f32_bf16 v149, v159, v164, v149
    v_dot2_f32_bf16 v148, v160, v164, v148
    v_dot2_f32_bf16 v149, v161, v164, v149
    v_dot2_f32_bf16 v148, v162, v164, v148
    v_dot2_f32_bf16 v149, v163, v164, v149
    s_nop 1
L_p4cs_41:
    s_waitcnt vmcnt(9)
    s_waitcnt lgkmcnt(6)
    v_mfma_f32_32x32x16_bf16 v[72:87], v[40:43], v[184:187], v[72:87]
    ds_read_b64_tr_b16 v[56:57], v10 offset:256
    ds_read_b64_tr_b16 v[58:59], v10 offset:768
    buffer_load_dwordx4 v[224:227], v4, s[8:11], s30 offen offset:1024 sc1
    s_waitcnt lgkmcnt(6)
    v_mfma_f32_32x32x16_bf16 v[88:103], v[44:47], v[184:187], v[88:103]
    ds_read_b64_tr_b16 v[60:61], v10 offset:288
    ds_read_b64_tr_b16 v[62:63], v10 offset:800
    s_waitcnt lgkmcnt(6)
    v_mfma_f32_32x32x16_bf16 v[104:119], v[48:51], v[184:187], v[104:119]
    ds_read_b64_tr_b16 v[64:65], v10 offset:320
    ds_read_b64_tr_b16 v[66:67], v10 offset:832
    buffer_load_dwordx4 v[228:231], v4, s[8:11], s30 offen offset:1536 sc1
    s_add_u32 s30, s30, 2048
    s_cmp_ge_u32 s30, 20480
    s_cselect_b32 s30, 0, s30
    s_waitcnt lgkmcnt(6)
    v_mfma_f32_32x32x16_bf16 v[120:135], v[52:55], v[184:187], v[120:135]
    ds_read_b64_tr_b16 v[68:69], v10 offset:352
    ds_read_b64_tr_b16 v[70:71], v10 offset:864
    s_waitcnt vmcnt(10)
    s_waitcnt lgkmcnt(6)
    v_mfma_f32_32x32x16_bf16 v[72:87], v[56:59], v[188:191], v[72:87]
    ds_read_b64_tr_b16 v[40:41], v10 offset:1024
    ds_read_b64_tr_b16 v[42:43], v10 offset:1536
    s_waitcnt lgkmcnt(6)
    v_mfma_f32_32x32x16_bf16 v[88:103], v[60:63], v[188:191], v[88:103]
    ds_read_b64_tr_b16 v[44:45], v10 offset:1056
    ds_read_b64_tr_b16 v[46:47], v10 offset:1568
    buffer_load_dwordx4 v[232:235], v4, s[8:11], s30 offen offset:0 sc1
    s_waitcnt lgkmcnt(6)
    v_mfma_f32_32x32x16_bf16 v[104:119], v[64:67], v[188:191], v[104:119]
    ds_read_b64_tr_b16 v[48:49], v10 offset:1088
    ds_read_b64_tr_b16 v[50:51], v10 offset:1600
    s_waitcnt lgkmcnt(6)
    v_mfma_f32_32x32x16_bf16 v[120:135], v[68:71], v[188:191], v[120:135]
    ds_read_b64_tr_b16 v[52:53], v10 offset:1120
    ds_read_b64_tr_b16 v[54:55], v10 offset:1632
    buffer_load_dwordx4 v[236:239], v4, s[8:11], s30 offen offset:512 sc1
    s_waitcnt vmcnt(11)
    s_waitcnt lgkmcnt(6)
    v_mfma_f32_32x32x16_bf16 v[72:87], v[40:43], v[192:195], v[72:87]
    ds_read_b64_tr_b16 v[56:57], v10 offset:1280
    ds_read_b64_tr_b16 v[58:59], v10 offset:1792
    s_waitcnt lgkmcnt(6)
    v_mfma_f32_32x32x16_bf16 v[88:103], v[44:47], v[192:195], v[88:103]
    ds_read_b64_tr_b16 v[60:61], v10 offset:1312
    ds_read_b64_tr_b16 v[62:63], v10 offset:1824
    buffer_load_dwordx4 v[240:243], v4, s[8:11], s30 offen offset:1024 sc1
    s_waitcnt lgkmcnt(6)
    v_mfma_f32_32x32x16_bf16 v[104:119], v[48:51], v[192:195], v[104:119]
    ds_read_b64_tr_b16 v[64:65], v10 offset:1344
    ds_read_b64_tr_b16 v[66:67], v10 offset:1856
    s_waitcnt lgkmcnt(6)
    v_mfma_f32_32x32x16_bf16 v[120:135], v[52:55], v[192:195], v[120:135]
    ds_read_b64_tr_b16 v[68:69], v10 offset:1376
    ds_read_b64_tr_b16 v[70:71], v10 offset:1888
    buffer_load_dwordx4 v[244:247], v4, s[8:11], s30 offen offset:1536 sc1
    s_barrier
    s_waitcnt vmcnt(12)
    s_waitcnt lgkmcnt(6)
    v_mfma_f32_32x32x16_bf16 v[72:87], v[56:59], v[196:199], v[72:87]
    ds_read_b64_tr_b16 v[40:41], v10 offset:16960
    ds_read_b64_tr_b16 v[42:43], v10 offset:17472
    s_waitcnt lgkmcnt(6)
    v_mfma_f32_32x32x16_bf16 v[88:103], v[60:63], v[196:199], v[88:103]
    ds_read_b64_tr_b16 v[44:45], v10 offset:16992
    ds_read_b64_tr_b16 v[46:47], v10 offset:17504
    s_add_u32 m0, s34, 0
    s_nop 0
    buffer_load_dwordx4 v165, s[76:79], s33 offen lds
    s_add_u32 s33, s33, 81920
    s_cmp_ge_u32 s33, 2211840
    s_cselect_b32 s33, 0, s33
    s_waitcnt lgkmcnt(6)
    v_mfma_f32_32x32x16_bf16 v[104:119], v[64:67], v[196:199], v[104:119]
    ds_read_b64_tr_b16 v[48:49], v10 offset:17024
    ds_read_b64_tr_b16 v[50:51], v10 offset:17536
    s_waitcnt lgkmcnt(6)
    v_mfma_f32_32x32x16_bf16 v[120:135], v[68:71], v[196:199], v[120:135]
    ds_read_b64_tr_b16 v[52:53], v10 offset:17056
    ds_read_b64_tr_b16 v[54:55], v10 offset:17568
    s_cmp_lg_u32 s16, 0
    s_cbranch_scc1 L_p4cs_42
    ds_read_b64_tr_b16 v[156:157], v146 offset:0
    ds_read_b64_tr_b16 v[158:159], v146 offset:256
    ds_read_b64_tr_b16 v[160:161], v146 offset:512
    ds_read_b64_tr_b16 v[162:163], v146 offset:768
    s_waitcnt lgkmcnt(0)
    v_dot2_f32_bf16 v148, v156, v164, v148
    v_dot2_f32_bf16 v149, v157, v164, v149
    v_dot2_f32_bf16 v148, v158, v164, v148
    v_dot2_f32_bf16 v149, v159, v164, v149
    v_dot2_f32_bf16 v148, v160, v164, v148
    v_dot2_f32_bf16 v149, v161, v164, v149
    v_dot2_f32_bf16 v148, v162, v164, v148
    v_dot2_f32_bf16 v149, v163, v164, v149
    s_nop 1
L_p4cs_42:
    v_pk_add_f32 v[24:25], v[24:25], v[26:27]
    v_pk_add_f32 v[28:29], v[28:29], v[30:31]
    v_pk_add_f32 v[24:25], v[24:25], v[32:33]
    v_pk_add_f32 v[24:25], v[24:25], v[28:29]
    v_mov_b32 v34, v24
    v_mov_b32 v35, v25
    s_nop 0
    v_permlane32_swap_b32 v24, v34
    v_permlane32_swap_b32 v25, v35
    v_pk_add_f32 v[24:25], v[24:25], v[34:35]
    v_mul_f32 v14, 0xbacccccd, v24
    v_mul_f32 v25, 0x3acccccd, v25
    v_fma_f32 v25, -v14, v14, v25
    v_max_f32 v25, 0, v25
    v_cvt_pk_bf16_f32 v14, v14, v14
    v_and_b32 v14, 0xffff0000, v14
    v_cvt_pk_bf16_f32 v25, v25, v25
    v_and_b32 v25, 0xffff0000, v25
    v_add_f32 v25, 0x3727c5ac, v25
    v_cvt_pk_bf16_f32 v25, v25, v25
    v_and_b32 v25, 0xffff0000, v25
    v_sqrt_f32 v25, v25
    s_nop 0
    v_cvt_pk_bf16_f32 v25, v25, v25
    v_and_b32 v25, 0xffff0000, v25
    v_rcp_f32 v26, v25
    v_mul_f32 v25, v25, v25
    v_mov_b32 v20, v25
    v_mul_f32 v18, 0xc0135761, v26
    v_mul_f32 v27, v26, v26
    v_mul_f32 v27, 0x3d372713, v27
    v_mul_f32 v16, v18, v27
    s_waitcnt vmcnt(12)
    s_waitcnt lgkmcnt(6)
    v_mfma_f32_32x32x16_bf16 v[72:87], v[40:43], v[200:203], v[72:87]
    ds_read_b64_tr_b16 v[56:57], v10 offset:17216
    ds_read_b64_tr_b16 v[58:59], v10 offset:17728
    s_waitcnt lgkmcnt(6)
    v_mfma_f32_32x32x16_bf16 v[88:103], v[44:47], v[200:203], v[88:103]
    ds_read_b64_tr_b16 v[60:61], v10 offset:17248
    ds_read_b64_tr_b16 v[62:63], v10 offset:17760
    s_add_u32 m0, s34, 8448
    s_nop 0
    buffer_load_dwordx4 v165, s[76:79], s33 offen lds
    s_add_u32 s33, s33, 81920
    s_cmp_ge_u32 s33, 2211840
    s_cselect_b32 s33, 0, s33
    s_waitcnt lgkmcnt(6)
    v_mfma_f32_32x32x16_bf16 v[104:119], v[48:51], v[200:203], v[104:119]
    ds_read_b64_tr_b16 v[64:65], v10 offset:17280
    ds_read_b64_tr_b16 v[66:67], v10 offset:17792
    s_waitcnt lgkmcnt(6)
    v_mfma_f32_32x32x16_bf16 v[120:135], v[52:55], v[200:203], v[120:135]
    ds_read_b64_tr_b16 v[68:69], v10 offset:17312
    ds_read_b64_tr_b16 v[70:71], v10 offset:17824
    s_waitcnt vmcnt(12)
    s_waitcnt lgkmcnt(6)
    v_mfma_f32_32x32x16_bf16 v[72:87], v[56:59], v[204:207], v[72:87]
    ds_read_b64_tr_b16 v[40:41], v10 offset:17984
    ds_read_b64_tr_b16 v[42:43], v10 offset:18496
    s_waitcnt lgkmcnt(6)
    v_mfma_f32_32x32x16_bf16 v[88:103], v[60:63], v[204:207], v[88:103]
    ds_read_b64_tr_b16 v[44:45], v10 offset:18016
    ds_read_b64_tr_b16 v[46:47], v10 offset:18528
    s_add_u32 m0, s34, 16896
    s_nop 0
    buffer_load_dwordx4 v165, s[76:79], s33 offen lds
    s_add_u32 s33, s33, 81920
    s_cmp_ge_u32 s33, 2211840
    s_cselect_b32 s33, 0, s33
    s_waitcnt lgkmcnt(6)
    v_mfma_f32_32x32x16_bf16 v[104:119], v[64:67], v[204:207], v[104:119]
    ds_read_b64_tr_b16 v[48:49], v10 offset:18048
    ds_read_b64_tr_b16 v[50:51], v10 offset:18560
    s_waitcnt lgkmcnt(6)
    v_mfma_f32_32x32x16_bf16 v[120:135], v[68:71], v[204:207], v[120:135]
    ds_read_b64_tr_b16 v[52:53], v10 offset:18080
    ds_read_b64_tr_b16 v[54:55], v10 offset:18592
    s_waitcnt vmcnt(12)
    s_waitcnt lgkmcnt(6)
    v_mfma_f32_32x32x16_bf16 v[72:87], v[40:43], v[208:211], v[72:87]
    ds_read_b64_tr_b16 v[56:57], v10 offset:18240
    ds_read_b64_tr_b16 v[58:59], v10 offset:18752
    s_waitcnt lgkmcnt(6)
    v_mfma_f32_32x32x16_bf16 v[88:103], v[44:47], v[208:211], v[88:103]
    ds_read_b64_tr_b16 v[60:61], v10 offset:18272
    ds_read_b64_tr_b16 v[62:63], v10 offset:18784
    s_add_u32 m0, s34, 25344
    s_nop 0
    buffer_load_dwordx4 v165, s[76:79], s33 offen lds
    s_add_u32 s33, s33, 81920
    s_cmp_ge_u32 s33, 2211840
    s_cselect_b32 s33, 0, s33
    s_waitcnt lgkmcnt(6)
    v_mfma_f32_32x32x16_bf16 v[104:119], v[48:51], v[208:211], v[104:119]
    ds_read_b64_tr_b16 v[64:65], v10 offset:18304
    ds_read_b64_tr_b16 v[66:67], v10 offset:18816
    s_waitcnt lgkmcnt(6)
    v_mfma_f32_32x32x16_bf16 v[120:135], v[52:55], v[208:211], v[120:135]
    ds_read_b64_tr_b16 v[68:69], v10 offset:18336
    ds_read_b64_tr_b16 v[70:71], v10 offset:18848
    s_waitcnt vmcnt(12)
    s_waitcnt lgkmcnt(6)
    v_mfma_f32_32x32x16_bf16 v[72:87], v[56:59], v[212:215], v[72:87]
    ds_read_b64_tr_b16 v[40:41], v10 offset:33920
    ds_read_b64_tr_b16 v[42:43], v10 offset:34432
    s_waitcnt lgkmcnt(6)
    v_mfma_f32_32x32x16_bf16 v[88:103], v[60:63], v[212:215], v[88:103]
    ds_read_b64_tr_b16 v[44:45], v10 offset:33952
    ds_read_b64_tr_b16 v[46:47], v10 offset:34464
    s_add_u32 m0, s34, 33792
    s_nop 0
    buffer_load_dwordx4 v165, s[76:79], s33 offen lds
    s_add_u32 s33, s33, 81920
    s_cmp_ge_u32 s33, 2211840
    s_cselect_b32 s33, 0, s33
    s_waitcnt lgkmcnt(6)
    v_mfma_f32_32x32x16_bf16 v[104:119], v[64:67], v[212:215], v[104:119]
    ds_read_b64_tr_b16 v[48:49], v10 offset:33984
    ds_read_b64_tr_b16 v[50:51], v10 offset:34496
    s_waitcnt lgkmcnt(6)
    v_mfma_f32_32x32x16_bf16 v[120:135], v[68:71], v[212:215], v[120:135]
    ds_read_b64_tr_b16 v[52:53], v10 offset:34016
    ds_read_b64_tr_b16 v[54:55], v10 offset:34528
    s_cmp_lg_u32 s16, 0
    s_cbranch_scc1 L_p4cs_43
    ds_read_b64_tr_b16 v[156:157], v146 offset:16960
    ds_read_b64_tr_b16 v[158:159], v146 offset:17216
    ds_read_b64_tr_b16 v[160:161], v146 offset:17472
    ds_read_b64_tr_b16 v[162:163], v146 offset:17728
    s_waitcnt lgkmcnt(0)
    v_dot2_f32_bf16 v148, v156, v164, v148
    v_dot2_f32_bf16 v149, v157, v164, v149
    v_dot2_f32_bf16 v148, v158, v164, v148
    v_dot2_f32_bf16 v149, v159, v164, v149
    v_dot2_f32_bf16 v148, v160, v164, v148
    v_dot2_f32_bf16 v149, v161, v164, v149
    v_dot2_f32_bf16 v148, v162, v164, v148
    v_dot2_f32_bf16 v149, v163, v164, v149
    s_nop 1
L_p4cs_43:
    s_waitcnt vmcnt(12)
    s_waitcnt lgkmcnt(6)
    v_mfma_f32_32x32x16_bf16 v[72:87], v[40:43], v[216:219], v[72:87]
    ds_read_b64_tr_b16 v[56:57], v10 offset:34176
    ds_read_b64_tr_b16 v[58:59], v10 offset:34688
    s_waitcnt lgkmcnt(6)
    v_mfma_f32_32x32x16_bf16 v[88:103], v[44:47], v[216:219], v[88:103]
    ds_read_b64_tr_b16 v[60:61], v10 offset:34208
    ds_read_b64_tr_b16 v[62:63], v10 offset:34720
    s_add_u32 m0, s34, 42240
    s_nop 0
    buffer_load_dwordx4 v165, s[76:79], s33 offen lds
    s_add_u32 s33, s33, 81920
    s_cmp_ge_u32 s33, 2211840
    s_cselect_b32 s33, 0, s33
    s_waitcnt lgkmcnt(6)
    v_mfma_f32_32x32x16_bf16 v[104:119], v[48:51], v[216:219], v[104:119]
    ds_read_b64_tr_b16 v[64:65], v10 offset:34240
    ds_read_b64_tr_b16 v[66:67], v10 offset:34752
    s_waitcnt lgkmcnt(6)
    v_mfma_f32_32x32x16_bf16 v[120:135], v[52:55], v[216:219], v[120:135]
    ds_read_b64_tr_b16 v[68:69], v10 offset:34272
    ds_read_b64_tr_b16 v[70:71], v10 offset:34784
    s_waitcnt vmcnt(12)
    s_waitcnt lgkmcnt(6)
    v_mfma_f32_32x32x16_bf16 v[72:87], v[56:59], v[220:223], v[72:87]
    ds_read_b64_tr_b16 v[40:41], v10 offset:34944
    ds_read_b64_tr_b16 v[42:43], v10 offset:35456
    s_waitcnt lgkmcnt(6)
    v_mfma_f32_32x32x16_bf16 v[88:103], v[60:63], v[220:223], v[88:103]
    ds_read_b64_tr_b16 v[44:45], v10 offset:34976
    ds_read_b64_tr_b16 v[46:47], v10 offset:35488
    s_add_u32 m0, s34, 50688
    s_nop 0
    buffer_load_dwordx4 v165, s[76:79], s33 offen lds
    s_add_u32 s33, s33, 81920
    s_cmp_ge_u32 s33, 2211840
    s_cselect_b32 s33, 0, s33
    s_waitcnt lgkmcnt(6)
    v_mfma_f32_32x32x16_bf16 v[104:119], v[64:67], v[220:223], v[104:119]
    ds_read_b64_tr_b16 v[48:49], v10 offset:35008
    ds_read_b64_tr_b16 v[50:51], v10 offset:35520
    s_waitcnt lgkmcnt(6)
    v_mfma_f32_32x32x16_bf16 v[120:135], v[68:71], v[220:223], v[120:135]
    ds_read_b64_tr_b16 v[52:53], v10 offset:35040
    ds_read_b64_tr_b16 v[54:55], v10 offset:35552
    s_waitcnt vmcnt(12)
    s_waitcnt lgkmcnt(6)
    v_mfma_f32_32x32x16_bf16 v[72:87], v[40:43], v[224:227], v[72:87]
    ds_read_b64_tr_b16 v[56:57], v10 offset:35200
    ds_read_b64_tr_b16 v[58:59], v10 offset:35712
    s_waitcnt lgkmcnt(6)
    v_mfma_f32_32x32x16_bf16 v[88:103], v[44:47], v[224:227], v[88:103]
    ds_read_b64_tr_b16 v[60:61], v10 offset:35232
    ds_read_b64_tr_b16 v[62:63], v10 offset:35744
    s_add_u32 m0, s34, 59136
    s_nop 0
    buffer_load_dwordx4 v165, s[76:79], s33 offen lds
    s_add_u32 s33, s33, 81920
    s_cmp_ge_u32 s33, 2211840
    s_cselect_b32 s33, 0, s33
    s_waitcnt lgkmcnt(6)
    v_mfma_f32_32x32x16_bf16 v[104:119], v[48:51], v[224:227], v[104:119]
    ds_read_b64_tr_b16 v[64:65], v10 offset:35264
    ds_read_b64_tr_b16 v[66:67], v10 offset:35776
    s_waitcnt lgkmcnt(6)
    v_mfma_f32_32x32x16_bf16 v[120:135], v[52:55], v[224:227], v[120:135]
    ds_read_b64_tr_b16 v[68:69], v10 offset:35296
    ds_read_b64_tr_b16 v[70:71], v10 offset:35808
    s_waitcnt vmcnt(12)
    s_waitcnt lgkmcnt(6)
    v_mfma_f32_32x32x16_bf16 v[72:87], v[56:59], v[228:231], v[72:87]
    ds_read_b64_tr_b16 v[40:41], v8 offset:0
    ds_read_b64_tr_b16 v[42:43], v8 offset:512
    s_waitcnt lgkmcnt(6)
    v_mfma_f32_32x32x16_bf16 v[88:103], v[60:63], v[228:231], v[88:103]
    ds_read_b64_tr_b16 v[44:45], v8 offset:32
    ds_read_b64_tr_b16 v[46:47], v8 offset:544
    s_add_u32 m0, s34, 67584
    s_nop 0
    buffer_load_dwordx4 v165, s[76:79], s33 offen lds
    s_add_u32 s33, s33, 81920
    s_cmp_ge_u32 s33, 2211840
    s_cselect_b32 s33, 0, s33
    s_waitcnt lgkmcnt(6)
    v_mfma_f32_32x32x16_bf16 v[104:119], v[64:67], v[228:231], v[104:119]
    ds_read_b64_tr_b16 v[48:49], v8 offset:64
    ds_read_b64_tr_b16 v[50:51], v8 offset:576
    s_waitcnt lgkmcnt(6)
    v_mfma_f32_32x32x16_bf16 v[120:135], v[68:71], v[228:231], v[120:135]
    ds_read_b64_tr_b16 v[52:53], v8 offset:96
    ds_read_b64_tr_b16 v[54:55], v8 offset:608
    s_cmp_lg_u32 s16, 0
    s_cbranch_scc1 L_p4cs_44
    ds_read_b64_tr_b16 v[156:157], v146 offset:33920
    ds_read_b64_tr_b16 v[158:159], v146 offset:34176
    ds_read_b64_tr_b16 v[160:161], v146 offset:34432
    ds_read_b64_tr_b16 v[162:163], v146 offset:34688
    s_waitcnt lgkmcnt(0)
    v_dot2_f32_bf16 v148, v156, v164, v148
    v_dot2_f32_bf16 v149, v157, v164, v149
    v_dot2_f32_bf16 v148, v158, v164, v148
    v_dot2_f32_bf16 v149, v159, v164, v149
    v_dot2_f32_bf16 v148, v160, v164, v148
    v_dot2_f32_bf16 v149, v161, v164, v149
    v_dot2_f32_bf16 v148, v162, v164, v148
    v_dot2_f32_bf16 v149, v163, v164, v149
    s_nop 1
L_p4cs_44:
    s_waitcnt vmcnt(12)
    s_waitcnt lgkmcnt(6)
    v_mfma_f32_32x32x16_bf16 v[72:87], v[40:43], v[232:235], v[72:87]
    ds_read_b64_tr_b16 v[56:57], v8 offset:256
    ds_read_b64_tr_b16 v[58:59], v8 offset:768
    s_waitcnt lgkmcnt(6)
    v_mfma_f32_32x32x16_bf16 v[88:103], v[44:47], v[232:235], v[88:103]
    ds_read_b64_tr_b16 v[60:61], v8 offset:288
    ds_read_b64_tr_b16 v[62:63], v8 offset:800
    s_add_u32 m0, s34, 76032
    s_nop 0
    buffer_load_dwordx4 v165, s[76:79], s33 offen lds
    s_add_u32 s33, s33, 81920
    s_cmp_ge_u32 s33, 2211840
    s_cselect_b32 s33, 0, s33
    s_waitcnt lgkmcnt(6)
    v_mfma_f32_32x32x16_bf16 v[104:119], v[48:51], v[232:235], v[104:119]
    ds_read_b64_tr_b16 v[64:65], v8 offset:320
    ds_read_b64_tr_b16 v[66:67], v8 offset:832
    s_waitcnt lgkmcnt(6)
    v_mfma_f32_32x32x16_bf16 v[120:135], v[52:55], v[232:235], v[120:135]
    ds_read_b64_tr_b16 v[68:69], v8 offset:352
    ds_read_b64_tr_b16 v[70:71], v8 offset:864
    s_waitcnt vmcnt(12)
    s_waitcnt lgkmcnt(6)
    v_mfma_f32_32x32x16_bf16 v[72:87], v[56:59], v[236:239], v[72:87]
    ds_read_b64_tr_b16 v[40:41], v8 offset:1024
    ds_read_b64_tr_b16 v[42:43], v8 offset:1536
    s_waitcnt lgkmcnt(6)
    v_mfma_f32_32x32x16_bf16 v[88:103], v[60:63], v[236:239], v[88:103]
    ds_read_b64_tr_b16 v[44:45], v8 offset:1056
    ds_read_b64_tr_b16 v[46:47], v8 offset:1568
    s_waitcnt lgkmcnt(6)
    v_mfma_f32_32x32x16_bf16 v[104:119], v[64:67], v[236:239], v[104:119]
    ds_read_b64_tr_b16 v[48:49], v8 offset:1088
    ds_read_b64_tr_b16 v[50:51], v8 offset:1600
    s_waitcnt lgkmcnt(6)
    v_mfma_f32_32x32x16_bf16 v[120:135], v[68:71], v[236:239], v[120:135]
    ds_read_b64_tr_b16 v[52:53], v8 offset:1120
    ds_read_b64_tr_b16 v[54:55], v8 offset:1632
    s_waitcnt vmcnt(11)
    s_waitcnt lgkmcnt(6)
    v_mfma_f32_32x32x16_bf16 v[72:87], v[40:43], v[240:243], v[72:87]
    ds_read_b64_tr_b16 v[56:57], v8 offset:1280
    ds_read_b64_tr_b16 v[58:59], v8 offset:1792
    s_waitcnt lgkmcnt(6)
    v_mfma_f32_32x32x16_bf16 v[88:103], v[44:47], v[240:243], v[88:103]
    ds_read_b64_tr_b16 v[60:61], v8 offset:1312
    ds_read_b64_tr_b16 v[62:63], v8 offset:1824
    s_waitcnt lgkmcnt(6)
    v_mfma_f32_32x32x16_bf16 v[104:119], v[48:51], v[240:243], v[104:119]
    ds_read_b64_tr_b16 v[64:65], v8 offset:1344
    ds_read_b64_tr_b16 v[66:67], v8 offset:1856
    s_waitcnt lgkmcnt(6)
    v_mfma_f32_32x32x16_bf16 v[120:135], v[52:55], v[240:243], v[120:135]
    ds_read_b64_tr_b16 v[68:69], v8 offset:1376
    ds_read_b64_tr_b16 v[70:71], v8 offset:1888
    s_waitcnt vmcnt(10)
    s_waitcnt lgkmcnt(6)
    v_mfma_f32_32x32x16_bf16 v[72:87], v[56:59], v[244:247], v[72:87]
    s_waitcnt lgkmcnt(4)
    v_mfma_f32_32x32x16_bf16 v[88:103], v[60:63], v[244:247], v[88:103]
    s_waitcnt lgkmcnt(2)
    v_mfma_f32_32x32x16_bf16 v[104:119], v[64:67], v[244:247], v[104:119]
    s_waitcnt lgkmcnt(0)
    v_mfma_f32_32x32x16_bf16 v[120:135], v[68:71], v[244:247], v[120:135]
    s_cmp_lg_u32 s16, 0
    s_cbranch_scc1 L_p4cs_45
    ds_read_b64_tr_b16 v[156:157], v144 offset:0
    ds_read_b64_tr_b16 v[158:159], v144 offset:256
    ds_read_b64_tr_b16 v[160:161], v144 offset:512
    ds_read_b64_tr_b16 v[162:163], v144 offset:768
    s_waitcnt lgkmcnt(0)
    v_dot2_f32_bf16 v148, v156, v164, v148
    v_dot2_f32_bf16 v149, v157, v164, v149
    v_dot2_f32_bf16 v148, v158, v164, v148
    v_dot2_f32_bf16 v149, v159, v164, v149
    v_dot2_f32_bf16 v148, v160, v164, v148
    v_dot2_f32_bf16 v149, v161, v164, v149
    v_dot2_f32_bf16 v148, v162, v164, v148
    v_dot2_f32_bf16 v149, v163, v164, v149
    s_nop 1
L_p4cs_45:
    s_cmp_lg_u32 s16, 0
    s_cbranch_scc1 L_p4cp_46
    s_nop 3
    v_add_f32 v148, v148, v149
    v_mov_b32 v149, v148
    s_nop 1
    v_permlane32_swap_b32 v148, v149
    v_add_f32 v148, v148, v149
    v_bfe_u32 v156, v1, 4, 1
    v_lshlrev_b32 v156, 8, v156
    v_and_b32 v157, 15, v1
    v_lshl_add_u32 v156, v157, 2, v156
    s_lshl_b32 s21, s26, 6
    s_lshl_b32 s22, s29, 9
    s_add_u32 s21, s21, s22
    s_add_u32 s21, s21, 160768
    v_add_u32 v156, s21, v156
    ds_write_b32 v156, v148
    s_nop 0
L_p4cp_46:
    s_cmp_lg_u32 s16, 0
    s_cbranch_scc1 L_p4cf_47
    s_waitcnt lgkmcnt(0)
    s_barrier
    v_lshlrev_b32 v156, 3, v1
    v_add_u32 v156, 160768, v156
    ds_read_b64 v[158:159], v156
    ds_read_b64 v[160:161], v156 offset:512
    s_waitcnt lgkmcnt(0)
    v_pk_add_f32 v[158:159], v[158:159], v[160:161]
    ds_write_b64 v156, v[158:159] offset:1536
    s_waitcnt lgkmcnt(0)
L_p4cf_47:
    ds_read_b128 v[40:43], v12 offset:0
    ds_read_b128 v[48:51], v12 offset:256
    ds_read_b128 v[44:47], v12 offset:32
    ds_read_b128 v[52:55], v12 offset:288
    ds_read_b128 v[56:59], v12 offset:64
    ds_read_b128 v[64:67], v12 offset:320
    ds_read_b128 v[60:63], v12 offset:96
    ds_read_b128 v[68:71], v12 offset:352
    s_waitcnt lgkmcnt(4)
    v_pk_fma_f32 v[72:73], v[40:41], v[14:15], v[72:73] op_sel_hi:[1,0,1]
    v_pk_fma_f32 v[74:75], v[42:43], v[14:15], v[74:75] op_sel_hi:[1,0,1]
    v_pk_fma_f32 v[76:77], v[44:45], v[14:15], v[76:77] op_sel_hi:[1,0,1]
    v_pk_fma_f32 v[78:79], v[46:47], v[14:15], v[78:79] op_sel_hi:[1,0,1]
    v_pk_fma_f32 v[80:81], v[48:49], v[14:15], v[80:81] op_sel_hi:[1,0,1]
    v_pk_fma_f32 v[82:83], v[50:51], v[14:15], v[82:83] op_sel_hi:[1,0,1]
    v_pk_fma_f32 v[84:85], v[52:53], v[14:15], v[84:85] op_sel_hi:[1,0,1]
    v_pk_fma_f32 v[86:87], v[54:55], v[14:15], v[86:87] op_sel_hi:[1,0,1]
    s_waitcnt lgkmcnt(0)
    v_pk_fma_f32 v[88:89], v[56:57], v[14:15], v[88:89] op_sel_hi:[1,0,1]
    v_pk_fma_f32 v[90:91], v[58:59], v[14:15], v[90:91] op_sel_hi:[1,0,1]
    v_pk_fma_f32 v[92:93], v[60:61], v[14:15], v[92:93] op_sel_hi:[1,0,1]
    v_pk_fma_f32 v[94:95], v[62:63], v[14:15], v[94:95] op_sel_hi:[1,0,1]
    v_pk_fma_f32 v[96:97], v[64:65], v[14:15], v[96:97] op_sel_hi:[1,0,1]
    v_pk_fma_f32 v[98:99], v[66:67], v[14:15], v[98:99] op_sel_hi:[1,0,1]
    v_pk_fma_f32 v[100:101], v[68:69], v[14:15], v[100:101] op_sel_hi:[1,0,1]
    v_pk_fma_f32 v[102:103], v[70:71], v[14:15], v[102:103] op_sel_hi:[1,0,1]
    ds_read_b128 v[40:43], v12 offset:128
    ds_read_b128 v[48:51], v12 offset:384
    ds_read_b128 v[44:47], v12 offset:160
    ds_read_b128 v[52:55], v12 offset:416
    ds_read_b128 v[56:59], v12 offset:192
    ds_read_b128 v[64:67], v12 offset:448
    ds_read_b128 v[60:63], v12 offset:224
    ds_read_b128 v[68:71], v12 offset:480
    v_pk_mul_f32 v[136:137], v[72:73], v[72:73]
    v_pk_mul_f32 v[138:139], v[74:75], v[74:75]
    v_pk_fma_f32 v[136:137], v[136:137], v[16:17], v[18:19] op_sel_hi:[1,0,0]
    v_pk_fma_f32 v[138:139], v[138:139], v[16:17], v[18:19] op_sel_hi:[1,0,0]
    v_pk_mul_f32 v[136:137], v[136:137], v[72:73]
    v_pk_mul_f32 v[138:139], v[138:139], v[74:75]
    v_exp_f32 v136, v136
    v_exp_f32 v137, v137
    v_exp_f32 v138, v138
    v_exp_f32 v139, v139
    v_pk_mul_f32 v[72:73], v[72:73], v[80:81]
    v_pk_mul_f32 v[74:75], v[74:75], v[82:83]
    v_pk_fma_f32 v[136:137], v[136:137], v[20:21], v[20:21] op_sel_hi:[1,0,0]
    v_pk_fma_f32 v[138:139], v[138:139], v[20:21], v[20:21] op_sel_hi:[1,0,0]
    v_rcp_f32 v136, v136
    v_rcp_f32 v137, v137
    v_rcp_f32 v138, v138
    v_rcp_f32 v139, v139
    v_pk_mul_f32 v[72:73], v[72:73], v[136:137]
    v_pk_mul_f32 v[74:75], v[74:75], v[138:139]
    v_cvt_pk_bf16_f32 v24, v72, v73
    v_cvt_pk_bf16_f32 v25, v74, v75
    v_pk_mul_f32 v[140:141], v[88:89], v[88:89]
    v_pk_mul_f32 v[142:143], v[90:91], v[90:91]
    v_pk_fma_f32 v[140:141], v[140:141], v[16:17], v[18:19] op_sel_hi:[1,0,0]
    v_pk_fma_f32 v[142:143], v[142:143], v[16:17], v[18:19] op_sel_hi:[1,0,0]
    v_pk_mul_f32 v[140:141], v[140:141], v[88:89]
    v_pk_mul_f32 v[142:143], v[142:143], v[90:91]
    v_exp_f32 v140, v140
    v_exp_f32 v141, v141
    v_exp_f32 v142, v142
    v_exp_f32 v143, v143
    v_pk_mul_f32 v[88:89], v[88:89], v[96:97]
    v_pk_mul_f32 v[90:91], v[90:91], v[98:99]
    v_pk_fma_f32 v[140:141], v[140:141], v[20:21], v[20:21] op_sel_hi:[1,0,0]
    v_pk_fma_f32 v[142:143], v[142:143], v[20:21], v[20:21] op_sel_hi:[1,0,0]
    v_rcp_f32 v140, v140
    v_rcp_f32 v141, v141
    v_rcp_f32 v142, v142
    v_rcp_f32 v143, v143
    v_pk_mul_f32 v[88:89], v[88:89], v[140:141]
    v_pk_mul_f32 v[90:91], v[90:91], v[142:143]
    v_cvt_pk_bf16_f32 v26, v88, v89
    v_cvt_pk_bf16_f32 v27, v90, v91
    buffer_store_dwordx4 v[24:27], v13, s[80:83], 0 offen offset:0 sc1
    v_pk_mul_f32 v[136:137], v[76:77], v[76:77]
    v_pk_mul_f32 v[138:139], v[78:79], v[78:79]
    v_pk_fma_f32 v[136:137], v[136:137], v[16:17], v[18:19] op_sel_hi:[1,0,0]
    v_pk_fma_f32 v[138:139], v[138:139], v[16:17], v[18:19] op_sel_hi:[1,0,0]
    v_pk_mul_f32 v[136:137], v[136:137], v[76:77]
    v_pk_mul_f32 v[138:139], v[138:139], v[78:79]
    v_exp_f32 v136, v136
    v_exp_f32 v137, v137
    v_exp_f32 v138, v138
    v_exp_f32 v139, v139
    v_pk_mul_f32 v[76:77], v[76:77], v[84:85]
    v_pk_mul_f32 v[78:79], v[78:79], v[86:87]
    v_pk_fma_f32 v[136:137], v[136:137], v[20:21], v[20:21] op_sel_hi:[1,0,0]
    v_pk_fma_f32 v[138:139], v[138:139], v[20:21], v[20:21] op_sel_hi:[1,0,0]
    v_rcp_f32 v136, v136
    v_rcp_f32 v137, v137
    v_rcp_f32 v138, v138
    v_rcp_f32 v139, v139
    v_pk_mul_f32 v[76:77], v[76:77], v[136:137]
    v_pk_mul_f32 v[78:79], v[78:79], v[138:139]
    v_cvt_pk_bf16_f32 v28, v76, v77
    v_cvt_pk_bf16_f32 v29, v78, v79
    v_pk_mul_f32 v[140:141], v[92:93], v[92:93]
    v_pk_mul_f32 v[142:143], v[94:95], v[94:95]
    v_pk_fma_f32 v[140:141], v[140:141], v[16:17], v[18:19] op_sel_hi:[1,0,0]
    v_pk_fma_f32 v[142:143], v[142:143], v[16:17], v[18:19] op_sel_hi:[1,0,0]
    v_pk_mul_f32 v[140:141], v[140:141], v[92:93]
    v_pk_mul_f32 v[142:143], v[142:143], v[94:95]
    v_exp_f32 v140, v140
    v_exp_f32 v141, v141
    v_exp_f32 v142, v142
    v_exp_f32 v143, v143
    v_pk_mul_f32 v[92:93], v[92:93], v[100:101]
    v_pk_mul_f32 v[94:95], v[94:95], v[102:103]
    v_pk_fma_f32 v[140:141], v[140:141], v[20:21], v[20:21] op_sel_hi:[1,0,0]
    v_pk_fma_f32 v[142:143], v[142:143], v[20:21], v[20:21] op_sel_hi:[1,0,0]
    v_rcp_f32 v140, v140
    v_rcp_f32 v141, v141
    v_rcp_f32 v142, v142
    v_rcp_f32 v143, v143
    v_pk_mul_f32 v[92:93], v[92:93], v[140:141]
    v_pk_mul_f32 v[94:95], v[94:95], v[142:143]
    v_cvt_pk_bf16_f32 v30, v92, v93
    v_cvt_pk_bf16_f32 v31, v94, v95
    buffer_store_dwordx4 v[28:31], v13, s[80:83], 0 offen offset:512 sc1
    s_waitcnt lgkmcnt(4)
    v_pk_fma_f32 v[104:105], v[40:41], v[14:15], v[104:105] op_sel_hi:[1,0,1]
    v_pk_fma_f32 v[106:107], v[42:43], v[14:15], v[106:107] op_sel_hi:[1,0,1]
    v_pk_fma_f32 v[108:109], v[44:45], v[14:15], v[108:109] op_sel_hi:[1,0,1]
    v_pk_fma_f32 v[110:111], v[46:47], v[14:15], v[110:111] op_sel_hi:[1,0,1]
    v_pk_fma_f32 v[112:113], v[48:49], v[14:15], v[112:113] op_sel_hi:[1,0,1]
    v_pk_fma_f32 v[114:115], v[50:51], v[14:15], v[114:115] op_sel_hi:[1,0,1]
    v_pk_fma_f32 v[116:117], v[52:53], v[14:15], v[116:117] op_sel_hi:[1,0,1]
    v_pk_fma_f32 v[118:119], v[54:55], v[14:15], v[118:119] op_sel_hi:[1,0,1]
    s_waitcnt lgkmcnt(0)
    v_pk_fma_f32 v[120:121], v[56:57], v[14:15], v[120:121] op_sel_hi:[1,0,1]
    v_pk_fma_f32 v[122:123], v[58:59], v[14:15], v[122:123] op_sel_hi:[1,0,1]
    v_pk_fma_f32 v[124:125], v[60:61], v[14:15], v[124:125] op_sel_hi:[1,0,1]
    v_pk_fma_f32 v[126:127], v[62:63], v[14:15], v[126:127] op_sel_hi:[1,0,1]
    v_pk_fma_f32 v[128:129], v[64:65], v[14:15], v[128:129] op_sel_hi:[1,0,1]
    v_pk_fma_f32 v[130:131], v[66:67], v[14:15], v[130:131] op_sel_hi:[1,0,1]
    v_pk_fma_f32 v[132:133], v[68:69], v[14:15], v[132:133] op_sel_hi:[1,0,1]
    v_pk_fma_f32 v[134:135], v[70:71], v[14:15], v[134:135] op_sel_hi:[1,0,1]
    v_pk_mul_f32 v[136:137], v[104:105], v[104:105]
    v_pk_mul_f32 v[138:139], v[106:107], v[106:107]
    v_pk_fma_f32 v[136:137], v[136:137], v[16:17], v[18:19] op_sel_hi:[1,0,0]
    v_pk_fma_f32 v[138:139], v[138:139], v[16:17], v[18:19] op_sel_hi:[1,0,0]
    v_pk_mul_f32 v[136:137], v[136:137], v[104:105]
    v_pk_mul_f32 v[138:139], v[138:139], v[106:107]
    v_exp_f32 v136, v136
    v_exp_f32 v137, v137
    v_exp_f32 v138, v138
    v_exp_f32 v139, v139
    v_pk_mul_f32 v[104:105], v[104:105], v[112:113]
    v_pk_mul_f32 v[106:107], v[106:107], v[114:115]
    v_pk_fma_f32 v[136:137], v[136:137], v[20:21], v[20:21] op_sel_hi:[1,0,0]
    v_pk_fma_f32 v[138:139], v[138:139], v[20:21], v[20:21] op_sel_hi:[1,0,0]
    v_rcp_f32 v136, v136
    v_rcp_f32 v137, v137
    v_rcp_f32 v138, v138
    v_rcp_f32 v139, v139
    v_pk_mul_f32 v[104:105], v[104:105], v[136:137]
    v_pk_mul_f32 v[106:107], v[106:107], v[138:139]
    v_cvt_pk_bf16_f32 v32, v104, v105
    v_cvt_pk_bf16_f32 v33, v106, v107
    v_pk_mul_f32 v[140:141], v[120:121], v[120:121]
    v_pk_mul_f32 v[142:143], v[122:123], v[122:123]
    v_pk_fma_f32 v[140:141], v[140:141], v[16:17], v[18:19] op_sel_hi:[1,0,0]
    v_pk_fma_f32 v[142:143], v[142:143], v[16:17], v[18:19] op_sel_hi:[1,0,0]
    v_pk_mul_f32 v[140:141], v[140:141], v[120:121]
    v_pk_mul_f32 v[142:143], v[142:143], v[122:123]
    v_exp_f32 v140, v140
    v_exp_f32 v141, v141
    v_exp_f32 v142, v142
    v_exp_f32 v143, v143
    v_pk_mul_f32 v[120:121], v[120:121], v[128:129]
    v_pk_mul_f32 v[122:123], v[122:123], v[130:131]
    v_pk_fma_f32 v[140:141], v[140:141], v[20:21], v[20:21] op_sel_hi:[1,0,0]
    v_pk_fma_f32 v[142:143], v[142:143], v[20:21], v[20:21] op_sel_hi:[1,0,0]
    v_rcp_f32 v140, v140
    v_rcp_f32 v141, v141
    v_rcp_f32 v142, v142
    v_rcp_f32 v143, v143
    v_pk_mul_f32 v[120:121], v[120:121], v[140:141]
    v_pk_mul_f32 v[122:123], v[122:123], v[142:143]
    v_cvt_pk_bf16_f32 v34, v120, v121
    v_cvt_pk_bf16_f32 v35, v122, v123
    buffer_store_dwordx4 v[32:35], v13, s[80:83], 0 offen offset:1024 sc1
    v_pk_mul_f32 v[136:137], v[108:109], v[108:109]
    v_pk_mul_f32 v[138:139], v[110:111], v[110:111]
    v_pk_fma_f32 v[136:137], v[136:137], v[16:17], v[18:19] op_sel_hi:[1,0,0]
    v_pk_fma_f32 v[138:139], v[138:139], v[16:17], v[18:19] op_sel_hi:[1,0,0]
    v_pk_mul_f32 v[136:137], v[136:137], v[108:109]
    v_pk_mul_f32 v[138:139], v[138:139], v[110:111]
    v_exp_f32 v136, v136
    v_exp_f32 v137, v137
    v_exp_f32 v138, v138
    v_exp_f32 v139, v139
    v_pk_mul_f32 v[108:109], v[108:109], v[116:117]
    v_pk_mul_f32 v[110:111], v[110:111], v[118:119]
    v_pk_fma_f32 v[136:137], v[136:137], v[20:21], v[20:21] op_sel_hi:[1,0,0]
    v_pk_fma_f32 v[138:139], v[138:139], v[20:21], v[20:21] op_sel_hi:[1,0,0]
    v_rcp_f32 v136, v136
    v_rcp_f32 v137, v137
    v_rcp_f32 v138, v138
    v_rcp_f32 v139, v139
    v_pk_mul_f32 v[108:109], v[108:109], v[136:137]
    v_pk_mul_f32 v[110:111], v[110:111], v[138:139]
    v_cvt_pk_bf16_f32 v36, v108, v109
    v_cvt_pk_bf16_f32 v37, v110, v111
    v_pk_mul_f32 v[140:141], v[124:125], v[124:125]
    v_pk_mul_f32 v[142:143], v[126:127], v[126:127]
    v_pk_fma_f32 v[140:141], v[140:141], v[16:17], v[18:19] op_sel_hi:[1,0,0]
    v_pk_fma_f32 v[142:143], v[142:143], v[16:17], v[18:19] op_sel_hi:[1,0,0]
    v_pk_mul_f32 v[140:141], v[140:141], v[124:125]
    v_pk_mul_f32 v[142:143], v[142:143], v[126:127]
    v_exp_f32 v140, v140
    v_exp_f32 v141, v141
    v_exp_f32 v142, v142
    v_exp_f32 v143, v143
    v_pk_mul_f32 v[124:125], v[124:125], v[132:133]
    v_pk_mul_f32 v[126:127], v[126:127], v[134:135]
    v_pk_fma_f32 v[140:141], v[140:141], v[20:21], v[20:21] op_sel_hi:[1,0,0]
    v_pk_fma_f32 v[142:143], v[142:143], v[20:21], v[20:21] op_sel_hi:[1,0,0]
    v_rcp_f32 v140, v140
    v_rcp_f32 v141, v141
    v_rcp_f32 v142, v142
    v_rcp_f32 v143, v143
    v_pk_mul_f32 v[124:125], v[124:125], v[140:141]
    v_pk_mul_f32 v[126:127], v[126:127], v[142:143]
    v_cvt_pk_bf16_f32 v38, v124, v125
    v_cvt_pk_bf16_f32 v39, v126, v127
    buffer_store_dwordx4 v[36:39], v13, s[80:83], 0 offen offset:1536 sc1
    s_lshl_b32 s21, s16, 3
    s_add_u32 s21, s21, 2
    s_lshl_b32 s21, s21, 3
    s_add_u32 s21, s21, s18
    s_lshl_b32 s21, s21, 3
    s_add_u32 s21, s21, s28
    s_lshl_b32 s21, s21, 5
    s_add_u32 s21, s21, s19
    v_mov_b32 v136, s21
    v_mov_b32 v137, 1
    s_waitcnt vmcnt(0)
    s_mov_b64 exec, 1
    s_cmp_eq_u32 s17, 0
    s_cbranch_scc1 L_sigslow_48
    buffer_store_byte v137, v136, s[72:75], 0 offen
    s_branch L_sigdone_49
L_sigslow_48:
    buffer_store_byte v137, v136, s[72:75], 0 offen sc1
L_sigdone_49:
    s_mov_b64 exec, -1
    s_setprio 0
L_p4_done:
    s_cmp_lt_u32 s19, 30
    s_cbranch_scc1 L_p5_go
    s_cmp_lg_u32 s16, 0
    s_cbranch_scc1 L_i5l0_50
    s_cmp_lg_u32 s20, 0
    s_cbranch_scc1 L_i5_51
    v_and_b32 v5, 7, v1
    v_lshlrev_b32 v6, 5, v5
    v_mov_b32 v4, 0
    v_cmp_eq_u32 vcc, 6, v5
    v_mov_b32 v6, 0x10101
    s_nop 0
    v_cndmask_b32 v4, v4, v6, vcc
    v_subrev_u32 v6, 0, v5
    v_cmp_gt_u32 vcc, 6, v6
    v_mov_b32 v6, 0x01010101
    s_nop 0
    v_cndmask_b32 v4, v4, v6, vcc
    v_lshlrev_b32 v5, 2, v1
    s_add_u32 s21, s16, 0x0
    s_lshl_b32 s21, s21, 3
    s_add_u32 s21, s21, 2
    s_lshl_b32 s21, s21, 3
    s_add_u32 s21, s21, s18
    s_lshl_b32 s21, s21, 3
    s_lshl_b32 s21, s21, 5
    s_mov_b32 s35, 0
L_wl_52:
    buffer_load_dword v6, v5, s[72:75], s21 offen sc1
    s_waitcnt vmcnt(0)
    v_and_b32 v6, v6, v4
    v_cmp_ne_u32 vcc, v6, v4
    s_add_u32 s35, s35, 1
    s_cmp_gt_u32 s35, 65536
    s_cbranch_scc1 L_wlx_53
    s_cbranch_vccz L_wlx_53
    s_sleep 16
    s_branch L_wl_52
L_wlx_53:
    s_cmp_lg_u32 s17, 0
    s_cbranch_scc1 L_acq_54
    buffer_inv sc1
    s_waitcnt vmcnt(0)
L_acq_54:
L_i5_51:
    s_barrier
    s_cmp_lt_u32 s19, 31
    s_cbranch_scc1 L_wc_55
    s_getpc_b64 s[22:23]
L_pc_56:
    s_sub_u32 s22, s22, L_pc_56-interleave_layers__sliding_block__glu_gated_geglu__prompt_kernel
    s_subb_u32 s23, s23, 0
    v_lshlrev_b32 v6, 4, v0
L_wcl_57:
    v_min_u32 v7, L_code_end-interleave_layers__sliding_block__glu_gated_geglu__prompt_kernel-16, v6
    v_mov_b32 v5, s23
    v_add_co_u32 v4, vcc, s22, v7
    s_nop 1
    v_addc_co_u32 v5, vcc, 0, v5, vcc
    global_load_dwordx4 v[8:11], v[4:5], off
    v_add_u32 v6, 8192, v6
    s_nop 0
    v_readfirstlane_b32 s21, v6
    s_cmp_lt_u32 s21, L_code_end-interleave_layers__sliding_block__glu_gated_geglu__prompt_kernel
    s_cbranch_scc1 L_wcl_57
    s_waitcnt vmcnt(0)
    s_nop 1
L_wc_55:
    s_mul_i32 s21, s18, 10
    s_lshr_b32 s21, s21, 3
    s_lshl_b32 s30, s21, 11
    s_mul_i32 s31, s21, 245760
    s_sub_u32 s24, s19, 30
    s_lshl_b32 s24, s24, 13
    s_add_u32 s24, s24, s31
    s_add_u32 s36, s86, 0x0
    s_addc_u32 s37, s87, 0
    s_mov_b32 s38, 0x258000
    s_mov_b32 s39, 0x20000
    v_lshlrev_b32 v4, 4, v0
    s_mov_b32 s22, 0
L_ws_58:
    buffer_load_dwordx4 v[8:11], v4, s[36:39], s24 offen
    s_waitcnt vmcnt(6)
    s_add_u32 s24, s24, 16384
    s_cmp_ge_u32 s24, 2457600
    s_cselect_b32 s23, 2457600, 0
    s_sub_u32 s24, s24, s23
    s_add_u32 s22, s22, 1
    s_cmp_lt_u32 s22, 60
    s_cbranch_scc1 L_ws_58
    s_waitcnt vmcnt(0)
L_i5l0_50:
    s_branch L_p5_done
L_p5_go:
    s_mul_i32 s28, s19, 171
    s_lshr_b32 s28, s28, 9
    s_mul_i32 s25, s28, 3
    s_sub_u32 s24, s19, s25
    s_and_b32 s26, s20, 3
    s_lshl_b32 s24, s24, 2
    s_add_u32 s24, s24, s26
    s_lshl_b32 s24, s24, 2
    s_mov_b32 s22, 0x86528410
    s_mov_b32 s23, 0x8873
    s_lshr_b64 s[22:23], s[22:23], s24
    s_and_b32 s29, s22, 15
    s_lshl_b32 s24, s29, 5
    s_lshl_b32 s27, s18, 8
    s_add_u32 s27, s27, s24
    s_mul_i32 s21, s18, 27
    s_lshr_b32 s21, s21, 3
    s_lshl_b32 s30, s21, 11
    s_mul_i32 s31, s21, 81920
    s_lshl_b32 s21, s20, 1
    s_or_b32 s21, s21, s29
    s_cmp_lt_u32 s21, 8
    s_cbranch_scc1 L_p5_comp
    s_cmp_lt_u32 s20, 4
    s_cbranch_scc1 L_p5_idle
    s_lshl_b32 s25, s28, 7
    v_lshrrev_b32 v16, 3, v1
    v_lshlrev_b32 v16, 2, v16
    v_add_u32 v16, s26, v16
    v_mul_u32_u24 v16, 1280, v16
    v_and_b32 v17, 7, v1
    v_lshl_add_u32 v16, v17, 4, v16
    v_add_u32 v6, s25, v16
    v_add_u32 v7, 40960, v6
    s_mul_i32 s32, s26, 2112
    s_add_u32 s32, s32, 16960
    s_add_u32 s12, s96, 0x0
    s_addc_u32 s13, s97, 0
    s_mov_b32 s14, 0x21c000
    s_mov_b32 s15, 0x20000
    s_cmp_lt_u32 s19, 27
    s_cbranch_scc1 L_p5_pre
    s_add_u32 m0, s32, 0
    s_nop 0
    buffer_load_dwordx4 v6, s[12:15], s31 offen lds
    s_add_u32 m0, s32, 1024
    s_nop 0
    buffer_load_dwordx4 v7, s[12:15], s31 offen lds
    s_add_u32 s31, s31, 81920
    s_cmp_ge_u32 s31, 2211840
    s_cselect_b32 s31, 0, s31
    s_add_u32 m0, s32, 8448
    s_nop 0
    buffer_load_dwordx4 v6, s[12:15], s31 offen lds
    s_add_u32 m0, s32, 9472
    s_nop 0
    buffer_load_dwordx4 v7, s[12:15], s31 offen lds
    s_add_u32 s31, s31, 81920
    s_cmp_ge_u32 s31, 2211840
    s_cselect_b32 s31, 0, s31
    s_add_u32 m0, s32, 16896
    s_nop 0
    buffer_load_dwordx4 v6, s[12:15], s31 offen lds
    s_add_u32 m0, s32, 17920
    s_nop 0
    buffer_load_dwordx4 v7, s[12:15], s31 offen lds
    s_add_u32 s31, s31, 81920
    s_cmp_ge_u32 s31, 2211840
    s_cselect_b32 s31, 0, s31
    s_add_u32 m0, s32, 25344
    s_nop 0
    buffer_load_dwordx4 v6, s[12:15], s31 offen lds
    s_add_u32 m0, s32, 26368
    s_nop 0
    buffer_load_dwordx4 v7, s[12:15], s31 offen lds
    s_add_u32 s31, s31, 81920
    s_cmp_ge_u32 s31, 2211840
    s_cselect_b32 s31, 0, s31
    s_add_u32 m0, s32, 33792
    s_nop 0
    buffer_load_dwordx4 v6, s[12:15], s31 offen lds
    s_add_u32 m0, s32, 34816
    s_nop 0
    buffer_load_dwordx4 v7, s[12:15], s31 offen lds
    s_add_u32 s31, s31, 81920
    s_cmp_ge_u32 s31, 2211840
    s_cselect_b32 s31, 0, s31
    s_add_u32 m0, s32, 42240
    s_nop 0
    buffer_load_dwordx4 v6, s[12:15], s31 offen lds
    s_add_u32 m0, s32, 43264
    s_nop 0
    buffer_load_dwordx4 v7, s[12:15], s31 offen lds
    s_add_u32 s31, s31, 81920
    s_cmp_ge_u32 s31, 2211840
    s_cselect_b32 s31, 0, s31
    s_add_u32 m0, s32, 50688
    s_nop 0
    buffer_load_dwordx4 v6, s[12:15], s31 offen lds
    s_add_u32 m0, s32, 51712
    s_nop 0
    buffer_load_dwordx4 v7, s[12:15], s31 offen lds
    s_add_u32 s31, s31, 81920
    s_cmp_ge_u32 s31, 2211840
    s_cselect_b32 s31, 0, s31
    s_add_u32 m0, s32, 59136
    s_nop 0
    buffer_load_dwordx4 v6, s[12:15], s31 offen lds
    s_add_u32 m0, s32, 60160
    s_nop 0
    buffer_load_dwordx4 v7, s[12:15], s31 offen lds
    s_add_u32 s31, s31, 81920
    s_cmp_ge_u32 s31, 2211840
    s_cselect_b32 s31, 0, s31
    s_add_u32 m0, s32, 67584
    s_nop 0
    buffer_load_dwordx4 v6, s[12:15], s31 offen lds
    s_add_u32 m0, s32, 68608
    s_nop 0
    buffer_load_dwordx4 v7, s[12:15], s31 offen lds
    s_add_u32 s31, s31, 81920
    s_cmp_ge_u32 s31, 2211840
    s_cselect_b32 s31, 0, s31
    s_add_u32 m0, s32, 76032
    s_nop 0
    buffer_load_dwordx4 v6, s[12:15], s31 offen lds
    s_add_u32 m0, s32, 77056
    s_nop 0
    buffer_load_dwordx4 v7, s[12:15], s31 offen lds
    s_add_u32 s31, s31, 81920
    s_cmp_ge_u32 s31, 2211840
    s_cselect_b32 s31, 0, s31
    s_waitcnt vmcnt(0)
L_p5_pre:
    s_mul_i32 s21, s18, 27
    s_lshr_b32 s21, s21, 3
    s_lshl_b32 s30, s21, 11
    s_add_u32 s21, s21, 10
    s_cmp_ge_u32 s21, 27
    s_cselect_b32 s22, 27, 0
    s_sub_u32 s21, s21, s22
    s_mul_i32 s31, s21, 81920
    s_barrier
    s_add_u32 m0, s32, 84480
    s_nop 0
    buffer_load_dwordx4 v6, s[12:15], s31 offen lds
    s_add_u32 m0, s32, 85504
    s_nop 0
    buffer_load_dwordx4 v7, s[12:15], s31 offen lds
    s_add_u32 s31, s31, 81920
    s_cmp_ge_u32 s31, 2211840
    s_cselect_b32 s31, 0, s31
    s_add_u32 m0, s32, 92928
    s_nop 0
    buffer_load_dwordx4 v6, s[12:15], s31 offen lds
    s_add_u32 m0, s32, 93952
    s_nop 0
    buffer_load_dwordx4 v7, s[12:15], s31 offen lds
    s_add_u32 s31, s31, 81920
    s_cmp_ge_u32 s31, 2211840
    s_cselect_b32 s31, 0, s31
    s_add_u32 m0, s32, 101376
    s_nop 0
    buffer_load_dwordx4 v6, s[12:15], s31 offen lds
    s_add_u32 m0, s32, 102400
    s_nop 0
    buffer_load_dwordx4 v7, s[12:15], s31 offen lds
    s_add_u32 s31, s31, 81920
    s_cmp_ge_u32 s31, 2211840
    s_cselect_b32 s31, 0, s31
    s_add_u32 m0, s32, 109824
    s_nop 0
    buffer_load_dwordx4 v6, s[12:15], s31 offen lds
    s_add_u32 m0, s32, 110848
    s_nop 0
    buffer_load_dwordx4 v7, s[12:15], s31 offen lds
    s_add_u32 s31, s31, 81920
    s_cmp_ge_u32 s31, 2211840
    s_cselect_b32 s31, 0, s31
    s_barrier
    s_add_u32 m0, s32, 118272
    s_nop 0
    buffer_load_dwordx4 v6, s[12:15], s31 offen lds
    s_add_u32 m0, s32, 119296
    s_nop 0
    buffer_load_dwordx4 v7, s[12:15], s31 offen lds
    s_add_u32 s31, s31, 81920
    s_cmp_ge_u32 s31, 2211840
    s_cselect_b32 s31, 0, s31
    s_barrier
    s_add_u32 m0, s32, 126720
    s_nop 0
    buffer_load_dwordx4 v6, s[12:15], s31 offen lds
    s_add_u32 m0, s32, 127744
    s_nop 0
    buffer_load_dwordx4 v7, s[12:15], s31 offen lds
    s_add_u32 s31, s31, 81920
    s_cmp_ge_u32 s31, 2211840
    s_cselect_b32 s31, 0, s31
    s_barrier
    s_add_u32 m0, s32, 135168
    s_nop 0
    buffer_load_dwordx4 v6, s[12:15], s31 offen lds
    s_add_u32 m0, s32, 136192
    s_nop 0
    buffer_load_dwordx4 v7, s[12:15], s31 offen lds
    s_add_u32 s31, s31, 81920
    s_cmp_ge_u32 s31, 2211840
    s_cselect_b32 s31, 0, s31
    s_barrier
    s_add_u32 m0, s32, 0
    s_nop 0
    buffer_load_dwordx4 v6, s[12:15], s31 offen lds
    s_add_u32 m0, s32, 1024
    s_nop 0
    buffer_load_dwordx4 v7, s[12:15], s31 offen lds
    s_add_u32 s31, s31, 81920
    s_cmp_ge_u32 s31, 2211840
    s_cselect_b32 s31, 0, s31
    s_barrier
    s_add_u32 m0, s32, 8448
    s_nop 0
    buffer_load_dwordx4 v6, s[12:15], s31 offen lds
    s_add_u32 m0, s32, 9472
    s_nop 0
    buffer_load_dwordx4 v7, s[12:15], s31 offen lds
    s_add_u32 s31, s31, 81920
    s_cmp_ge_u32 s31, 2211840
    s_cselect_b32 s31, 0, s31
    s_barrier
    s_add_u32 m0, s32, 16896
    s_nop 0
    buffer_load_dwordx4 v6, s[12:15], s31 offen lds
    s_add_u32 m0, s32, 17920
    s_nop 0
    buffer_load_dwordx4 v7, s[12:15], s31 offen lds
    s_add_u32 s31, s31, 81920
    s_cmp_ge_u32 s31, 2211840
    s_cselect_b32 s31, 0, s31
    s_barrier
    s_add_u32 m0, s32, 25344
    s_nop 0
    buffer_load_dwordx4 v6, s[12:15], s31 offen lds
    s_add_u32 m0, s32, 26368
    s_nop 0
    buffer_load_dwordx4 v7, s[12:15], s31 offen lds
    s_add_u32 s31, s31, 81920
    s_cmp_ge_u32 s31, 2211840
    s_cselect_b32 s31, 0, s31
    s_barrier
    s_add_u32 m0, s32, 33792
    s_nop 0
    buffer_load_dwordx4 v6, s[12:15], s31 offen lds
    s_add_u32 m0, s32, 34816
    s_nop 0
    buffer_load_dwordx4 v7, s[12:15], s31 offen lds
    s_add_u32 s31, s31, 81920
    s_cmp_ge_u32 s31, 2211840
    s_cselect_b32 s31, 0, s31
    s_barrier
    s_add_u32 m0, s32, 42240
    s_nop 0
    buffer_load_dwordx4 v6, s[12:15], s31 offen lds
    s_add_u32 m0, s32, 43264
    s_nop 0
    buffer_load_dwordx4 v7, s[12:15], s31 offen lds
    s_add_u32 s31, s31, 81920
    s_cmp_ge_u32 s31, 2211840
    s_cselect_b32 s31, 0, s31
    s_barrier
    s_add_u32 m0, s32, 50688
    s_nop 0
    buffer_load_dwordx4 v6, s[12:15], s31 offen lds
    s_add_u32 m0, s32, 51712
    s_nop 0
    buffer_load_dwordx4 v7, s[12:15], s31 offen lds
    s_add_u32 s31, s31, 81920
    s_cmp_ge_u32 s31, 2211840
    s_cselect_b32 s31, 0, s31
    s_waitcnt vmcnt(26)
    s_barrier
    s_add_u32 m0, s32, 59136
    s_nop 0
    buffer_load_dwordx4 v6, s[12:15], s31 offen lds
    s_add_u32 m0, s32, 60160
    s_nop 0
    buffer_load_dwordx4 v7, s[12:15], s31 offen lds
    s_add_u32 s31, s31, 81920
    s_cmp_ge_u32 s31, 2211840
    s_cselect_b32 s31, 0, s31
    s_waitcnt vmcnt(26)
    s_barrier
    s_add_u32 m0, s32, 67584
    s_nop 0
    buffer_load_dwordx4 v6, s[12:15], s31 offen lds
    s_add_u32 m0, s32, 68608
    s_nop 0
    buffer_load_dwordx4 v7, s[12:15], s31 offen lds
    s_add_u32 s31, s31, 81920
    s_cmp_ge_u32 s31, 2211840
    s_cselect_b32 s31, 0, s31
    s_waitcnt vmcnt(26)
    s_barrier
    s_add_u32 m0, s32, 76032
    s_nop 0
    buffer_load_dwordx4 v6, s[12:15], s31 offen lds
    s_add_u32 m0, s32, 77056
    s_nop 0
    buffer_load_dwordx4 v7, s[12:15], s31 offen lds
    s_waitcnt vmcnt(26)
    s_barrier
    s_waitcnt vmcnt(24)
    s_barrier
    s_waitcnt vmcnt(22)
    s_barrier
    s_waitcnt vmcnt(20)
    s_barrier
    s_waitcnt vmcnt(18)
    s_barrier
    s_waitcnt vmcnt(16)
    s_barrier
    s_waitcnt vmcnt(14)
    s_barrier
    s_waitcnt vmcnt(12)
    s_barrier
    s_waitcnt vmcnt(10)
    s_barrier
    s_waitcnt vmcnt(8)
    s_barrier
    s_waitcnt vmcnt(6)
    s_barrier
    s_waitcnt vmcnt(4)
    s_barrier
    s_waitcnt vmcnt(2)
    s_barrier
    s_waitcnt vmcnt(0)
    s_barrier
    s_barrier
    s_branch L_p5_done
L_p5_idle:
    s_mov_b32 s21, 0
L_p5_idle_loop:
    s_cmp_lg_u32 s21, 6
    s_cbranch_scc1 L_p5_idle3
    s_waitcnt vmcnt(0)
L_p5_idle3:
    s_barrier
    s_add_u32 s21, s21, 1
    s_cmp_lt_u32 s21, 29
    s_cbranch_scc1 L_p5_idle_loop
    s_branch L_p5_done
L_p5_comp:
    v_lshrrev_b32 v16, 4, v2
    s_lshr_b32 s21, s27, 4
    v_add_u32 v16, s21, v16
    s_mov_b32 s21, 55296
    v_mul_lo_u32 v4, v16, s21
    v_lshl_add_u32 v4, v3, 8, v4
    v_and_b32 v16, 15, v2
    v_lshl_add_u32 v4, v16, 4, v4
    v_bfe_u32 v16, v1, 2, 2
    v_mul_u32_u24 v8, 2112, v16
    v_mul_u32_u24 v16, 128, v3
    v_add_u32 v8, v8, v16
    v_bfe_u32 v16, v1, 4, 1
    v_mul_u32_u24 v16, 32, v16
    v_add_u32 v8, v8, v16
    v_and_b32 v16, 3, v1
    v_lshl_add_u32 v8, v16, 3, v8
    v_add_u32 v8, 16960, v8
    v_add_u32 v9, 59136, v8
    v_add_u32 v13, 118272, v8
    v_lshrrev_b32 v16, 4, v2
    s_lshr_b32 s21, s27, 4
    v_add_u32 v16, s21, v16
    s_mov_b32 s21, 20480
    v_mul_lo_u32 v10, v16, s21
    v_lshl_add_u32 v10, v3, 8, v10
    v_and_b32 v16, 15, v2
    v_lshl_add_u32 v10, v16, 4, v10
    s_lshl_b32 s21, s28, 11
    v_add_u32 v10, s21, v10
    v_add_u32 v16, s27, v2
    v_mul_u32_u24 v12, 1280, v16
    s_lshl_b32 s21, s28, 7
    v_add_u32 v12, s21, v12
    v_lshl_add_u32 v12, v3, 5, v12
    v_add_u32 v16, s24, v2
    v_lshlrev_b32 v11, 3, v16
    s_mul_i32 s21, s18, 10
    s_add_u32 s21, s21, s28
    s_lshl_b32 s21, s21, 11
    v_add_u32 v11, s21, v11
    s_add_u32 s8, s6, 0x900000
    s_addc_u32 s9, s7, 0
    s_mov_b32 s10, 0x6c0000
    s_mov_b32 s11, 0x20000
    s_add_u32 s36, s6, 0x300000
    s_addc_u32 s37, s7, 0
    s_mov_b32 s38, 0x280000
    s_mov_b32 s39, 0x20000
    s_add_u32 s76, s6, 0x2000000
    s_addc_u32 s77, s7, 0
    s_mov_b32 s78, 0x280000
    s_mov_b32 s79, 0x20000
    s_add_u32 s80, s6, 0x3800000
    s_addc_u32 s81, s7, 0
    s_mov_b32 s82, 0x28000
    s_mov_b32 s83, 0x20000
    buffer_load_dwordx4 v[80:83], v10, s[36:39], 0 offen offset:0 sc1
    buffer_load_dwordx4 v[84:87], v10, s[36:39], 0 offen offset:512 sc1
    buffer_load_dwordx4 v[88:91], v10, s[36:39], 0 offen offset:1024 sc1
    buffer_load_dwordx4 v[92:95], v10, s[36:39], 0 offen offset:1536 sc1
    s_waitcnt vmcnt(0)
    v_lshlrev_b32 v48, 16, v80
    v_and_b32 v49, 0xffff0000, v80
    v_lshlrev_b32 v50, 16, v81
    v_and_b32 v51, 0xffff0000, v81
    v_lshlrev_b32 v56, 16, v82
    v_and_b32 v57, 0xffff0000, v82
    v_lshlrev_b32 v58, 16, v83
    v_and_b32 v59, 0xffff0000, v83
    v_lshlrev_b32 v52, 16, v84
    v_and_b32 v53, 0xffff0000, v84
    v_lshlrev_b32 v54, 16, v85
    v_and_b32 v55, 0xffff0000, v85
    v_lshlrev_b32 v60, 16, v86
    v_and_b32 v61, 0xffff0000, v86
    v_lshlrev_b32 v62, 16, v87
    v_and_b32 v63, 0xffff0000, v87
    v_lshlrev_b32 v64, 16, v88
    v_and_b32 v65, 0xffff0000, v88
    v_lshlrev_b32 v66, 16, v89
    v_and_b32 v67, 0xffff0000, v89
    v_lshlrev_b32 v72, 16, v90
    v_and_b32 v73, 0xffff0000, v90
    v_lshlrev_b32 v74, 16, v91
    v_and_b32 v75, 0xffff0000, v91
    v_lshlrev_b32 v68, 16, v92
    v_and_b32 v69, 0xffff0000, v92
    v_lshlrev_b32 v70, 16, v93
    v_and_b32 v71, 0xffff0000, v93
    v_lshlrev_b32 v76, 16, v94
    v_and_b32 v77, 0xffff0000, v94
    v_lshlrev_b32 v78, 16, v95
    v_and_b32 v79, 0xffff0000, v95
    v_and_b32 v17, 7, v1
    v_lshlrev_b32 v18, 5, v17
    v_mov_b32 v16, 0
    v_cmp_eq_u32 vcc, 6, v17
    v_mov_b32 v18, 0x10101
    s_nop 0
    v_cndmask_b32 v16, v16, v18, vcc
    v_subrev_u32 v18, 0, v17
    v_cmp_gt_u32 vcc, 6, v18
    v_mov_b32 v18, 0x01010101
    s_nop 0
    v_cndmask_b32 v16, v16, v18, vcc
    v_lshlrev_b32 v17, 2, v17
    s_add_u32 s21, s16, 0x0
    s_lshl_b32 s21, s21, 3
    s_add_u32 s21, s21, 2
    s_lshl_b32 s21, s21, 3
    s_add_u32 s21, s21, s18
    s_lshl_b32 s21, s21, 3
    s_add_u32 s21, s21, s29
    s_lshl_b32 s21, s21, 5
    s_mov_b32 s35, 0
L_wl_59:
    buffer_load_dword v18, v17, s[72:75], s21 offen sc1
    s_waitcnt vmcnt(0)
    v_and_b32 v18, v18, v16
    v_cmp_ne_u32 vcc, v18, v16
    s_add_u32 s35, s35, 1
    s_cmp_gt_u32 s35, 65536
    s_cbranch_scc1 L_wlx_60
    s_cbranch_vccz L_wlx_60
    s_sleep 1
    s_branch L_wl_59
L_wlx_60:
    s_cmp_lg_u32 s17, 0
    s_cbranch_scc1 L_acq_61
    buffer_inv sc1
    s_waitcnt vmcnt(0)
L_acq_61:
    buffer_load_dwordx4 v[96:99], v4, s[8:11], s30 offen offset:0 sc1
    buffer_load_dwordx4 v[100:103], v4, s[8:11], s30 offen offset:512 sc1
    buffer_load_dwordx4 v[104:107], v4, s[8:11], s30 offen offset:1024 sc1
    buffer_load_dwordx4 v[108:111], v4, s[8:11], s30 offen offset:1536 sc1
    s_add_u32 s30, s30, 2048
    s_cmp_ge_u32 s30, 55296
    s_cselect_b32 s30, 0, s30
    buffer_load_dwordx4 v[112:115], v4, s[8:11], s30 offen offset:0 sc1
    buffer_load_dwordx4 v[116:119], v4, s[8:11], s30 offen offset:512 sc1
    buffer_load_dwordx4 v[120:123], v4, s[8:11], s30 offen offset:1024 sc1
    buffer_load_dwordx4 v[124:127], v4, s[8:11], s30 offen offset:1536 sc1
    s_add_u32 s30, s30, 2048
    s_cmp_ge_u32 s30, 55296
    s_cselect_b32 s30, 0, s30
    buffer_load_dwordx4 v[128:131], v4, s[8:11], s30 offen offset:0 sc1
    buffer_load_dwordx4 v[132:135], v4, s[8:11], s30 offen offset:512 sc1
    buffer_load_dwordx4 v[136:139], v4, s[8:11], s30 offen offset:1024 sc1
    buffer_load_dwordx4 v[140:143], v4, s[8:11], s30 offen offset:1536 sc1
    s_add_u32 s30, s30, 2048
    s_cmp_ge_u32 s30, 55296
    s_cselect_b32 s30, 0, s30
    buffer_load_dwordx4 v[144:147], v4, s[8:11], s30 offen offset:0 sc1
    buffer_load_dwordx4 v[148:151], v4, s[8:11], s30 offen offset:512 sc1
    buffer_load_dwordx4 v[152:155], v4, s[8:11], s30 offen offset:1024 sc1
    buffer_load_dwordx4 v[156:159], v4, s[8:11], s30 offen offset:1536 sc1
    s_add_u32 s30, s30, 2048
    s_cmp_ge_u32 s30, 55296
    s_cselect_b32 s30, 0, s30
    s_barrier
    s_barrier
    ds_read_b64_tr_b16 v[24:25], v8 offset:0
    ds_read_b64_tr_b16 v[26:27], v8 offset:512
    ds_read_b64_tr_b16 v[28:29], v8 offset:64
    ds_read_b64_tr_b16 v[30:31], v8 offset:576
    ds_read_b64_tr_b16 v[32:33], v8 offset:256
    ds_read_b64_tr_b16 v[34:35], v8 offset:768
    ds_read_b64_tr_b16 v[36:37], v8 offset:320
    ds_read_b64_tr_b16 v[38:39], v8 offset:832
    s_waitcnt vmcnt(15)
    s_waitcnt lgkmcnt(6)
    v_mfma_f32_32x32x16_bf16 v[48:63], v[24:27], v[96:99], v[48:63]
    ds_read_b64_tr_b16 v[40:41], v8 offset:1024
    ds_read_b64_tr_b16 v[42:43], v8 offset:1536
    s_waitcnt lgkmcnt(6)
    v_mfma_f32_32x32x16_bf16 v[64:79], v[28:31], v[96:99], v[64:79]
    ds_read_b64_tr_b16 v[44:45], v8 offset:1088
    ds_read_b64_tr_b16 v[46:47], v8 offset:1600
    buffer_load_dwordx4 v[160:163], v4, s[8:11], s30 offen offset:0 sc1
    s_waitcnt vmcnt(15)
    s_waitcnt lgkmcnt(6)
    v_mfma_f32_32x32x16_bf16 v[48:63], v[32:35], v[100:103], v[48:63]
    ds_read_b64_tr_b16 v[24:25], v8 offset:1280
    ds_read_b64_tr_b16 v[26:27], v8 offset:1792
    s_waitcnt lgkmcnt(6)
    v_mfma_f32_32x32x16_bf16 v[64:79], v[36:39], v[100:103], v[64:79]
    ds_read_b64_tr_b16 v[28:29], v8 offset:1344
    ds_read_b64_tr_b16 v[30:31], v8 offset:1856
    buffer_load_dwordx4 v[164:167], v4, s[8:11], s30 offen offset:512 sc1
    s_barrier
    s_waitcnt vmcnt(15)
    s_waitcnt lgkmcnt(6)
    v_mfma_f32_32x32x16_bf16 v[48:63], v[40:43], v[104:107], v[48:63]
    ds_read_b64_tr_b16 v[32:33], v8 offset:8448
    ds_read_b64_tr_b16 v[34:35], v8 offset:8960
    s_waitcnt lgkmcnt(6)
    v_mfma_f32_32x32x16_bf16 v[64:79], v[44:47], v[104:107], v[64:79]
    ds_read_b64_tr_b16 v[36:37], v8 offset:8512
    ds_read_b64_tr_b16 v[38:39], v8 offset:9024
    buffer_load_dwordx4 v[168:171], v4, s[8:11], s30 offen offset:1024 sc1
    s_waitcnt vmcnt(15)
    s_waitcnt lgkmcnt(6)
    v_mfma_f32_32x32x16_bf16 v[48:63], v[24:27], v[108:111], v[48:63]
    ds_read_b64_tr_b16 v[40:41], v8 offset:8704
    ds_read_b64_tr_b16 v[42:43], v8 offset:9216
    s_waitcnt lgkmcnt(6)
    v_mfma_f32_32x32x16_bf16 v[64:79], v[28:31], v[108:111], v[64:79]
    ds_read_b64_tr_b16 v[44:45], v8 offset:8768
    ds_read_b64_tr_b16 v[46:47], v8 offset:9280
    buffer_load_dwordx4 v[172:175], v4, s[8:11], s30 offen offset:1536 sc1
    s_add_u32 s30, s30, 2048
    s_cmp_ge_u32 s30, 55296
    s_cselect_b32 s30, 0, s30
    s_waitcnt vmcnt(15)
    s_waitcnt lgkmcnt(6)
    v_mfma_f32_32x32x16_bf16 v[48:63], v[32:35], v[112:115], v[48:63]
    ds_read_b64_tr_b16 v[24:25], v8 offset:9472
    ds_read_b64_tr_b16 v[26:27], v8 offset:9984
    s_waitcnt lgkmcnt(6)
    v_mfma_f32_32x32x16_bf16 v[64:79], v[36:39], v[112:115], v[64:79]
    ds_read_b64_tr_b16 v[28:29], v8 offset:9536
    ds_read_b64_tr_b16 v[30:31], v8 offset:10048
    buffer_load_dwordx4 v[176:179], v4, s[8:11], s30 offen offset:0 sc1
    s_waitcnt vmcnt(15)
    s_waitcnt lgkmcnt(6)
    v_mfma_f32_32x32x16_bf16 v[48:63], v[40:43], v[116:119], v[48:63]
    ds_read_b64_tr_b16 v[32:33], v8 offset:9728
    ds_read_b64_tr_b16 v[34:35], v8 offset:10240
    s_waitcnt lgkmcnt(6)
    v_mfma_f32_32x32x16_bf16 v[64:79], v[44:47], v[116:119], v[64:79]
    ds_read_b64_tr_b16 v[36:37], v8 offset:9792
    ds_read_b64_tr_b16 v[38:39], v8 offset:10304
    buffer_load_dwordx4 v[180:183], v4, s[8:11], s30 offen offset:512 sc1
    s_barrier
    s_waitcnt vmcnt(15)
    s_waitcnt lgkmcnt(6)
    v_mfma_f32_32x32x16_bf16 v[48:63], v[24:27], v[120:123], v[48:63]
    ds_read_b64_tr_b16 v[40:41], v8 offset:16896
    ds_read_b64_tr_b16 v[42:43], v8 offset:17408
    s_waitcnt lgkmcnt(6)
    v_mfma_f32_32x32x16_bf16 v[64:79], v[28:31], v[120:123], v[64:79]
    ds_read_b64_tr_b16 v[44:45], v8 offset:16960
    ds_read_b64_tr_b16 v[46:47], v8 offset:17472
    buffer_load_dwordx4 v[184:187], v4, s[8:11], s30 offen offset:1024 sc1
    s_waitcnt vmcnt(15)
    s_waitcnt lgkmcnt(6)
    v_mfma_f32_32x32x16_bf16 v[48:63], v[32:35], v[124:127], v[48:63]
    ds_read_b64_tr_b16 v[24:25], v8 offset:17152
    ds_read_b64_tr_b16 v[26:27], v8 offset:17664
    s_waitcnt lgkmcnt(6)
    v_mfma_f32_32x32x16_bf16 v[64:79], v[36:39], v[124:127], v[64:79]
    ds_read_b64_tr_b16 v[28:29], v8 offset:17216
    ds_read_b64_tr_b16 v[30:31], v8 offset:17728
    buffer_load_dwordx4 v[188:191], v4, s[8:11], s30 offen offset:1536 sc1
    s_add_u32 s30, s30, 2048
    s_cmp_ge_u32 s30, 55296
    s_cselect_b32 s30, 0, s30
    s_waitcnt vmcnt(15)
    s_waitcnt lgkmcnt(6)
    v_mfma_f32_32x32x16_bf16 v[48:63], v[40:43], v[128:131], v[48:63]
    ds_read_b64_tr_b16 v[32:33], v8 offset:17920
    ds_read_b64_tr_b16 v[34:35], v8 offset:18432
    s_waitcnt lgkmcnt(6)
    v_mfma_f32_32x32x16_bf16 v[64:79], v[44:47], v[128:131], v[64:79]
    ds_read_b64_tr_b16 v[36:37], v8 offset:17984
    ds_read_b64_tr_b16 v[38:39], v8 offset:18496
    buffer_load_dwordx4 v[192:195], v4, s[8:11], s30 offen offset:0 sc1
    s_waitcnt vmcnt(15)
    s_waitcnt lgkmcnt(6)
    v_mfma_f32_32x32x16_bf16 v[48:63], v[24:27], v[132:135], v[48:63]
    ds_read_b64_tr_b16 v[40:41], v8 offset:18176
    ds_read_b64_tr_b16 v[42:43], v8 offset:18688
    s_waitcnt lgkmcnt(6)
    v_mfma_f32_32x32x16_bf16 v[64:79], v[28:31], v[132:135], v[64:79]
    ds_read_b64_tr_b16 v[44:45], v8 offset:18240
    ds_read_b64_tr_b16 v[46:47], v8 offset:18752
    buffer_load_dwordx4 v[196:199], v4, s[8:11], s30 offen offset:512 sc1
    s_barrier
    s_waitcnt vmcnt(15)
    s_waitcnt lgkmcnt(6)
    v_mfma_f32_32x32x16_bf16 v[48:63], v[32:35], v[136:139], v[48:63]
    ds_read_b64_tr_b16 v[24:25], v8 offset:25344
    ds_read_b64_tr_b16 v[26:27], v8 offset:25856
    s_waitcnt lgkmcnt(6)
    v_mfma_f32_32x32x16_bf16 v[64:79], v[36:39], v[136:139], v[64:79]
    ds_read_b64_tr_b16 v[28:29], v8 offset:25408
    ds_read_b64_tr_b16 v[30:31], v8 offset:25920
    buffer_load_dwordx4 v[200:203], v4, s[8:11], s30 offen offset:1024 sc1
    s_waitcnt vmcnt(15)
    s_waitcnt lgkmcnt(6)
    v_mfma_f32_32x32x16_bf16 v[48:63], v[40:43], v[140:143], v[48:63]
    ds_read_b64_tr_b16 v[32:33], v8 offset:25600
    ds_read_b64_tr_b16 v[34:35], v8 offset:26112
    s_waitcnt lgkmcnt(6)
    v_mfma_f32_32x32x16_bf16 v[64:79], v[44:47], v[140:143], v[64:79]
    ds_read_b64_tr_b16 v[36:37], v8 offset:25664
    ds_read_b64_tr_b16 v[38:39], v8 offset:26176
    buffer_load_dwordx4 v[204:207], v4, s[8:11], s30 offen offset:1536 sc1
    s_add_u32 s30, s30, 2048
    s_cmp_ge_u32 s30, 55296
    s_cselect_b32 s30, 0, s30
    s_waitcnt vmcnt(15)
    s_waitcnt lgkmcnt(6)
    v_mfma_f32_32x32x16_bf16 v[48:63], v[24:27], v[144:147], v[48:63]
    ds_read_b64_tr_b16 v[40:41], v8 offset:26368
    ds_read_b64_tr_b16 v[42:43], v8 offset:26880
    s_waitcnt lgkmcnt(6)
    v_mfma_f32_32x32x16_bf16 v[64:79], v[28:31], v[144:147], v[64:79]
    ds_read_b64_tr_b16 v[44:45], v8 offset:26432
    ds_read_b64_tr_b16 v[46:47], v8 offset:26944
    buffer_load_dwordx4 v[208:211], v4, s[8:11], s30 offen offset:0 sc1
    s_waitcnt vmcnt(15)
    s_waitcnt lgkmcnt(6)
    v_mfma_f32_32x32x16_bf16 v[48:63], v[32:35], v[148:151], v[48:63]
    ds_read_b64_tr_b16 v[24:25], v8 offset:26624
    ds_read_b64_tr_b16 v[26:27], v8 offset:27136
    s_waitcnt lgkmcnt(6)
    v_mfma_f32_32x32x16_bf16 v[64:79], v[36:39], v[148:151], v[64:79]
    ds_read_b64_tr_b16 v[28:29], v8 offset:26688
    ds_read_b64_tr_b16 v[30:31], v8 offset:27200
    buffer_load_dwordx4 v[212:215], v4, s[8:11], s30 offen offset:512 sc1
    s_barrier
    s_waitcnt vmcnt(15)
    s_waitcnt lgkmcnt(6)
    v_mfma_f32_32x32x16_bf16 v[48:63], v[40:43], v[152:155], v[48:63]
    ds_read_b64_tr_b16 v[32:33], v8 offset:33792
    ds_read_b64_tr_b16 v[34:35], v8 offset:34304
    s_waitcnt lgkmcnt(6)
    v_mfma_f32_32x32x16_bf16 v[64:79], v[44:47], v[152:155], v[64:79]
    ds_read_b64_tr_b16 v[36:37], v8 offset:33856
    ds_read_b64_tr_b16 v[38:39], v8 offset:34368
    buffer_load_dwordx4 v[216:219], v4, s[8:11], s30 offen offset:1024 sc1
    s_waitcnt vmcnt(15)
    s_waitcnt lgkmcnt(6)
    v_mfma_f32_32x32x16_bf16 v[48:63], v[24:27], v[156:159], v[48:63]
    ds_read_b64_tr_b16 v[40:41], v8 offset:34048
    ds_read_b64_tr_b16 v[42:43], v8 offset:34560
    s_waitcnt lgkmcnt(6)
    v_mfma_f32_32x32x16_bf16 v[64:79], v[28:31], v[156:159], v[64:79]
    ds_read_b64_tr_b16 v[44:45], v8 offset:34112
    ds_read_b64_tr_b16 v[46:47], v8 offset:34624
    buffer_load_dwordx4 v[220:223], v4, s[8:11], s30 offen offset:1536 sc1
    s_add_u32 s30, s30, 2048
    s_cmp_ge_u32 s30, 55296
    s_cselect_b32 s30, 0, s30
    s_waitcnt vmcnt(15)
    s_waitcnt lgkmcnt(6)
    v_mfma_f32_32x32x16_bf16 v[48:63], v[32:35], v[160:163], v[48:63]
    ds_read_b64_tr_b16 v[24:25], v8 offset:34816
    ds_read_b64_tr_b16 v[26:27], v8 offset:35328
    s_waitcnt lgkmcnt(6)
    v_mfma_f32_32x32x16_bf16 v[64:79], v[36:39], v[160:163], v[64:79]
    ds_read_b64_tr_b16 v[28:29], v8 offset:34880
    ds_read_b64_tr_b16 v[30:31], v8 offset:35392
    buffer_load_dwordx4 v[224:227], v4, s[8:11], s30 offen offset:0 sc1
    s_waitcnt vmcnt(15)
    s_waitcnt lgkmcnt(6)
    v_mfma_f32_32x32x16_bf16 v[48:63], v[40:43], v[164:167], v[48:63]
    ds_read_b64_tr_b16 v[32:33], v8 offset:35072
    ds_read_b64_tr_b16 v[34:35], v8 offset:35584
    s_waitcnt lgkmcnt(6)
    v_mfma_f32_32x32x16_bf16 v[64:79], v[44:47], v[164:167], v[64:79]
    ds_read_b64_tr_b16 v[36:37], v8 offset:35136
    ds_read_b64_tr_b16 v[38:39], v8 offset:35648
    buffer_load_dwordx4 v[228:231], v4, s[8:11], s30 offen offset:512 sc1
    s_barrier
    s_waitcnt vmcnt(15)
    s_waitcnt lgkmcnt(6)
    v_mfma_f32_32x32x16_bf16 v[48:63], v[24:27], v[168:171], v[48:63]
    ds_read_b64_tr_b16 v[40:41], v8 offset:42240
    ds_read_b64_tr_b16 v[42:43], v8 offset:42752
    s_waitcnt lgkmcnt(6)
    v_mfma_f32_32x32x16_bf16 v[64:79], v[28:31], v[168:171], v[64:79]
    ds_read_b64_tr_b16 v[44:45], v8 offset:42304
    ds_read_b64_tr_b16 v[46:47], v8 offset:42816
    buffer_load_dwordx4 v[232:235], v4, s[8:11], s30 offen offset:1024 sc1
    s_waitcnt vmcnt(15)
    s_waitcnt lgkmcnt(6)
    v_mfma_f32_32x32x16_bf16 v[48:63], v[32:35], v[172:175], v[48:63]
    ds_read_b64_tr_b16 v[24:25], v8 offset:42496
    ds_read_b64_tr_b16 v[26:27], v8 offset:43008
    s_waitcnt lgkmcnt(6)
    v_mfma_f32_32x32x16_bf16 v[64:79], v[36:39], v[172:175], v[64:79]
    ds_read_b64_tr_b16 v[28:29], v8 offset:42560
    ds_read_b64_tr_b16 v[30:31], v8 offset:43072
    buffer_load_dwordx4 v[236:239], v4, s[8:11], s30 offen offset:1536 sc1
    s_add_u32 s30, s30, 2048
    s_cmp_ge_u32 s30, 55296
    s_cselect_b32 s30, 0, s30
    s_waitcnt vmcnt(15)
    s_waitcnt lgkmcnt(6)
    v_mfma_f32_32x32x16_bf16 v[48:63], v[40:43], v[176:179], v[48:63]
    ds_read_b64_tr_b16 v[32:33], v8 offset:43264
    ds_read_b64_tr_b16 v[34:35], v8 offset:43776
    s_waitcnt lgkmcnt(6)
    v_mfma_f32_32x32x16_bf16 v[64:79], v[44:47], v[176:179], v[64:79]
    ds_read_b64_tr_b16 v[36:37], v8 offset:43328
    ds_read_b64_tr_b16 v[38:39], v8 offset:43840
    buffer_load_dwordx4 v[96:99], v4, s[8:11], s30 offen offset:0 sc1
    s_waitcnt vmcnt(15)
    s_waitcnt lgkmcnt(6)
    v_mfma_f32_32x32x16_bf16 v[48:63], v[24:27], v[180:183], v[48:63]
    ds_read_b64_tr_b16 v[40:41], v8 offset:43520
    ds_read_b64_tr_b16 v[42:43], v8 offset:44032
    s_waitcnt lgkmcnt(6)
    v_mfma_f32_32x32x16_bf16 v[64:79], v[28:31], v[180:183], v[64:79]
    ds_read_b64_tr_b16 v[44:45], v8 offset:43584
    ds_read_b64_tr_b16 v[46:47], v8 offset:44096
    buffer_load_dwordx4 v[100:103], v4, s[8:11], s30 offen offset:512 sc1
    s_barrier
    s_waitcnt vmcnt(15)
    s_waitcnt lgkmcnt(6)
    v_mfma_f32_32x32x16_bf16 v[48:63], v[32:35], v[184:187], v[48:63]
    ds_read_b64_tr_b16 v[24:25], v8 offset:50688
    ds_read_b64_tr_b16 v[26:27], v8 offset:51200
    s_waitcnt lgkmcnt(6)
    v_mfma_f32_32x32x16_bf16 v[64:79], v[36:39], v[184:187], v[64:79]
    ds_read_b64_tr_b16 v[28:29], v8 offset:50752
    ds_read_b64_tr_b16 v[30:31], v8 offset:51264
    buffer_load_dwordx4 v[104:107], v4, s[8:11], s30 offen offset:1024 sc1
    s_waitcnt vmcnt(15)
    s_waitcnt lgkmcnt(6)
    v_mfma_f32_32x32x16_bf16 v[48:63], v[40:43], v[188:191], v[48:63]
    ds_read_b64_tr_b16 v[32:33], v8 offset:50944
    ds_read_b64_tr_b16 v[34:35], v8 offset:51456
    s_waitcnt lgkmcnt(6)
    v_mfma_f32_32x32x16_bf16 v[64:79], v[44:47], v[188:191], v[64:79]
    ds_read_b64_tr_b16 v[36:37], v8 offset:51008
    ds_read_b64_tr_b16 v[38:39], v8 offset:51520
    buffer_load_dwordx4 v[108:111], v4, s[8:11], s30 offen offset:1536 sc1
    s_add_u32 s30, s30, 2048
    s_cmp_ge_u32 s30, 55296
    s_cselect_b32 s30, 0, s30
    s_waitcnt vmcnt(15)
    s_waitcnt lgkmcnt(6)
    v_mfma_f32_32x32x16_bf16 v[48:63], v[24:27], v[192:195], v[48:63]
    ds_read_b64_tr_b16 v[40:41], v8 offset:51712
    ds_read_b64_tr_b16 v[42:43], v8 offset:52224
    s_waitcnt lgkmcnt(6)
    v_mfma_f32_32x32x16_bf16 v[64:79], v[28:31], v[192:195], v[64:79]
    ds_read_b64_tr_b16 v[44:45], v8 offset:51776
    ds_read_b64_tr_b16 v[46:47], v8 offset:52288
    buffer_load_dwordx4 v[112:115], v4, s[8:11], s30 offen offset:0 sc1
    s_waitcnt vmcnt(15)
    s_waitcnt lgkmcnt(6)
    v_mfma_f32_32x32x16_bf16 v[48:63], v[32:35], v[196:199], v[48:63]
    ds_read_b64_tr_b16 v[24:25], v8 offset:51968
    ds_read_b64_tr_b16 v[26:27], v8 offset:52480
    s_waitcnt lgkmcnt(6)
    v_mfma_f32_32x32x16_bf16 v[64:79], v[36:39], v[196:199], v[64:79]
    ds_read_b64_tr_b16 v[28:29], v8 offset:52032
    ds_read_b64_tr_b16 v[30:31], v8 offset:52544
    buffer_load_dwordx4 v[116:119], v4, s[8:11], s30 offen offset:512 sc1
    s_barrier
    s_waitcnt vmcnt(15)
    s_waitcnt lgkmcnt(6)
    v_mfma_f32_32x32x16_bf16 v[48:63], v[40:43], v[200:203], v[48:63]
    ds_read_b64_tr_b16 v[32:33], v9 offset:0
    ds_read_b64_tr_b16 v[34:35], v9 offset:512
    s_waitcnt lgkmcnt(6)
    v_mfma_f32_32x32x16_bf16 v[64:79], v[44:47], v[200:203], v[64:79]
    ds_read_b64_tr_b16 v[36:37], v9 offset:64
    ds_read_b64_tr_b16 v[38:39], v9 offset:576
    buffer_load_dwordx4 v[120:123], v4, s[8:11], s30 offen offset:1024 sc1
    s_waitcnt vmcnt(15)
    s_waitcnt lgkmcnt(6)
    v_mfma_f32_32x32x16_bf16 v[48:63], v[24:27], v[204:207], v[48:63]
    ds_read_b64_tr_b16 v[40:41], v9 offset:256
    ds_read_b64_tr_b16 v[42:43], v9 offset:768
    s_waitcnt lgkmcnt(6)
    v_mfma_f32_32x32x16_bf16 v[64:79], v[28:31], v[204:207], v[64:79]
    ds_read_b64_tr_b16 v[44:45], v9 offset:320
    ds_read_b64_tr_b16 v[46:47], v9 offset:832
    buffer_load_dwordx4 v[124:127], v4, s[8:11], s30 offen offset:1536 sc1
    s_add_u32 s30, s30, 2048
    s_cmp_ge_u32 s30, 55296
    s_cselect_b32 s30, 0, s30
    s_waitcnt vmcnt(15)
    s_waitcnt lgkmcnt(6)
    v_mfma_f32_32x32x16_bf16 v[48:63], v[32:35], v[208:211], v[48:63]
    ds_read_b64_tr_b16 v[24:25], v9 offset:1024
    ds_read_b64_tr_b16 v[26:27], v9 offset:1536
    s_waitcnt lgkmcnt(6)
    v_mfma_f32_32x32x16_bf16 v[64:79], v[36:39], v[208:211], v[64:79]
    ds_read_b64_tr_b16 v[28:29], v9 offset:1088
    ds_read_b64_tr_b16 v[30:31], v9 offset:1600
    buffer_load_dwordx4 v[128:131], v4, s[8:11], s30 offen offset:0 sc1
    s_waitcnt vmcnt(15)
    s_waitcnt lgkmcnt(6)
    v_mfma_f32_32x32x16_bf16 v[48:63], v[40:43], v[212:215], v[48:63]
    ds_read_b64_tr_b16 v[32:33], v9 offset:1280
    ds_read_b64_tr_b16 v[34:35], v9 offset:1792
    s_waitcnt lgkmcnt(6)
    v_mfma_f32_32x32x16_bf16 v[64:79], v[44:47], v[212:215], v[64:79]
    ds_read_b64_tr_b16 v[36:37], v9 offset:1344
    ds_read_b64_tr_b16 v[38:39], v9 offset:1856
    buffer_load_dwordx4 v[132:135], v4, s[8:11], s30 offen offset:512 sc1
    s_barrier
    s_waitcnt vmcnt(15)
    s_waitcnt lgkmcnt(6)
    v_mfma_f32_32x32x16_bf16 v[48:63], v[24:27], v[216:219], v[48:63]
    ds_read_b64_tr_b16 v[40:41], v9 offset:8448
    ds_read_b64_tr_b16 v[42:43], v9 offset:8960
    s_waitcnt lgkmcnt(6)
    v_mfma_f32_32x32x16_bf16 v[64:79], v[28:31], v[216:219], v[64:79]
    ds_read_b64_tr_b16 v[44:45], v9 offset:8512
    ds_read_b64_tr_b16 v[46:47], v9 offset:9024
    buffer_load_dwordx4 v[136:139], v4, s[8:11], s30 offen offset:1024 sc1
    s_waitcnt vmcnt(15)
    s_waitcnt lgkmcnt(6)
    v_mfma_f32_32x32x16_bf16 v[48:63], v[32:35], v[220:223], v[48:63]
    ds_read_b64_tr_b16 v[24:25], v9 offset:8704
    ds_read_b64_tr_b16 v[26:27], v9 offset:9216
    s_waitcnt lgkmcnt(6)
    v_mfma_f32_32x32x16_bf16 v[64:79], v[36:39], v[220:223], v[64:79]
    ds_read_b64_tr_b16 v[28:29], v9 offset:8768
    ds_read_b64_tr_b16 v[30:31], v9 offset:9280
    buffer_load_dwordx4 v[140:143], v4, s[8:11], s30 offen offset:1536 sc1
    s_add_u32 s30, s30, 2048
    s_cmp_ge_u32 s30, 55296
    s_cselect_b32 s30, 0, s30
    s_waitcnt vmcnt(15)
    s_waitcnt lgkmcnt(6)
    v_mfma_f32_32x32x16_bf16 v[48:63], v[40:43], v[224:227], v[48:63]
    ds_read_b64_tr_b16 v[32:33], v9 offset:9472
    ds_read_b64_tr_b16 v[34:35], v9 offset:9984
    s_waitcnt lgkmcnt(6)
    v_mfma_f32_32x32x16_bf16 v[64:79], v[44:47], v[224:227], v[64:79]
    ds_read_b64_tr_b16 v[36:37], v9 offset:9536
    ds_read_b64_tr_b16 v[38:39], v9 offset:10048
    buffer_load_dwordx4 v[144:147], v4, s[8:11], s30 offen offset:0 sc1
    s_waitcnt vmcnt(15)
    s_waitcnt lgkmcnt(6)
    v_mfma_f32_32x32x16_bf16 v[48:63], v[24:27], v[228:231], v[48:63]
    ds_read_b64_tr_b16 v[40:41], v9 offset:9728
    ds_read_b64_tr_b16 v[42:43], v9 offset:10240
    s_waitcnt lgkmcnt(6)
    v_mfma_f32_32x32x16_bf16 v[64:79], v[28:31], v[228:231], v[64:79]
    ds_read_b64_tr_b16 v[44:45], v9 offset:9792
    ds_read_b64_tr_b16 v[46:47], v9 offset:10304
    buffer_load_dwordx4 v[148:151], v4, s[8:11], s30 offen offset:512 sc1
    s_barrier
    s_waitcnt vmcnt(15)
    s_waitcnt lgkmcnt(6)
    v_mfma_f32_32x32x16_bf16 v[48:63], v[32:35], v[232:235], v[48:63]
    ds_read_b64_tr_b16 v[24:25], v9 offset:16896
    ds_read_b64_tr_b16 v[26:27], v9 offset:17408
    s_waitcnt lgkmcnt(6)
    v_mfma_f32_32x32x16_bf16 v[64:79], v[36:39], v[232:235], v[64:79]
    ds_read_b64_tr_b16 v[28:29], v9 offset:16960
    ds_read_b64_tr_b16 v[30:31], v9 offset:17472
    buffer_load_dwordx4 v[152:155], v4, s[8:11], s30 offen offset:1024 sc1
    s_waitcnt vmcnt(15)
    s_waitcnt lgkmcnt(6)
    v_mfma_f32_32x32x16_bf16 v[48:63], v[40:43], v[236:239], v[48:63]
    ds_read_b64_tr_b16 v[32:33], v9 offset:17152
    ds_read_b64_tr_b16 v[34:35], v9 offset:17664
    s_waitcnt lgkmcnt(6)
    v_mfma_f32_32x32x16_bf16 v[64:79], v[44:47], v[236:239], v[64:79]
    ds_read_b64_tr_b16 v[36:37], v9 offset:17216
    ds_read_b64_tr_b16 v[38:39], v9 offset:17728
    buffer_load_dwordx4 v[156:159], v4, s[8:11], s30 offen offset:1536 sc1
    s_add_u32 s30, s30, 2048
    s_cmp_ge_u32 s30, 55296
    s_cselect_b32 s30, 0, s30
    s_waitcnt vmcnt(15)
    s_waitcnt lgkmcnt(6)
    v_mfma_f32_32x32x16_bf16 v[48:63], v[24:27], v[96:99], v[48:63]
    ds_read_b64_tr_b16 v[40:41], v9 offset:17920
    ds_read_b64_tr_b16 v[42:43], v9 offset:18432
    s_waitcnt lgkmcnt(6)
    v_mfma_f32_32x32x16_bf16 v[64:79], v[28:31], v[96:99], v[64:79]
    ds_read_b64_tr_b16 v[44:45], v9 offset:17984
    ds_read_b64_tr_b16 v[46:47], v9 offset:18496
    buffer_load_dwordx4 v[160:163], v4, s[8:11], s30 offen offset:0 sc1
    s_waitcnt vmcnt(15)
    s_waitcnt lgkmcnt(6)
    v_mfma_f32_32x32x16_bf16 v[48:63], v[32:35], v[100:103], v[48:63]
    ds_read_b64_tr_b16 v[24:25], v9 offset:18176
    ds_read_b64_tr_b16 v[26:27], v9 offset:18688
    s_waitcnt lgkmcnt(6)
    v_mfma_f32_32x32x16_bf16 v[64:79], v[36:39], v[100:103], v[64:79]
    ds_read_b64_tr_b16 v[28:29], v9 offset:18240
    ds_read_b64_tr_b16 v[30:31], v9 offset:18752
    buffer_load_dwordx4 v[164:167], v4, s[8:11], s30 offen offset:512 sc1
    s_barrier
    s_waitcnt vmcnt(15)
    s_waitcnt lgkmcnt(6)
    v_mfma_f32_32x32x16_bf16 v[48:63], v[40:43], v[104:107], v[48:63]
    ds_read_b64_tr_b16 v[32:33], v9 offset:25344
    ds_read_b64_tr_b16 v[34:35], v9 offset:25856
    s_waitcnt lgkmcnt(6)
    v_mfma_f32_32x32x16_bf16 v[64:79], v[44:47], v[104:107], v[64:79]
    ds_read_b64_tr_b16 v[36:37], v9 offset:25408
    ds_read_b64_tr_b16 v[38:39], v9 offset:25920
    buffer_load_dwordx4 v[168:171], v4, s[8:11], s30 offen offset:1024 sc1
    s_waitcnt vmcnt(15)
    s_waitcnt lgkmcnt(6)
    v_mfma_f32_32x32x16_bf16 v[48:63], v[24:27], v[108:111], v[48:63]
    ds_read_b64_tr_b16 v[40:41], v9 offset:25600
    ds_read_b64_tr_b16 v[42:43], v9 offset:26112
    s_waitcnt lgkmcnt(6)
    v_mfma_f32_32x32x16_bf16 v[64:79], v[28:31], v[108:111], v[64:79]
    ds_read_b64_tr_b16 v[44:45], v9 offset:25664
    ds_read_b64_tr_b16 v[46:47], v9 offset:26176
    buffer_load_dwordx4 v[172:175], v4, s[8:11], s30 offen offset:1536 sc1
    s_add_u32 s30, s30, 2048
    s_cmp_ge_u32 s30, 55296
    s_cselect_b32 s30, 0, s30
    s_waitcnt vmcnt(15)
    s_waitcnt lgkmcnt(6)
    v_mfma_f32_32x32x16_bf16 v[48:63], v[32:35], v[112:115], v[48:63]
    ds_read_b64_tr_b16 v[24:25], v9 offset:26368
    ds_read_b64_tr_b16 v[26:27], v9 offset:26880
    s_waitcnt lgkmcnt(6)
    v_mfma_f32_32x32x16_bf16 v[64:79], v[36:39], v[112:115], v[64:79]
    ds_read_b64_tr_b16 v[28:29], v9 offset:26432
    ds_read_b64_tr_b16 v[30:31], v9 offset:26944
    buffer_load_dwordx4 v[176:179], v4, s[8:11], s30 offen offset:0 sc1
    s_waitcnt vmcnt(15)
    s_waitcnt lgkmcnt(6)
    v_mfma_f32_32x32x16_bf16 v[48:63], v[40:43], v[116:119], v[48:63]
    ds_read_b64_tr_b16 v[32:33], v9 offset:26624
    ds_read_b64_tr_b16 v[34:35], v9 offset:27136
    s_waitcnt lgkmcnt(6)
    v_mfma_f32_32x32x16_bf16 v[64:79], v[44:47], v[116:119], v[64:79]
    ds_read_b64_tr_b16 v[36:37], v9 offset:26688
    ds_read_b64_tr_b16 v[38:39], v9 offset:27200
    buffer_load_dwordx4 v[180:183], v4, s[8:11], s30 offen offset:512 sc1
    s_barrier
    s_waitcnt vmcnt(15)
    s_waitcnt lgkmcnt(6)
    v_mfma_f32_32x32x16_bf16 v[48:63], v[24:27], v[120:123], v[48:63]
    ds_read_b64_tr_b16 v[40:41], v9 offset:33792
    ds_read_b64_tr_b16 v[42:43], v9 offset:34304
    s_waitcnt lgkmcnt(6)
    v_mfma_f32_32x32x16_bf16 v[64:79], v[28:31], v[120:123], v[64:79]
    ds_read_b64_tr_b16 v[44:45], v9 offset:33856
    ds_read_b64_tr_b16 v[46:47], v9 offset:34368
    buffer_load_dwordx4 v[184:187], v4, s[8:11], s30 offen offset:1024 sc1
    s_waitcnt vmcnt(15)
    s_waitcnt lgkmcnt(6)
    v_mfma_f32_32x32x16_bf16 v[48:63], v[32:35], v[124:127], v[48:63]
    ds_read_b64_tr_b16 v[24:25], v9 offset:34048
    ds_read_b64_tr_b16 v[26:27], v9 offset:34560
    s_waitcnt lgkmcnt(6)
    v_mfma_f32_32x32x16_bf16 v[64:79], v[36:39], v[124:127], v[64:79]
    ds_read_b64_tr_b16 v[28:29], v9 offset:34112
    ds_read_b64_tr_b16 v[30:31], v9 offset:34624
    buffer_load_dwordx4 v[188:191], v4, s[8:11], s30 offen offset:1536 sc1
    s_add_u32 s30, s30, 2048
    s_cmp_ge_u32 s30, 55296
    s_cselect_b32 s30, 0, s30
    s_waitcnt vmcnt(15)
    s_waitcnt lgkmcnt(6)
    v_mfma_f32_32x32x16_bf16 v[48:63], v[40:43], v[128:131], v[48:63]
    ds_read_b64_tr_b16 v[32:33], v9 offset:34816
    ds_read_b64_tr_b16 v[34:35], v9 offset:35328
    s_waitcnt lgkmcnt(6)
    v_mfma_f32_32x32x16_bf16 v[64:79], v[44:47], v[128:131], v[64:79]
    ds_read_b64_tr_b16 v[36:37], v9 offset:34880
    ds_read_b64_tr_b16 v[38:39], v9 offset:35392
    buffer_load_dwordx4 v[192:195], v4, s[8:11], s30 offen offset:0 sc1
    s_waitcnt vmcnt(15)
    s_waitcnt lgkmcnt(6)
    v_mfma_f32_32x32x16_bf16 v[48:63], v[24:27], v[132:135], v[48:63]
    ds_read_b64_tr_b16 v[40:41], v9 offset:35072
    ds_read_b64_tr_b16 v[42:43], v9 offset:35584
    s_waitcnt lgkmcnt(6)
    v_mfma_f32_32x32x16_bf16 v[64:79], v[28:31], v[132:135], v[64:79]
    ds_read_b64_tr_b16 v[44:45], v9 offset:35136
    ds_read_b64_tr_b16 v[46:47], v9 offset:35648
    buffer_load_dwordx4 v[196:199], v4, s[8:11], s30 offen offset:512 sc1
    s_barrier
    s_waitcnt vmcnt(15)
    s_waitcnt lgkmcnt(6)
    v_mfma_f32_32x32x16_bf16 v[48:63], v[32:35], v[136:139], v[48:63]
    ds_read_b64_tr_b16 v[24:25], v9 offset:42240
    ds_read_b64_tr_b16 v[26:27], v9 offset:42752
    s_waitcnt lgkmcnt(6)
    v_mfma_f32_32x32x16_bf16 v[64:79], v[36:39], v[136:139], v[64:79]
    ds_read_b64_tr_b16 v[28:29], v9 offset:42304
    ds_read_b64_tr_b16 v[30:31], v9 offset:42816
    buffer_load_dwordx4 v[200:203], v4, s[8:11], s30 offen offset:1024 sc1
    s_waitcnt vmcnt(15)
    s_waitcnt lgkmcnt(6)
    v_mfma_f32_32x32x16_bf16 v[48:63], v[40:43], v[140:143], v[48:63]
    ds_read_b64_tr_b16 v[32:33], v9 offset:42496
    ds_read_b64_tr_b16 v[34:35], v9 offset:43008
    s_waitcnt lgkmcnt(6)
    v_mfma_f32_32x32x16_bf16 v[64:79], v[44:47], v[140:143], v[64:79]
    ds_read_b64_tr_b16 v[36:37], v9 offset:42560
    ds_read_b64_tr_b16 v[38:39], v9 offset:43072
    buffer_load_dwordx4 v[204:207], v4, s[8:11], s30 offen offset:1536 sc1
    s_add_u32 s30, s30, 2048
    s_cmp_ge_u32 s30, 55296
    s_cselect_b32 s30, 0, s30
    s_waitcnt vmcnt(15)
    s_waitcnt lgkmcnt(6)
    v_mfma_f32_32x32x16_bf16 v[48:63], v[24:27], v[144:147], v[48:63]
    ds_read_b64_tr_b16 v[40:41], v9 offset:43264
    ds_read_b64_tr_b16 v[42:43], v9 offset:43776
    s_waitcnt lgkmcnt(6)
    v_mfma_f32_32x32x16_bf16 v[64:79], v[28:31], v[144:147], v[64:79]
    ds_read_b64_tr_b16 v[44:45], v9 offset:43328
    ds_read_b64_tr_b16 v[46:47], v9 offset:43840
    buffer_load_dwordx4 v[208:211], v4, s[8:11], s30 offen offset:0 sc1
    s_waitcnt vmcnt(15)
    s_waitcnt lgkmcnt(6)
    v_mfma_f32_32x32x16_bf16 v[48:63], v[32:35], v[148:151], v[48:63]
    ds_read_b64_tr_b16 v[24:25], v9 offset:43520
    ds_read_b64_tr_b16 v[26:27], v9 offset:44032
    s_waitcnt lgkmcnt(6)
    v_mfma_f32_32x32x16_bf16 v[64:79], v[36:39], v[148:151], v[64:79]
    ds_read_b64_tr_b16 v[28:29], v9 offset:43584
    ds_read_b64_tr_b16 v[30:31], v9 offset:44096
    buffer_load_dwordx4 v[212:215], v4, s[8:11], s30 offen offset:512 sc1
    s_barrier
    s_waitcnt vmcnt(15)
    s_waitcnt lgkmcnt(6)
    v_mfma_f32_32x32x16_bf16 v[48:63], v[40:43], v[152:155], v[48:63]
    ds_read_b64_tr_b16 v[32:33], v9 offset:50688
    ds_read_b64_tr_b16 v[34:35], v9 offset:51200
    s_waitcnt lgkmcnt(6)
    v_mfma_f32_32x32x16_bf16 v[64:79], v[44:47], v[152:155], v[64:79]
    ds_read_b64_tr_b16 v[36:37], v9 offset:50752
    ds_read_b64_tr_b16 v[38:39], v9 offset:51264
    buffer_load_dwordx4 v[216:219], v4, s[8:11], s30 offen offset:1024 sc1
    s_waitcnt vmcnt(15)
    s_waitcnt lgkmcnt(6)
    v_mfma_f32_32x32x16_bf16 v[48:63], v[24:27], v[156:159], v[48:63]
    ds_read_b64_tr_b16 v[40:41], v9 offset:50944
    ds_read_b64_tr_b16 v[42:43], v9 offset:51456
    s_waitcnt lgkmcnt(6)
    v_mfma_f32_32x32x16_bf16 v[64:79], v[28:31], v[156:159], v[64:79]
    ds_read_b64_tr_b16 v[44:45], v9 offset:51008
    ds_read_b64_tr_b16 v[46:47], v9 offset:51520
    buffer_load_dwordx4 v[220:223], v4, s[8:11], s30 offen offset:1536 sc1
    s_add_u32 s30, s30, 2048
    s_cmp_ge_u32 s30, 55296
    s_cselect_b32 s30, 0, s30
    s_waitcnt vmcnt(15)
    s_waitcnt lgkmcnt(6)
    v_mfma_f32_32x32x16_bf16 v[48:63], v[32:35], v[160:163], v[48:63]
    ds_read_b64_tr_b16 v[24:25], v9 offset:51712
    ds_read_b64_tr_b16 v[26:27], v9 offset:52224
    s_waitcnt lgkmcnt(6)
    v_mfma_f32_32x32x16_bf16 v[64:79], v[36:39], v[160:163], v[64:79]
    ds_read_b64_tr_b16 v[28:29], v9 offset:51776
    ds_read_b64_tr_b16 v[30:31], v9 offset:52288
    buffer_load_dwordx4 v[224:227], v4, s[8:11], s30 offen offset:0 sc1
    s_waitcnt vmcnt(15)
    s_waitcnt lgkmcnt(6)
    v_mfma_f32_32x32x16_bf16 v[48:63], v[40:43], v[164:167], v[48:63]
    ds_read_b64_tr_b16 v[32:33], v9 offset:51968
    ds_read_b64_tr_b16 v[34:35], v9 offset:52480
    s_waitcnt lgkmcnt(6)
    v_mfma_f32_32x32x16_bf16 v[64:79], v[44:47], v[164:167], v[64:79]
    ds_read_b64_tr_b16 v[36:37], v9 offset:52032
    ds_read_b64_tr_b16 v[38:39], v9 offset:52544
    buffer_load_dwordx4 v[228:231], v4, s[8:11], s30 offen offset:512 sc1
    s_barrier
    s_waitcnt vmcnt(15)
    s_waitcnt lgkmcnt(6)
    v_mfma_f32_32x32x16_bf16 v[48:63], v[24:27], v[168:171], v[48:63]
    ds_read_b64_tr_b16 v[40:41], v13 offset:0
    ds_read_b64_tr_b16 v[42:43], v13 offset:512
    s_waitcnt lgkmcnt(6)
    v_mfma_f32_32x32x16_bf16 v[64:79], v[28:31], v[168:171], v[64:79]
    ds_read_b64_tr_b16 v[44:45], v13 offset:64
    ds_read_b64_tr_b16 v[46:47], v13 offset:576
    buffer_load_dwordx4 v[232:235], v4, s[8:11], s30 offen offset:1024 sc1
    s_waitcnt vmcnt(15)
    s_waitcnt lgkmcnt(6)
    v_mfma_f32_32x32x16_bf16 v[48:63], v[32:35], v[172:175], v[48:63]
    ds_read_b64_tr_b16 v[24:25], v13 offset:256
    ds_read_b64_tr_b16 v[26:27], v13 offset:768
    s_waitcnt lgkmcnt(6)
    v_mfma_f32_32x32x16_bf16 v[64:79], v[36:39], v[172:175], v[64:79]
    ds_read_b64_tr_b16 v[28:29], v13 offset:320
    ds_read_b64_tr_b16 v[30:31], v13 offset:832
    buffer_load_dwordx4 v[236:239], v4, s[8:11], s30 offen offset:1536 sc1
    s_add_u32 s30, s30, 2048
    s_cmp_ge_u32 s30, 55296
    s_cselect_b32 s30, 0, s30
    s_waitcnt vmcnt(15)
    s_waitcnt lgkmcnt(6)
    v_mfma_f32_32x32x16_bf16 v[48:63], v[40:43], v[176:179], v[48:63]
    ds_read_b64_tr_b16 v[32:33], v13 offset:1024
    ds_read_b64_tr_b16 v[34:35], v13 offset:1536
    s_waitcnt lgkmcnt(6)
    v_mfma_f32_32x32x16_bf16 v[64:79], v[44:47], v[176:179], v[64:79]
    ds_read_b64_tr_b16 v[36:37], v13 offset:1088
    ds_read_b64_tr_b16 v[38:39], v13 offset:1600
    buffer_load_dwordx4 v[96:99], v4, s[8:11], s30 offen offset:0 sc1
    s_waitcnt vmcnt(15)
    s_waitcnt lgkmcnt(6)
    v_mfma_f32_32x32x16_bf16 v[48:63], v[24:27], v[180:183], v[48:63]
    ds_read_b64_tr_b16 v[40:41], v13 offset:1280
    ds_read_b64_tr_b16 v[42:43], v13 offset:1792
    s_waitcnt lgkmcnt(6)
    v_mfma_f32_32x32x16_bf16 v[64:79], v[28:31], v[180:183], v[64:79]
    ds_read_b64_tr_b16 v[44:45], v13 offset:1344
    ds_read_b64_tr_b16 v[46:47], v13 offset:1856
    buffer_load_dwordx4 v[100:103], v4, s[8:11], s30 offen offset:512 sc1
    s_barrier
    s_waitcnt vmcnt(15)
    s_waitcnt lgkmcnt(6)
    v_mfma_f32_32x32x16_bf16 v[48:63], v[32:35], v[184:187], v[48:63]
    ds_read_b64_tr_b16 v[24:25], v13 offset:8448
    ds_read_b64_tr_b16 v[26:27], v13 offset:8960
    s_waitcnt lgkmcnt(6)
    v_mfma_f32_32x32x16_bf16 v[64:79], v[36:39], v[184:187], v[64:79]
    ds_read_b64_tr_b16 v[28:29], v13 offset:8512
    ds_read_b64_tr_b16 v[30:31], v13 offset:9024
    buffer_load_dwordx4 v[104:107], v4, s[8:11], s30 offen offset:1024 sc1
    s_waitcnt vmcnt(15)
    s_waitcnt lgkmcnt(6)
    v_mfma_f32_32x32x16_bf16 v[48:63], v[40:43], v[188:191], v[48:63]
    ds_read_b64_tr_b16 v[32:33], v13 offset:8704
    ds_read_b64_tr_b16 v[34:35], v13 offset:9216
    s_waitcnt lgkmcnt(6)
    v_mfma_f32_32x32x16_bf16 v[64:79], v[44:47], v[188:191], v[64:79]
    ds_read_b64_tr_b16 v[36:37], v13 offset:8768
    ds_read_b64_tr_b16 v[38:39], v13 offset:9280
    buffer_load_dwordx4 v[108:111], v4, s[8:11], s30 offen offset:1536 sc1
    s_add_u32 s30, s30, 2048
    s_cmp_ge_u32 s30, 55296
    s_cselect_b32 s30, 0, s30
    s_waitcnt vmcnt(15)
    s_waitcnt lgkmcnt(6)
    v_mfma_f32_32x32x16_bf16 v[48:63], v[24:27], v[192:195], v[48:63]
    ds_read_b64_tr_b16 v[40:41], v13 offset:9472
    ds_read_b64_tr_b16 v[42:43], v13 offset:9984
    s_waitcnt lgkmcnt(6)
    v_mfma_f32_32x32x16_bf16 v[64:79], v[28:31], v[192:195], v[64:79]
    ds_read_b64_tr_b16 v[44:45], v13 offset:9536
    ds_read_b64_tr_b16 v[46:47], v13 offset:10048
    buffer_load_dwordx4 v[112:115], v4, s[8:11], s30 offen offset:0 sc1
    s_waitcnt vmcnt(15)
    s_waitcnt lgkmcnt(6)
    v_mfma_f32_32x32x16_bf16 v[48:63], v[32:35], v[196:199], v[48:63]
    ds_read_b64_tr_b16 v[24:25], v13 offset:9728
    ds_read_b64_tr_b16 v[26:27], v13 offset:10240
    s_waitcnt lgkmcnt(6)
    v_mfma_f32_32x32x16_bf16 v[64:79], v[36:39], v[196:199], v[64:79]
    ds_read_b64_tr_b16 v[28:29], v13 offset:9792
    ds_read_b64_tr_b16 v[30:31], v13 offset:10304
    buffer_load_dwordx4 v[116:119], v4, s[8:11], s30 offen offset:512 sc1
    s_barrier
    s_waitcnt vmcnt(15)
    s_waitcnt lgkmcnt(6)
    v_mfma_f32_32x32x16_bf16 v[48:63], v[40:43], v[200:203], v[48:63]
    ds_read_b64_tr_b16 v[32:33], v13 offset:16896
    ds_read_b64_tr_b16 v[34:35], v13 offset:17408
    s_waitcnt lgkmcnt(6)
    v_mfma_f32_32x32x16_bf16 v[64:79], v[44:47], v[200:203], v[64:79]
    ds_read_b64_tr_b16 v[36:37], v13 offset:16960
    ds_read_b64_tr_b16 v[38:39], v13 offset:17472
    buffer_load_dwordx4 v[120:123], v4, s[8:11], s30 offen offset:1024 sc1
    s_waitcnt vmcnt(15)
    s_waitcnt lgkmcnt(6)
    v_mfma_f32_32x32x16_bf16 v[48:63], v[24:27], v[204:207], v[48:63]
    ds_read_b64_tr_b16 v[40:41], v13 offset:17152
    ds_read_b64_tr_b16 v[42:43], v13 offset:17664
    s_waitcnt lgkmcnt(6)
    v_mfma_f32_32x32x16_bf16 v[64:79], v[28:31], v[204:207], v[64:79]
    ds_read_b64_tr_b16 v[44:45], v13 offset:17216
    ds_read_b64_tr_b16 v[46:47], v13 offset:17728
    buffer_load_dwordx4 v[124:127], v4, s[8:11], s30 offen offset:1536 sc1
    s_add_u32 s30, s30, 2048
    s_cmp_ge_u32 s30, 55296
    s_cselect_b32 s30, 0, s30
    s_waitcnt vmcnt(15)
    s_waitcnt lgkmcnt(6)
    v_mfma_f32_32x32x16_bf16 v[48:63], v[32:35], v[208:211], v[48:63]
    ds_read_b64_tr_b16 v[24:25], v13 offset:17920
    ds_read_b64_tr_b16 v[26:27], v13 offset:18432
    s_waitcnt lgkmcnt(6)
    v_mfma_f32_32x32x16_bf16 v[64:79], v[36:39], v[208:211], v[64:79]
    ds_read_b64_tr_b16 v[28:29], v13 offset:17984
    ds_read_b64_tr_b16 v[30:31], v13 offset:18496
    buffer_load_dwordx4 v[128:131], v4, s[8:11], s30 offen offset:0 sc1
    s_waitcnt vmcnt(15)
    s_waitcnt lgkmcnt(6)
    v_mfma_f32_32x32x16_bf16 v[48:63], v[40:43], v[212:215], v[48:63]
    ds_read_b64_tr_b16 v[32:33], v13 offset:18176
    ds_read_b64_tr_b16 v[34:35], v13 offset:18688
    s_waitcnt lgkmcnt(6)
    v_mfma_f32_32x32x16_bf16 v[64:79], v[44:47], v[212:215], v[64:79]
    ds_read_b64_tr_b16 v[36:37], v13 offset:18240
    ds_read_b64_tr_b16 v[38:39], v13 offset:18752
    buffer_load_dwordx4 v[132:135], v4, s[8:11], s30 offen offset:512 sc1
    s_barrier
    s_waitcnt vmcnt(15)
    s_waitcnt lgkmcnt(6)
    v_mfma_f32_32x32x16_bf16 v[48:63], v[24:27], v[216:219], v[48:63]
    ds_read_b64_tr_b16 v[40:41], v8 offset:0
    ds_read_b64_tr_b16 v[42:43], v8 offset:512
    s_waitcnt lgkmcnt(6)
    v_mfma_f32_32x32x16_bf16 v[64:79], v[28:31], v[216:219], v[64:79]
    ds_read_b64_tr_b16 v[44:45], v8 offset:64
    ds_read_b64_tr_b16 v[46:47], v8 offset:576
    buffer_load_dwordx4 v[136:139], v4, s[8:11], s30 offen offset:1024 sc1
    s_waitcnt vmcnt(15)
    s_waitcnt lgkmcnt(6)
    v_mfma_f32_32x32x16_bf16 v[48:63], v[32:35], v[220:223], v[48:63]
    ds_read_b64_tr_b16 v[24:25], v8 offset:256
    ds_read_b64_tr_b16 v[26:27], v8 offset:768
    s_waitcnt lgkmcnt(6)
    v_mfma_f32_32x32x16_bf16 v[64:79], v[36:39], v[220:223], v[64:79]
    ds_read_b64_tr_b16 v[28:29], v8 offset:320
    ds_read_b64_tr_b16 v[30:31], v8 offset:832
    buffer_load_dwordx4 v[140:143], v4, s[8:11], s30 offen offset:1536 sc1
    s_add_u32 s30, s30, 2048
    s_cmp_ge_u32 s30, 55296
    s_cselect_b32 s30, 0, s30
    s_waitcnt vmcnt(15)
    s_waitcnt lgkmcnt(6)
    v_mfma_f32_32x32x16_bf16 v[48:63], v[40:43], v[224:227], v[48:63]
    ds_read_b64_tr_b16 v[32:33], v8 offset:1024
    ds_read_b64_tr_b16 v[34:35], v8 offset:1536
    s_waitcnt lgkmcnt(6)
    v_mfma_f32_32x32x16_bf16 v[64:79], v[44:47], v[224:227], v[64:79]
    ds_read_b64_tr_b16 v[36:37], v8 offset:1088
    ds_read_b64_tr_b16 v[38:39], v8 offset:1600
    buffer_load_dwordx4 v[144:147], v4, s[8:11], s30 offen offset:0 sc1
    s_waitcnt vmcnt(15)
    s_waitcnt lgkmcnt(6)
    v_mfma_f32_32x32x16_bf16 v[48:63], v[24:27], v[228:231], v[48:63]
    ds_read_b64_tr_b16 v[40:41], v8 offset:1280
    ds_read_b64_tr_b16 v[42:43], v8 offset:1792
    s_waitcnt lgkmcnt(6)
    v_mfma_f32_32x32x16_bf16 v[64:79], v[28:31], v[228:231], v[64:79]
    ds_read_b64_tr_b16 v[44:45], v8 offset:1344
    ds_read_b64_tr_b16 v[46:47], v8 offset:1856
    buffer_load_dwordx4 v[148:151], v4, s[8:11], s30 offen offset:512 sc1
    s_barrier
    s_waitcnt vmcnt(15)
    s_waitcnt lgkmcnt(6)
    v_mfma_f32_32x32x16_bf16 v[48:63], v[32:35], v[232:235], v[48:63]
    ds_read_b64_tr_b16 v[24:25], v8 offset:8448
    ds_read_b64_tr_b16 v[26:27], v8 offset:8960
    s_waitcnt lgkmcnt(6)
    v_mfma_f32_32x32x16_bf16 v[64:79], v[36:39], v[232:235], v[64:79]
    ds_read_b64_tr_b16 v[28:29], v8 offset:8512
    ds_read_b64_tr_b16 v[30:31], v8 offset:9024
    buffer_load_dwordx4 v[152:155], v4, s[8:11], s30 offen offset:1024 sc1
    s_waitcnt vmcnt(15)
    s_waitcnt lgkmcnt(6)
    v_mfma_f32_32x32x16_bf16 v[48:63], v[40:43], v[236:239], v[48:63]
    ds_read_b64_tr_b16 v[32:33], v8 offset:8704
    ds_read_b64_tr_b16 v[34:35], v8 offset:9216
    s_waitcnt lgkmcnt(6)
    v_mfma_f32_32x32x16_bf16 v[64:79], v[44:47], v[236:239], v[64:79]
    ds_read_b64_tr_b16 v[36:37], v8 offset:8768
    ds_read_b64_tr_b16 v[38:39], v8 offset:9280
    buffer_load_dwordx4 v[156:159], v4, s[8:11], s30 offen offset:1536 sc1
    s_add_u32 s30, s30, 2048
    s_cmp_ge_u32 s30, 55296
    s_cselect_b32 s30, 0, s30
    s_waitcnt vmcnt(15)
    s_waitcnt lgkmcnt(6)
    v_mfma_f32_32x32x16_bf16 v[48:63], v[24:27], v[96:99], v[48:63]
    ds_read_b64_tr_b16 v[40:41], v8 offset:9472
    ds_read_b64_tr_b16 v[42:43], v8 offset:9984
    s_waitcnt lgkmcnt(6)
    v_mfma_f32_32x32x16_bf16 v[64:79], v[28:31], v[96:99], v[64:79]
    ds_read_b64_tr_b16 v[44:45], v8 offset:9536
    ds_read_b64_tr_b16 v[46:47], v8 offset:10048
    buffer_load_dwordx4 v[160:163], v4, s[8:11], s30 offen offset:0 sc1
    s_waitcnt vmcnt(15)
    s_waitcnt lgkmcnt(6)
    v_mfma_f32_32x32x16_bf16 v[48:63], v[32:35], v[100:103], v[48:63]
    ds_read_b64_tr_b16 v[24:25], v8 offset:9728
    ds_read_b64_tr_b16 v[26:27], v8 offset:10240
    s_waitcnt lgkmcnt(6)
    v_mfma_f32_32x32x16_bf16 v[64:79], v[36:39], v[100:103], v[64:79]
    ds_read_b64_tr_b16 v[28:29], v8 offset:9792
    ds_read_b64_tr_b16 v[30:31], v8 offset:10304
    buffer_load_dwordx4 v[164:167], v4, s[8:11], s30 offen offset:512 sc1
    s_barrier
    s_waitcnt vmcnt(15)
    s_waitcnt lgkmcnt(6)
    v_mfma_f32_32x32x16_bf16 v[48:63], v[40:43], v[104:107], v[48:63]
    ds_read_b64_tr_b16 v[32:33], v8 offset:16896
    ds_read_b64_tr_b16 v[34:35], v8 offset:17408
    s_waitcnt lgkmcnt(6)
    v_mfma_f32_32x32x16_bf16 v[64:79], v[44:47], v[104:107], v[64:79]
    ds_read_b64_tr_b16 v[36:37], v8 offset:16960
    ds_read_b64_tr_b16 v[38:39], v8 offset:17472
    buffer_load_dwordx4 v[168:171], v4, s[8:11], s30 offen offset:1024 sc1
    s_waitcnt vmcnt(15)
    s_waitcnt lgkmcnt(6)
    v_mfma_f32_32x32x16_bf16 v[48:63], v[24:27], v[108:111], v[48:63]
    ds_read_b64_tr_b16 v[40:41], v8 offset:17152
    ds_read_b64_tr_b16 v[42:43], v8 offset:17664
    s_waitcnt lgkmcnt(6)
    v_mfma_f32_32x32x16_bf16 v[64:79], v[28:31], v[108:111], v[64:79]
    ds_read_b64_tr_b16 v[44:45], v8 offset:17216
    ds_read_b64_tr_b16 v[46:47], v8 offset:17728
    buffer_load_dwordx4 v[172:175], v4, s[8:11], s30 offen offset:1536 sc1
    s_add_u32 s30, s30, 2048
    s_cmp_ge_u32 s30, 55296
    s_cselect_b32 s30, 0, s30
    s_waitcnt vmcnt(15)
    s_waitcnt lgkmcnt(6)
    v_mfma_f32_32x32x16_bf16 v[48:63], v[32:35], v[112:115], v[48:63]
    ds_read_b64_tr_b16 v[24:25], v8 offset:17920
    ds_read_b64_tr_b16 v[26:27], v8 offset:18432
    s_waitcnt lgkmcnt(6)
    v_mfma_f32_32x32x16_bf16 v[64:79], v[36:39], v[112:115], v[64:79]
    ds_read_b64_tr_b16 v[28:29], v8 offset:17984
    ds_read_b64_tr_b16 v[30:31], v8 offset:18496
    buffer_load_dwordx4 v[176:179], v4, s[8:11], s30 offen offset:0 sc1
    s_waitcnt vmcnt(15)
    s_waitcnt lgkmcnt(6)
    v_mfma_f32_32x32x16_bf16 v[48:63], v[40:43], v[116:119], v[48:63]
    ds_read_b64_tr_b16 v[32:33], v8 offset:18176
    ds_read_b64_tr_b16 v[34:35], v8 offset:18688
    s_waitcnt lgkmcnt(6)
    v_mfma_f32_32x32x16_bf16 v[64:79], v[44:47], v[116:119], v[64:79]
    ds_read_b64_tr_b16 v[36:37], v8 offset:18240
    ds_read_b64_tr_b16 v[38:39], v8 offset:18752
    buffer_load_dwordx4 v[180:183], v4, s[8:11], s30 offen offset:512 sc1
    s_barrier
    s_waitcnt vmcnt(15)
    s_waitcnt lgkmcnt(6)
    v_mfma_f32_32x32x16_bf16 v[48:63], v[24:27], v[120:123], v[48:63]
    ds_read_b64_tr_b16 v[40:41], v8 offset:25344
    ds_read_b64_tr_b16 v[42:43], v8 offset:25856
    s_waitcnt lgkmcnt(6)
    v_mfma_f32_32x32x16_bf16 v[64:79], v[28:31], v[120:123], v[64:79]
    ds_read_b64_tr_b16 v[44:45], v8 offset:25408
    ds_read_b64_tr_b16 v[46:47], v8 offset:25920
    buffer_load_dwordx4 v[184:187], v4, s[8:11], s30 offen offset:1024 sc1
    s_waitcnt vmcnt(15)
    s_waitcnt lgkmcnt(6)
    v_mfma_f32_32x32x16_bf16 v[48:63], v[32:35], v[124:127], v[48:63]
    ds_read_b64_tr_b16 v[24:25], v8 offset:25600
    ds_read_b64_tr_b16 v[26:27], v8 offset:26112
    s_waitcnt lgkmcnt(6)
    v_mfma_f32_32x32x16_bf16 v[64:79], v[36:39], v[124:127], v[64:79]
    ds_read_b64_tr_b16 v[28:29], v8 offset:25664
    ds_read_b64_tr_b16 v[30:31], v8 offset:26176
    buffer_load_dwordx4 v[188:191], v4, s[8:11], s30 offen offset:1536 sc1
    s_add_u32 s30, s30, 2048
    s_cmp_ge_u32 s30, 55296
    s_cselect_b32 s30, 0, s30
    s_waitcnt vmcnt(15)
    s_waitcnt lgkmcnt(6)
    v_mfma_f32_32x32x16_bf16 v[48:63], v[40:43], v[128:131], v[48:63]
    ds_read_b64_tr_b16 v[32:33], v8 offset:26368
    ds_read_b64_tr_b16 v[34:35], v8 offset:26880
    s_waitcnt lgkmcnt(6)
    v_mfma_f32_32x32x16_bf16 v[64:79], v[44:47], v[128:131], v[64:79]
    ds_read_b64_tr_b16 v[36:37], v8 offset:26432
    ds_read_b64_tr_b16 v[38:39], v8 offset:26944
    buffer_load_dwordx4 v[192:195], v4, s[8:11], s30 offen offset:0 sc1
    s_waitcnt vmcnt(15)
    s_waitcnt lgkmcnt(6)
    v_mfma_f32_32x32x16_bf16 v[48:63], v[24:27], v[132:135], v[48:63]
    ds_read_b64_tr_b16 v[40:41], v8 offset:26624
    ds_read_b64_tr_b16 v[42:43], v8 offset:27136
    s_waitcnt lgkmcnt(6)
    v_mfma_f32_32x32x16_bf16 v[64:79], v[28:31], v[132:135], v[64:79]
    ds_read_b64_tr_b16 v[44:45], v8 offset:26688
    ds_read_b64_tr_b16 v[46:47], v8 offset:27200
    buffer_load_dwordx4 v[196:199], v4, s[8:11], s30 offen offset:512 sc1
    s_barrier
    s_waitcnt vmcnt(15)
    s_waitcnt lgkmcnt(6)
    v_mfma_f32_32x32x16_bf16 v[48:63], v[32:35], v[136:139], v[48:63]
    ds_read_b64_tr_b16 v[24:25], v8 offset:33792
    ds_read_b64_tr_b16 v[26:27], v8 offset:34304
    s_waitcnt lgkmcnt(6)
    v_mfma_f32_32x32x16_bf16 v[64:79], v[36:39], v[136:139], v[64:79]
    ds_read_b64_tr_b16 v[28:29], v8 offset:33856
    ds_read_b64_tr_b16 v[30:31], v8 offset:34368
    buffer_load_dwordx4 v[200:203], v4, s[8:11], s30 offen offset:1024 sc1
    s_waitcnt vmcnt(15)
    s_waitcnt lgkmcnt(6)
    v_mfma_f32_32x32x16_bf16 v[48:63], v[40:43], v[140:143], v[48:63]
    ds_read_b64_tr_b16 v[32:33], v8 offset:34048
    ds_read_b64_tr_b16 v[34:35], v8 offset:34560
    s_waitcnt lgkmcnt(6)
    v_mfma_f32_32x32x16_bf16 v[64:79], v[44:47], v[140:143], v[64:79]
    ds_read_b64_tr_b16 v[36:37], v8 offset:34112
    ds_read_b64_tr_b16 v[38:39], v8 offset:34624
    buffer_load_dwordx4 v[204:207], v4, s[8:11], s30 offen offset:1536 sc1
    s_add_u32 s30, s30, 2048
    s_cmp_ge_u32 s30, 55296
    s_cselect_b32 s30, 0, s30
    s_waitcnt vmcnt(15)
    s_waitcnt lgkmcnt(6)
    v_mfma_f32_32x32x16_bf16 v[48:63], v[24:27], v[144:147], v[48:63]
    ds_read_b64_tr_b16 v[40:41], v8 offset:34816
    ds_read_b64_tr_b16 v[42:43], v8 offset:35328
    s_waitcnt lgkmcnt(6)
    v_mfma_f32_32x32x16_bf16 v[64:79], v[28:31], v[144:147], v[64:79]
    ds_read_b64_tr_b16 v[44:45], v8 offset:34880
    ds_read_b64_tr_b16 v[46:47], v8 offset:35392
    buffer_load_dwordx4 v[208:211], v4, s[8:11], s30 offen offset:0 sc1
    s_waitcnt vmcnt(15)
    s_waitcnt lgkmcnt(6)
    v_mfma_f32_32x32x16_bf16 v[48:63], v[32:35], v[148:151], v[48:63]
    ds_read_b64_tr_b16 v[24:25], v8 offset:35072
    ds_read_b64_tr_b16 v[26:27], v8 offset:35584
    s_waitcnt lgkmcnt(6)
    v_mfma_f32_32x32x16_bf16 v[64:79], v[36:39], v[148:151], v[64:79]
    ds_read_b64_tr_b16 v[28:29], v8 offset:35136
    ds_read_b64_tr_b16 v[30:31], v8 offset:35648
    buffer_load_dwordx4 v[212:215], v4, s[8:11], s30 offen offset:512 sc1
    s_barrier
    s_waitcnt vmcnt(15)
    s_waitcnt lgkmcnt(6)
    v_mfma_f32_32x32x16_bf16 v[48:63], v[40:43], v[152:155], v[48:63]
    ds_read_b64_tr_b16 v[32:33], v8 offset:42240
    ds_read_b64_tr_b16 v[34:35], v8 offset:42752
    s_waitcnt lgkmcnt(6)
    v_mfma_f32_32x32x16_bf16 v[64:79], v[44:47], v[152:155], v[64:79]
    ds_read_b64_tr_b16 v[36:37], v8 offset:42304
    ds_read_b64_tr_b16 v[38:39], v8 offset:42816
    buffer_load_dwordx4 v[216:219], v4, s[8:11], s30 offen offset:1024 sc1
    s_waitcnt vmcnt(15)
    s_waitcnt lgkmcnt(6)
    v_mfma_f32_32x32x16_bf16 v[48:63], v[24:27], v[156:159], v[48:63]
    ds_read_b64_tr_b16 v[40:41], v8 offset:42496
    ds_read_b64_tr_b16 v[42:43], v8 offset:43008
    s_waitcnt lgkmcnt(6)
    v_mfma_f32_32x32x16_bf16 v[64:79], v[28:31], v[156:159], v[64:79]
    ds_read_b64_tr_b16 v[44:45], v8 offset:42560
    ds_read_b64_tr_b16 v[46:47], v8 offset:43072
    buffer_load_dwordx4 v[220:223], v4, s[8:11], s30 offen offset:1536 sc1
    s_add_u32 s30, s30, 2048
    s_cmp_ge_u32 s30, 55296
    s_cselect_b32 s30, 0, s30
    s_waitcnt vmcnt(15)
    s_waitcnt lgkmcnt(6)
    v_mfma_f32_32x32x16_bf16 v[48:63], v[32:35], v[160:163], v[48:63]
    ds_read_b64_tr_b16 v[24:25], v8 offset:43264
    ds_read_b64_tr_b16 v[26:27], v8 offset:43776
    s_waitcnt lgkmcnt(6)
    v_mfma_f32_32x32x16_bf16 v[64:79], v[36:39], v[160:163], v[64:79]
    ds_read_b64_tr_b16 v[28:29], v8 offset:43328
    ds_read_b64_tr_b16 v[30:31], v8 offset:43840
    buffer_load_dwordx4 v[224:227], v4, s[8:11], s30 offen offset:0 sc1
    s_waitcnt vmcnt(15)
    s_waitcnt lgkmcnt(6)
    v_mfma_f32_32x32x16_bf16 v[48:63], v[40:43], v[164:167], v[48:63]
    ds_read_b64_tr_b16 v[32:33], v8 offset:43520
    ds_read_b64_tr_b16 v[34:35], v8 offset:44032
    s_waitcnt lgkmcnt(6)
    v_mfma_f32_32x32x16_bf16 v[64:79], v[44:47], v[164:167], v[64:79]
    ds_read_b64_tr_b16 v[36:37], v8 offset:43584
    ds_read_b64_tr_b16 v[38:39], v8 offset:44096
    buffer_load_dwordx4 v[228:231], v4, s[8:11], s30 offen offset:512 sc1
    s_barrier
    s_waitcnt vmcnt(15)
    s_waitcnt lgkmcnt(6)
    v_mfma_f32_32x32x16_bf16 v[48:63], v[24:27], v[168:171], v[48:63]
    ds_read_b64_tr_b16 v[40:41], v8 offset:50688
    ds_read_b64_tr_b16 v[42:43], v8 offset:51200
    s_waitcnt lgkmcnt(6)
    v_mfma_f32_32x32x16_bf16 v[64:79], v[28:31], v[168:171], v[64:79]
    ds_read_b64_tr_b16 v[44:45], v8 offset:50752
    ds_read_b64_tr_b16 v[46:47], v8 offset:51264
    buffer_load_dwordx4 v[232:235], v4, s[8:11], s30 offen offset:1024 sc1
    s_waitcnt vmcnt(15)
    s_waitcnt lgkmcnt(6)
    v_mfma_f32_32x32x16_bf16 v[48:63], v[32:35], v[172:175], v[48:63]
    ds_read_b64_tr_b16 v[24:25], v8 offset:50944
    ds_read_b64_tr_b16 v[26:27], v8 offset:51456
    s_waitcnt lgkmcnt(6)
    v_mfma_f32_32x32x16_bf16 v[64:79], v[36:39], v[172:175], v[64:79]
    ds_read_b64_tr_b16 v[28:29], v8 offset:51008
    ds_read_b64_tr_b16 v[30:31], v8 offset:51520
    buffer_load_dwordx4 v[236:239], v4, s[8:11], s30 offen offset:1536 sc1
    s_waitcnt vmcnt(15)
    s_waitcnt lgkmcnt(6)
    v_mfma_f32_32x32x16_bf16 v[48:63], v[40:43], v[176:179], v[48:63]
    ds_read_b64_tr_b16 v[32:33], v8 offset:51712
    ds_read_b64_tr_b16 v[34:35], v8 offset:52224
    s_waitcnt lgkmcnt(6)
    v_mfma_f32_32x32x16_bf16 v[64:79], v[44:47], v[176:179], v[64:79]
    ds_read_b64_tr_b16 v[36:37], v8 offset:51776
    ds_read_b64_tr_b16 v[38:39], v8 offset:52288
    s_waitcnt vmcnt(14)
    s_waitcnt lgkmcnt(6)
    v_mfma_f32_32x32x16_bf16 v[48:63], v[24:27], v[180:183], v[48:63]
    ds_read_b64_tr_b16 v[40:41], v8 offset:51968
    ds_read_b64_tr_b16 v[42:43], v8 offset:52480
    s_waitcnt lgkmcnt(6)
    v_mfma_f32_32x32x16_bf16 v[64:79], v[28:31], v[180:183], v[64:79]
    ds_read_b64_tr_b16 v[44:45], v8 offset:52032
    ds_read_b64_tr_b16 v[46:47], v8 offset:52544
    s_barrier
    s_waitcnt vmcnt(13)
    s_waitcnt lgkmcnt(6)
    v_mfma_f32_32x32x16_bf16 v[48:63], v[32:35], v[184:187], v[48:63]
    ds_read_b64_tr_b16 v[24:25], v9 offset:0
    ds_read_b64_tr_b16 v[26:27], v9 offset:512
    s_waitcnt lgkmcnt(6)
    v_mfma_f32_32x32x16_bf16 v[64:79], v[36:39], v[184:187], v[64:79]
    ds_read_b64_tr_b16 v[28:29], v9 offset:64
    ds_read_b64_tr_b16 v[30:31], v9 offset:576
    s_waitcnt vmcnt(12)
    s_waitcnt lgkmcnt(6)
    v_mfma_f32_32x32x16_bf16 v[48:63], v[40:43], v[188:191], v[48:63]
    ds_read_b64_tr_b16 v[32:33], v9 offset:256
    ds_read_b64_tr_b16 v[34:35], v9 offset:768
    s_waitcnt lgkmcnt(6)
    v_mfma_f32_32x32x16_bf16 v[64:79], v[44:47], v[188:191], v[64:79]
    ds_read_b64_tr_b16 v[36:37], v9 offset:320
    ds_read_b64_tr_b16 v[38:39], v9 offset:832
    s_waitcnt vmcnt(11)
    s_waitcnt lgkmcnt(6)
    v_mfma_f32_32x32x16_bf16 v[48:63], v[24:27], v[192:195], v[48:63]
    ds_read_b64_tr_b16 v[40:41], v9 offset:1024
    ds_read_b64_tr_b16 v[42:43], v9 offset:1536
    s_waitcnt lgkmcnt(6)
    v_mfma_f32_32x32x16_bf16 v[64:79], v[28:31], v[192:195], v[64:79]
    ds_read_b64_tr_b16 v[44:45], v9 offset:1088
    ds_read_b64_tr_b16 v[46:47], v9 offset:1600
    s_waitcnt vmcnt(10)
    s_waitcnt lgkmcnt(6)
    v_mfma_f32_32x32x16_bf16 v[48:63], v[32:35], v[196:199], v[48:63]
    ds_read_b64_tr_b16 v[24:25], v9 offset:1280
    ds_read_b64_tr_b16 v[26:27], v9 offset:1792
    s_waitcnt lgkmcnt(6)
    v_mfma_f32_32x32x16_bf16 v[64:79], v[36:39], v[196:199], v[64:79]
    ds_read_b64_tr_b16 v[28:29], v9 offset:1344
    ds_read_b64_tr_b16 v[30:31], v9 offset:1856
    s_barrier
    s_waitcnt vmcnt(9)
    s_waitcnt lgkmcnt(6)
    v_mfma_f32_32x32x16_bf16 v[48:63], v[40:43], v[200:203], v[48:63]
    ds_read_b64_tr_b16 v[32:33], v9 offset:8448
    ds_read_b64_tr_b16 v[34:35], v9 offset:8960
    s_waitcnt lgkmcnt(6)
    v_mfma_f32_32x32x16_bf16 v[64:79], v[44:47], v[200:203], v[64:79]
    ds_read_b64_tr_b16 v[36:37], v9 offset:8512
    ds_read_b64_tr_b16 v[38:39], v9 offset:9024
    s_waitcnt vmcnt(8)
    s_waitcnt lgkmcnt(6)
    v_mfma_f32_32x32x16_bf16 v[48:63], v[24:27], v[204:207], v[48:63]
    ds_read_b64_tr_b16 v[40:41], v9 offset:8704
    ds_read_b64_tr_b16 v[42:43], v9 offset:9216
    s_waitcnt lgkmcnt(6)
    v_mfma_f32_32x32x16_bf16 v[64:79], v[28:31], v[204:207], v[64:79]
    ds_read_b64_tr_b16 v[44:45], v9 offset:8768
    ds_read_b64_tr_b16 v[46:47], v9 offset:9280
    s_waitcnt vmcnt(7)
    s_waitcnt lgkmcnt(6)
    v_mfma_f32_32x32x16_bf16 v[48:63], v[32:35], v[208:211], v[48:63]
    ds_read_b64_tr_b16 v[24:25], v9 offset:9472
    ds_read_b64_tr_b16 v[26:27], v9 offset:9984
    s_waitcnt lgkmcnt(6)
    v_mfma_f32_32x32x16_bf16 v[64:79], v[36:39], v[208:211], v[64:79]
    ds_read_b64_tr_b16 v[28:29], v9 offset:9536
    ds_read_b64_tr_b16 v[30:31], v9 offset:10048
    s_waitcnt vmcnt(6)
    s_waitcnt lgkmcnt(6)
    v_mfma_f32_32x32x16_bf16 v[48:63], v[40:43], v[212:215], v[48:63]
    ds_read_b64_tr_b16 v[32:33], v9 offset:9728
    ds_read_b64_tr_b16 v[34:35], v9 offset:10240
    s_waitcnt lgkmcnt(6)
    v_mfma_f32_32x32x16_bf16 v[64:79], v[44:47], v[212:215], v[64:79]
    ds_read_b64_tr_b16 v[36:37], v9 offset:9792
    ds_read_b64_tr_b16 v[38:39], v9 offset:10304
    s_barrier
    s_waitcnt vmcnt(5)
    s_waitcnt lgkmcnt(6)
    v_mfma_f32_32x32x16_bf16 v[48:63], v[24:27], v[216:219], v[48:63]
    ds_read_b64_tr_b16 v[40:41], v9 offset:16896
    ds_read_b64_tr_b16 v[42:43], v9 offset:17408
    s_waitcnt lgkmcnt(6)
    v_mfma_f32_32x32x16_bf16 v[64:79], v[28:31], v[216:219], v[64:79]
    ds_read_b64_tr_b16 v[44:45], v9 offset:16960
    ds_read_b64_tr_b16 v[46:47], v9 offset:17472
    s_waitcnt vmcnt(4)
    s_waitcnt lgkmcnt(6)
    v_mfma_f32_32x32x16_bf16 v[48:63], v[32:35], v[220:223], v[48:63]
    ds_read_b64_tr_b16 v[24:25], v9 offset:17152
    ds_read_b64_tr_b16 v[26:27], v9 offset:17664
    s_waitcnt lgkmcnt(6)
    v_mfma_f32_32x32x16_bf16 v[64:79], v[36:39], v[220:223], v[64:79]
    ds_read_b64_tr_b16 v[28:29], v9 offset:17216
    ds_read_b64_tr_b16 v[30:31], v9 offset:17728
    s_waitcnt vmcnt(3)
    s_waitcnt lgkmcnt(6)
    v_mfma_f32_32x32x16_bf16 v[48:63], v[40:43], v[224:227], v[48:63]
    ds_read_b64_tr_b16 v[32:33], v9 offset:17920
    ds_read_b64_tr_b16 v[34:35], v9 offset:18432
    s_waitcnt lgkmcnt(6)
    v_mfma_f32_32x32x16_bf16 v[64:79], v[44:47], v[224:227], v[64:79]
    ds_read_b64_tr_b16 v[36:37], v9 offset:17984
    ds_read_b64_tr_b16 v[38:39], v9 offset:18496
    s_waitcnt vmcnt(2)
    s_waitcnt lgkmcnt(6)
    v_mfma_f32_32x32x16_bf16 v[48:63], v[24:27], v[228:231], v[48:63]
    ds_read_b64_tr_b16 v[40:41], v9 offset:18176
    ds_read_b64_tr_b16 v[42:43], v9 offset:18688
    s_waitcnt lgkmcnt(6)
    v_mfma_f32_32x32x16_bf16 v[64:79], v[28:31], v[228:231], v[64:79]
    ds_read_b64_tr_b16 v[44:45], v9 offset:18240
    ds_read_b64_tr_b16 v[46:47], v9 offset:18752
    s_waitcnt vmcnt(1)
    s_waitcnt lgkmcnt(6)
    v_mfma_f32_32x32x16_bf16 v[48:63], v[32:35], v[232:235], v[48:63]
    s_waitcnt lgkmcnt(4)
    v_mfma_f32_32x32x16_bf16 v[64:79], v[36:39], v[232:235], v[64:79]
    s_waitcnt vmcnt(0)
    s_waitcnt lgkmcnt(2)
    v_mfma_f32_32x32x16_bf16 v[48:63], v[40:43], v[236:239], v[48:63]
    s_waitcnt lgkmcnt(0)
    v_mfma_f32_32x32x16_bf16 v[64:79], v[44:47], v[236:239], v[64:79]
    s_barrier
    s_nop 8
    v_cvt_pk_bf16_f32 v80, v48, v49
    v_cvt_pk_bf16_f32 v81, v50, v51
    v_cvt_pk_bf16_f32 v82, v56, v57
    v_cvt_pk_bf16_f32 v83, v58, v59
    v_cvt_pk_bf16_f32 v84, v52, v53
    v_cvt_pk_bf16_f32 v85, v54, v55
    v_cvt_pk_bf16_f32 v86, v60, v61
    v_cvt_pk_bf16_f32 v87, v62, v63
    v_cvt_pk_bf16_f32 v88, v64, v65
    v_cvt_pk_bf16_f32 v89, v66, v67
    v_cvt_pk_bf16_f32 v90, v72, v73
    v_cvt_pk_bf16_f32 v91, v74, v75
    v_cvt_pk_bf16_f32 v92, v68, v69
    v_cvt_pk_bf16_f32 v93, v70, v71
    v_cvt_pk_bf16_f32 v94, v76, v77
    v_cvt_pk_bf16_f32 v95, v78, v79
    s_cmp_eq_u32 s16, 0
    s_cbranch_scc1 L_p5_notfinal
    s_add_u32 s76, s98, 0x0
    s_addc_u32 s77, s99, 0
    s_mov_b32 s78, 0x280000
    s_mov_b32 s79, 0x20000
    v_permlane32_swap_b32 v80, v82
    v_permlane32_swap_b32 v81, v83
    buffer_store_dwordx4 v[80:83], v12, s[76:79], 0 offen offset:0
    v_permlane32_swap_b32 v84, v86
    v_permlane32_swap_b32 v85, v87
    buffer_store_dwordx4 v[84:87], v12, s[76:79], 0 offen offset:16
    v_permlane32_swap_b32 v88, v90
    v_permlane32_swap_b32 v89, v91
    buffer_store_dwordx4 v[88:91], v12, s[76:79], 0 offen offset:64
    v_permlane32_swap_b32 v92, v94
    v_permlane32_swap_b32 v93, v95
    buffer_store_dwordx4 v[92:95], v12, s[76:79], 0 offen offset:80
    s_branch L_exit
L_p5_notfinal:
    buffer_store_dwordx4 v[80:83], v10, s[76:79], 0 offen offset:0 sc1
    buffer_store_dwordx4 v[84:87], v10, s[76:79], 0 offen offset:512 sc1
    buffer_store_dwordx4 v[88:91], v10, s[76:79], 0 offen offset:1024 sc1
    buffer_store_dwordx4 v[92:95], v10, s[76:79], 0 offen offset:1536 sc1
    v_mov_b32 v16, 0
    v_mov_b32 v17, 0
    v_mov_b32 v18, 0
    v_mov_b32 v19, 0
    v_mov_b32 v20, 0x3f803f80
    v_dot2_f32_bf16 v16, v80, v20, v16
    v_dot2_f32_bf16 v17, v80, v80, v17
    v_dot2_f32_bf16 v18, v81, v20, v18
    v_dot2_f32_bf16 v19, v81, v81, v19
    v_dot2_f32_bf16 v16, v82, v20, v16
    v_dot2_f32_bf16 v17, v82, v82, v17
    v_dot2_f32_bf16 v18, v83, v20, v18
    v_dot2_f32_bf16 v19, v83, v83, v19
    v_dot2_f32_bf16 v16, v84, v20, v16
    v_dot2_f32_bf16 v17, v84, v84, v17
    v_dot2_f32_bf16 v18, v85, v20, v18
    v_dot2_f32_bf16 v19, v85, v85, v19
    v_dot2_f32_bf16 v16, v86, v20, v16
    v_dot2_f32_bf16 v17, v86, v86, v17
    v_dot2_f32_bf16 v18, v87, v20, v18
    v_dot2_f32_bf16 v19, v87, v87, v19
    v_dot2_f32_bf16 v16, v88, v20, v16
    v_dot2_f32_bf16 v17, v88, v88, v17
    v_dot2_f32_bf16 v18, v89, v20, v18
    v_dot2_f32_bf16 v19, v89, v89, v19
    v_dot2_f32_bf16 v16, v90, v20, v16
    v_dot2_f32_bf16 v17, v90, v90, v17
    v_dot2_f32_bf16 v18, v91, v20, v18
    v_dot2_f32_bf16 v19, v91, v91, v19
    v_dot2_f32_bf16 v16, v92, v20, v16
    v_dot2_f32_bf16 v17, v92, v92, v17
    v_dot2_f32_bf16 v18, v93, v20, v18
    v_dot2_f32_bf16 v19, v93, v93, v19
    v_dot2_f32_bf16 v16, v94, v20, v16
    v_dot2_f32_bf16 v17, v94, v94, v17
    v_dot2_f32_bf16 v18, v95, v20, v18
    v_dot2_f32_bf16 v19, v95, v95, v19
    s_nop 3
    v_pk_add_f32 v[16:17], v[16:17], v[18:19]
    v_mov_b32 v18, v16
    v_mov_b32 v19, v17
    s_nop 0
    v_permlane32_swap_b32 v16, v18
    v_permlane32_swap_b32 v17, v19
    v_pk_add_f32 v[16:17], v[16:17], v[18:19]
    buffer_store_dwordx2 v[16:17], v11, s[80:83], 0 offen sc1
    s_lshl_b32 s21, s16, 3
    s_add_u32 s21, s21, 3
    s_lshl_b32 s21, s21, 3
    s_add_u32 s21, s21, s18
    s_lshl_b32 s21, s21, 3
    s_add_u32 s21, s21, s29
    s_lshl_b32 s21, s21, 5
    s_add_u32 s21, s21, s28
    v_mov_b32 v20, s21
    v_mov_b32 v21, 1
    s_waitcnt vmcnt(0)
    s_mov_b64 exec, 1
    s_cmp_eq_u32 s17, 0
    s_cbranch_scc1 L_sigslow_62
    buffer_store_byte v21, v20, s[72:75], 0 offen
    s_branch L_sigdone_63
L_sigslow_62:
    buffer_store_byte v21, v20, s[72:75], 0 offen sc1
L_sigdone_63:
    s_mov_b64 exec, -1
L_p5_done:
    s_cmp_lg_u32 s16, 0
    s_cbranch_scc1 L_exit
    s_mov_b32 s16, 1
    s_add_u32 s6, s6, 0x2000000
    s_addc_u32 s7, s7, 0
    s_branch L_layer
L_exit:
L_end:
    s_endpgm
L_p1a_idle:
    s_cmp_lt_u32 s20, 4
    s_cbranch_scc1 L_ir_1
    s_add_u32 s36, s84, 0x0
    s_addc_u32 s37, s85, 0
    s_mov_b32 s38, 0x280000
    s_mov_b32 s39, 0x20000
    s_lshl_b32 s21, s18, 8
    s_lshl_b32 s22, s19, 3
    s_add_u32 s21, s21, s22
    s_and_b32 s22, s20, 3
    s_lshl_b32 s22, s22, 1
    s_add_u32 s21, s21, s22
    v_add_u32 v44, s21, v3
    v_mul_u32_u24 v45, 1280, v44
    v_lshl_add_u32 v45, v2, 4, v45
    buffer_load_dwordx4 v[32:35], v45, s[36:39], 0 offen
    buffer_load_dwordx4 v[36:39], v45, s[36:39], 0 offen offset:512
    v_lshrrev_b32 v40, 4, v2
    v_lshl_add_u32 v45, v40, 31, v45
    buffer_load_dwordx4 v[40:43], v45, s[36:39], 0 offen offset:1024
    v_mov_b32 v4, 0
    v_mov_b32 v5, 0
    s_lshl_b32 s21, s18, 8
    s_lshl_b32 s22, s19, 3
    s_add_u32 s21, s21, s22
    v_lshlrev_b32 v6, 11, v1
    v_add_u32 v6, s21, v6
    s_lshl_b32 s21, s18, 5
    s_add_u32 s21, s21, s19
    s_lshl_b32 s21, s21, 7
    s_add_u32 s21, s21, 0xfff90000
    v_lshlrev_b32 v7, 15, v1
    v_add_u32 v7, s21, v7
    v_cmp_gt_u32 vcc, 16, v1
    s_nop 1
    v_cndmask_b32 v6, v7, v6, vcc
    s_lshl_b32 s21, s16, 3
    s_add_u32 s21, s21, s20
    s_cmp_eq_u32 s21, 4
    s_cselect_b32 s22, 0x3ffff, 0
    s_mov_b32 s23, 0
    v_mov_b32 v7, 0x80000000
    v_cndmask_b32 v6, v7, v6, s[22:23]
    buffer_store_dwordx2 v[4:5], v6, s[72:75], 0 offen sc1
    s_waitcnt vmcnt(1)
    v_mov_b32 v16, 0
    v_mov_b32 v17, 0
    v_mov_b32 v18, 0x3f803f80
    v_dot2_f32_bf16 v16, v32, v18, v16
    v_dot2_f32_bf16 v17, v32, v32, v17
    v_dot2_f32_bf16 v16, v33, v18, v16
    v_dot2_f32_bf16 v17, v33, v33, v17
    v_dot2_f32_bf16 v16, v34, v18, v16
    v_dot2_f32_bf16 v17, v34, v34, v17
    v_dot2_f32_bf16 v16, v35, v18, v16
    v_dot2_f32_bf16 v17, v35, v35, v17
    v_dot2_f32_bf16 v16, v36, v18, v16
    v_dot2_f32_bf16 v17, v36, v36, v17
    v_dot2_f32_bf16 v16, v37, v18, v16
    v_dot2_f32_bf16 v17, v37, v37, v17
    v_dot2_f32_bf16 v16, v38, v18, v16
    v_dot2_f32_bf16 v17, v38, v38, v17
    v_dot2_f32_bf16 v16, v39, v18, v16
    v_dot2_f32_bf16 v17, v39, v39, v17
    v_dot2_f32_bf16 v16, v40, v18, v16
    v_dot2_f32_bf16 v17, v40, v40, v17
    v_dot2_f32_bf16 v16, v41, v18, v16
    v_dot2_f32_bf16 v17, v41, v41, v17
    v_dot2_f32_bf16 v16, v42, v18, v16
    v_dot2_f32_bf16 v17, v42, v42, v17
    v_dot2_f32_bf16 v16, v43, v18, v16
    v_dot2_f32_bf16 v17, v43, v43, v17
    s_nop 3
    v_add_f32_dpp v16, v16, v16 row_ror:1 row_mask:0xf bank_mask:0xf
    v_add_f32_dpp v17, v17, v17 row_ror:1 row_mask:0xf bank_mask:0xf
    s_nop 0
    v_add_f32_dpp v16, v16, v16 row_ror:2 row_mask:0xf bank_mask:0xf
    v_add_f32_dpp v17, v17, v17 row_ror:2 row_mask:0xf bank_mask:0xf
    s_nop 0
    v_add_f32_dpp v16, v16, v16 row_ror:4 row_mask:0xf bank_mask:0xf
    v_add_f32_dpp v17, v17, v17 row_ror:4 row_mask:0xf bank_mask:0xf
    s_nop 0
    v_add_f32_dpp v16, v16, v16 row_ror:8 row_mask:0xf bank_mask:0xf
    v_add_f32_dpp v17, v17, v17 row_ror:8 row_mask:0xf bank_mask:0xf
    v_mov_b32 v18, v16
    v_mov_b32 v19, v17
    s_nop 0
    v_permlane16_swap_b32 v16, v18
    v_permlane16_swap_b32 v17, v19
    v_add_f32 v16, v16, v18
    v_add_f32 v17, v17, v19
    v_mul_f32 v20, 0xbacccccd, v16
    v_mul_f32 v17, 0x3acccccd, v17
    v_fma_f32 v17, -v20, v20, v17
    v_max_f32 v17, 0, v17
    v_cvt_pk_bf16_f32 v20, v20, v20
    v_and_b32 v20, 0xffff0000, v20
    v_cvt_pk_bf16_f32 v17, v17, v17
    v_and_b32 v17, 0xffff0000, v17
    v_add_f32 v17, 0x3727c5ac, v17
    v_cvt_pk_bf16_f32 v17, v17, v17
    v_and_b32 v17, 0xffff0000, v17
    v_sqrt_f32 v17, v17
    s_nop 0
    v_cvt_pk_bf16_f32 v17, v17, v17
    v_and_b32 v17, 0xffff0000, v17
    v_rcp_f32 v21, v17
    v_mul_f32 v17, v17, v17
    s_add_u32 s36, s6, 0x1800000
    s_addc_u32 s37, s7, 0
    s_mov_b32 s38, 0x28000
    s_mov_b32 s39, 0x20000
    v_lshlrev_b32 v16, 3, v44
    s_mov_b32 exec_lo, 1
    s_mov_b32 exec_hi, 1
    buffer_store_dwordx2 v[20:21], v16, s[36:39], 0 offen sc1
    s_mov_b64 exec, -1
    s_waitcnt vmcnt(0)
L_ir_1:
    s_barrier
    s_add_u32 s76, s4, 0x0
    s_addc_u32 s77, s5, 0
    s_mov_b32 s78, 0x100
    s_mov_b32 s79, 0x20000
    s_getreg_b32 s21, hwreg(HW_REG_XCC_ID)
    s_and_b32 s21, s21, 7
    s_lshl_b32 s21, s21, 3
    s_mov_b64 s[22:23], 1
    s_lshl_b64 s[22:23], s[22:23], s21
    v_mov_b32 v4, s22
    v_mov_b32 v5, s23
    s_lshl_b32 s21, s16, 3
    s_add_u32 s21, s21, s20
    s_lshl_b32 s22, s18, 5
    s_cmp_eq_u32 s21, 4
    s_cselect_b32 s21, s22, 0x80000000
    v_mov_b32 v6, s21
    s_mov_b64 exec, 1
    buffer_atomic_add_x2 v[4:5], v6, s[76:79], 0 offen sc1
    s_mov_b64 exec, -1
    s_cmp_lt_u32 s19, 31
    s_cbranch_scc1 L_wc_2
    s_getpc_b64 s[22:23]
L_pc_3:
    s_sub_u32 s22, s22, L_pc_3-interleave_layers__sliding_block__glu_gated_geglu__prompt_kernel
    s_subb_u32 s23, s23, 0
    v_lshlrev_b32 v6, 4, v0
L_wcl_4:
    v_min_u32 v7, L_code_end-interleave_layers__sliding_block__glu_gated_geglu__prompt_kernel-16, v6
    v_mov_b32 v5, s23
    v_add_co_u32 v4, vcc, s22, v7
    s_nop 1
    v_addc_co_u32 v5, vcc, 0, v5, vcc
    global_load_dwordx4 v[8:11], v[4:5], off
    v_add_u32 v6, 8192, v6
    s_nop 0
    v_readfirstlane_b32 s21, v6
    s_cmp_lt_u32 s21, L_code_end-interleave_layers__sliding_block__glu_gated_geglu__prompt_kernel
    s_cbranch_scc1 L_wcl_4
    s_waitcnt vmcnt(0)
    s_nop 1
L_wc_2:
    s_cmp_lg_u32 s20, 4
    s_cbranch_scc1 L_cw_5
    s_add_u32 s76, s4, 0x0
    s_addc_u32 s77, s5, 0
    s_mov_b32 s78, 0x100
    s_mov_b32 s79, 0x20000
    s_sub_u32 s21, s18, 1
    s_max_i32 s21, s21, 0
    v_mov_b32 v4, s18
    v_mov_b32 v5, s21
    v_cmp_eq_u32 vcc, 0, v1
    s_nop 1
    v_cndmask_b32 v4, v5, v4, vcc
    v_lshlrev_b32 v4, 5, v4
    s_mov_b32 s35, 0
    s_nop 0
L_cen_6:
    buffer_load_dwordx2 v[6:7], v4, s[76:79], 0 offen sc1
    s_waitcnt vmcnt(0)
    v_sad_u8 v5, v6, 0, 0
    v_sad_u8 v5, v7, 0, v5
    v_cmp_ne_u32 vcc, 32, v5
    s_add_u32 s35, s35, 1
    s_cmp_gt_u32 s35, 65536
    s_cbranch_scc1 L_cenx_7
    s_cbranch_vccz L_cenx_7
    s_sleep 64
    s_branch L_cen_6
L_cenx_7:
    v_readfirstlane_b32 s22, v6
    v_readfirstlane_b32 s23, v7
    s_bcnt1_i32_b64 s21, s[22:23]
    s_cmp_eq_u32 s21, 1
    s_cselect_b32 s17, 1, 0
    v_mov_b32 v4, 162816
    v_mov_b32 v6, s17
    v_mov_b32 v7, 0
    ds_write_b64 v4, v[6:7]
    v_mov_b32 v6, 0
    ds_write_b64 v4, v[6:7] offset:16
    ds_write_b64 v4, v[6:7] offset:24
    ds_write_b64 v4, v[6:7] offset:32
    s_waitcnt lgkmcnt(0)
L_cw_5:
    s_barrier
    v_mov_b32 v4, 162816
    ds_read_b32 v4, v4
    s_waitcnt lgkmcnt(0)
    v_readfirstlane_b32 s17, v4
    s_branch L_p1_done
L_p1a_ld:
    s_add_u32 s36, s84, 0x0
    s_addc_u32 s37, s85, 0
    s_mov_b32 s38, 0x280000
    s_mov_b32 s39, 0x20000
    s_lshl_b32 s21, s18, 8
    s_lshl_b32 s22, s19, 3
    s_add_u32 s21, s21, s22
    s_and_b32 s22, s20, 3
    s_lshl_b32 s22, s22, 1
    s_add_u32 s21, s21, s22
    v_add_u32 v76, s21, v3
    v_mul_u32_u24 v77, 1280, v76
    v_lshl_add_u32 v77, v2, 4, v77
    buffer_load_dwordx4 v[64:67], v77, s[36:39], 0 offen
    buffer_load_dwordx4 v[68:71], v77, s[36:39], 0 offen offset:512
    v_lshrrev_b32 v72, 4, v2
    v_lshl_add_u32 v77, v72, 31, v77
    buffer_load_dwordx4 v[72:75], v77, s[36:39], 0 offen offset:1024
    v_mov_b32 v20, 0
    v_mov_b32 v21, 0
    s_lshl_b32 s21, s18, 8
    s_lshl_b32 s22, s19, 3
    s_add_u32 s21, s21, s22
    v_lshlrev_b32 v22, 11, v1
    v_add_u32 v22, s21, v22
    s_lshl_b32 s21, s18, 5
    s_add_u32 s21, s21, s19
    s_lshl_b32 s21, s21, 7
    s_add_u32 s21, s21, 0xfff90000
    v_lshlrev_b32 v23, 15, v1
    v_add_u32 v23, s21, v23
    v_cmp_gt_u32 vcc, 16, v1
    s_nop 1
    v_cndmask_b32 v22, v23, v22, vcc
    s_lshl_b32 s21, s16, 3
    s_add_u32 s21, s21, s20
    s_cmp_eq_u32 s21, 4
    s_cselect_b32 s22, 0x3ffff, 0
    s_mov_b32 s23, 0
    v_mov_b32 v23, 0x80000000
    v_cndmask_b32 v22, v23, v22, s[22:23]
    buffer_store_dwordx2 v[20:21], v22, s[72:75], 0 offen sc1
    s_add_u32 m0, s32, 33280
    s_nop 0
    buffer_load_dwordx4 v4, s[12:15], s31 offen lds
    s_add_u32 m0, s32, 34304
    s_nop 0
    buffer_load_dwordx4 v5, s[12:15], s31 offen lds
    s_add_u32 m0, s32, 35328
    s_nop 0
    buffer_load_dwordx4 v6, s[12:15], s31 offen lds
    s_add_u32 m0, s32, 36352
    s_nop 0
    buffer_load_dwordx4 v7, s[12:15], s31 offen lds
    s_add_u32 s31, s31, 245760
    s_cmp_ge_u32 s31, 2457600
    s_cselect_b32 s31, 0, s31
    s_waitcnt vmcnt(12)
    s_barrier
    s_waitcnt vmcnt(5)
    v_mov_b32 v80, 0
    v_mov_b32 v81, 0
    v_mov_b32 v82, 0x3f803f80
    v_dot2_f32_bf16 v80, v64, v82, v80
    v_dot2_f32_bf16 v81, v64, v64, v81
    v_dot2_f32_bf16 v80, v65, v82, v80
    v_dot2_f32_bf16 v81, v65, v65, v81
    v_dot2_f32_bf16 v80, v66, v82, v80
    v_dot2_f32_bf16 v81, v66, v66, v81
    v_dot2_f32_bf16 v80, v67, v82, v80
    v_dot2_f32_bf16 v81, v67, v67, v81
    v_dot2_f32_bf16 v80, v68, v82, v80
    v_dot2_f32_bf16 v81, v68, v68, v81
    v_dot2_f32_bf16 v80, v69, v82, v80
    v_dot2_f32_bf16 v81, v69, v69, v81
    v_dot2_f32_bf16 v80, v70, v82, v80
    v_dot2_f32_bf16 v81, v70, v70, v81
    v_dot2_f32_bf16 v80, v71, v82, v80
    v_dot2_f32_bf16 v81, v71, v71, v81
    v_dot2_f32_bf16 v80, v72, v82, v80
    v_dot2_f32_bf16 v81, v72, v72, v81
    v_dot2_f32_bf16 v80, v73, v82, v80
    v_dot2_f32_bf16 v81, v73, v73, v81
    v_dot2_f32_bf16 v80, v74, v82, v80
    v_dot2_f32_bf16 v81, v74, v74, v81
    v_dot2_f32_bf16 v80, v75, v82, v80
    v_dot2_f32_bf16 v81, v75, v75, v81
    s_nop 3
    v_add_f32_dpp v80, v80, v80 row_ror:1 row_mask:0xf bank_mask:0xf
    v_add_f32_dpp v81, v81, v81 row_ror:1 row_mask:0xf bank_mask:0xf
    s_nop 0
    v_add_f32_dpp v80, v80, v80 row_ror:2 row_mask:0xf bank_mask:0xf
    v_add_f32_dpp v81, v81, v81 row_ror:2 row_mask:0xf bank_mask:0xf
    s_nop 0
    v_add_f32_dpp v80, v80, v80 row_ror:4 row_mask:0xf bank_mask:0xf
    v_add_f32_dpp v81, v81, v81 row_ror:4 row_mask:0xf bank_mask:0xf
    s_nop 0
    v_add_f32_dpp v80, v80, v80 row_ror:8 row_mask:0xf bank_mask:0xf
    v_add_f32_dpp v81, v81, v81 row_ror:8 row_mask:0xf bank_mask:0xf
    v_mov_b32 v82, v80
    v_mov_b32 v83, v81
    s_nop 0
    v_permlane16_swap_b32 v80, v82
    v_permlane16_swap_b32 v81, v83
    v_add_f32 v80, v80, v82
    v_add_f32 v81, v81, v83
    v_mul_f32 v84, 0xbacccccd, v80
    v_mul_f32 v81, 0x3acccccd, v81
    v_fma_f32 v81, -v84, v84, v81
    v_max_f32 v81, 0, v81
    v_cvt_pk_bf16_f32 v84, v84, v84
    v_and_b32 v84, 0xffff0000, v84
    v_cvt_pk_bf16_f32 v81, v81, v81
    v_and_b32 v81, 0xffff0000, v81
    v_add_f32 v81, 0x3727c5ac, v81
    v_cvt_pk_bf16_f32 v81, v81, v81
    v_and_b32 v81, 0xffff0000, v81
    v_sqrt_f32 v81, v81
    s_nop 0
    v_cvt_pk_bf16_f32 v81, v81, v81
    v_and_b32 v81, 0xffff0000, v81
    v_rcp_f32 v85, v81
    v_mul_f32 v81, v81, v81
    s_add_u32 s36, s6, 0x1800000
    s_addc_u32 s37, s7, 0
    s_mov_b32 s38, 0x28000
    s_mov_b32 s39, 0x20000
    v_lshlrev_b32 v80, 3, v76
    s_mov_b32 exec_lo, 1
    s_mov_b32 exec_hi, 1
    buffer_store_dwordx2 v[84:85], v80, s[36:39], 0 offen sc1
    s_mov_b64 exec, -1
    s_add_u32 m0, s32, 49920
    s_nop 0
    buffer_load_dwordx4 v4, s[12:15], s31 offen lds
    s_add_u32 m0, s32, 50944
    s_nop 0
    buffer_load_dwordx4 v5, s[12:15], s31 offen lds
    s_add_u32 m0, s32, 51968
    s_nop 0
    buffer_load_dwordx4 v6, s[12:15], s31 offen lds
    s_add_u32 m0, s32, 52992
    s_nop 0
    buffer_load_dwordx4 v7, s[12:15], s31 offen lds
    s_add_u32 s31, s31, 245760
    s_cmp_ge_u32 s31, 2457600
    s_cselect_b32 s31, 0, s31
    v_bfe_u32 v20, v1, 2, 2
    v_mul_u32_u24 v9, 4160, v20
    v_mul_u32_u24 v20, 256, v3
    v_add_u32 v9, v9, v20
    v_bfe_u32 v20, v1, 4, 1
    v_mul_u32_u24 v20, 32, v20
    v_add_u32 v9, v9, v20
    v_and_b32 v20, 3, v1
    v_lshl_add_u32 v9, v20, 3, v9
    s_lshl_b32 s21, s26, 6
    v_add_u32 v9, s21, v9
    v_add_u32 v10, 49920, v9
    v_mov_b32 v244, 0x3f803f80
    v_mov_b32 v240, 0
    v_mov_b32 v241, 0
    v_mov_b32 v242, 0
    v_mov_b32 v243, 0
    ds_read_b64_tr_b16 v[32:33], v9 offset:0
    ds_read_b64_tr_b16 v[34:35], v9 offset:512
    ds_read_b64_tr_b16 v[36:37], v9 offset:1024
    ds_read_b64_tr_b16 v[38:39], v9 offset:1536
    ds_read_b64_tr_b16 v[40:41], v9 offset:2048
    ds_read_b64_tr_b16 v[42:43], v9 offset:2560
    ds_read_b64_tr_b16 v[44:45], v9 offset:3072
    ds_read_b64_tr_b16 v[46:47], v9 offset:3584
    s_waitcnt lgkmcnt(0)
    v_dot2_f32_bf16 v240, v32, v244, v240
    v_dot2_f32_bf16 v241, v33, v244, v241
    v_dot2_f32_bf16 v242, v34, v244, v242
    v_dot2_f32_bf16 v243, v35, v244, v243
    v_dot2_f32_bf16 v240, v36, v244, v240
    v_dot2_f32_bf16 v241, v37, v244, v241
    v_dot2_f32_bf16 v242, v38, v244, v242
    v_dot2_f32_bf16 v243, v39, v244, v243
    v_dot2_f32_bf16 v240, v40, v244, v240
    v_dot2_f32_bf16 v241, v41, v244, v241
    v_dot2_f32_bf16 v242, v42, v244, v242
    v_dot2_f32_bf16 v243, v43, v244, v243
    v_dot2_f32_bf16 v240, v44, v244, v240
    v_dot2_f32_bf16 v241, v45, v244, v241
    v_dot2_f32_bf16 v242, v46, v244, v242
    v_dot2_f32_bf16 v243, v47, v244, v243
    s_barrier
    s_add_u32 m0, s32, 66560
    s_nop 0
    buffer_load_dwordx4 v4, s[12:15], s31 offen lds
    s_add_u32 m0, s32, 67584
    s_nop 0
    buffer_load_dwordx4 v5, s[12:15], s31 offen lds
    s_add_u32 m0, s32, 68608
    s_nop 0
    buffer_load_dwordx4 v6, s[12:15], s31 offen lds
    s_add_u32 m0, s32, 69632
    s_nop 0
    buffer_load_dwordx4 v7, s[12:15], s31 offen lds
    s_add_u32 s31, s31, 245760
    s_cmp_ge_u32 s31, 2457600
    s_cselect_b32 s31, 0, s31
    ds_read_b64_tr_b16 v[32:33], v9 offset:16640
    ds_read_b64_tr_b16 v[34:35], v9 offset:17152
    ds_read_b64_tr_b16 v[36:37], v9 offset:17664
    ds_read_b64_tr_b16 v[38:39], v9 offset:18176
    ds_read_b64_tr_b16 v[40:41], v9 offset:18688
    ds_read_b64_tr_b16 v[42:43], v9 offset:19200
    ds_read_b64_tr_b16 v[44:45], v9 offset:19712
    ds_read_b64_tr_b16 v[46:47], v9 offset:20224
    s_waitcnt lgkmcnt(0)
    v_dot2_f32_bf16 v240, v32, v244, v240
    v_dot2_f32_bf16 v241, v33, v244, v241
    v_dot2_f32_bf16 v242, v34, v244, v242
    v_dot2_f32_bf16 v243, v35, v244, v243
    v_dot2_f32_bf16 v240, v36, v244, v240
    v_dot2_f32_bf16 v241, v37, v244, v241
    v_dot2_f32_bf16 v242, v38, v244, v242
    v_dot2_f32_bf16 v243, v39, v244, v243
    v_dot2_f32_bf16 v240, v40, v244, v240
    v_dot2_f32_bf16 v241, v41, v244, v241
    v_dot2_f32_bf16 v242, v42, v244, v242
    v_dot2_f32_bf16 v243, v43, v244, v243
    v_dot2_f32_bf16 v240, v44, v244, v240
    v_dot2_f32_bf16 v241, v45, v244, v241
    v_dot2_f32_bf16 v242, v46, v244, v242
    v_dot2_f32_bf16 v243, v47, v244, v243
    s_waitcnt vmcnt(9)
    s_barrier
    s_add_u32 m0, s32, 0
    s_nop 0
    buffer_load_dwordx4 v4, s[12:15], s31 offen lds
    s_add_u32 m0, s32, 1024
    s_nop 0
    buffer_load_dwordx4 v5, s[12:15], s31 offen lds
    s_add_u32 m0, s32, 2048
    s_nop 0
    buffer_load_dwordx4 v6, s[12:15], s31 offen lds
    s_add_u32 m0, s32, 3072
    s_nop 0
    buffer_load_dwordx4 v7, s[12:15], s31 offen lds
    s_add_u32 s31, s31, 245760
    s_cmp_ge_u32 s31, 2457600
    s_cselect_b32 s31, 0, s31
    ds_read_b64_tr_b16 v[32:33], v9 offset:33280
    ds_read_b64_tr_b16 v[34:35], v9 offset:33792
    ds_read_b64_tr_b16 v[36:37], v9 offset:34304
    ds_read_b64_tr_b16 v[38:39], v9 offset:34816
    ds_read_b64_tr_b16 v[40:41], v9 offset:35328
    ds_read_b64_tr_b16 v[42:43], v9 offset:35840
    ds_read_b64_tr_b16 v[44:45], v9 offset:36352
    ds_read_b64_tr_b16 v[46:47], v9 offset:36864
    s_waitcnt lgkmcnt(0)
    v_dot2_f32_bf16 v240, v32, v244, v240
    v_dot2_f32_bf16 v241, v33, v244, v241
    v_dot2_f32_bf16 v242, v34, v244, v242
    v_dot2_f32_bf16 v243, v35, v244, v243
    v_dot2_f32_bf16 v240, v36, v244, v240
    v_dot2_f32_bf16 v241, v37, v244, v241
    v_dot2_f32_bf16 v242, v38, v244, v242
    v_dot2_f32_bf16 v243, v39, v244, v243
    v_dot2_f32_bf16 v240, v40, v244, v240
    v_dot2_f32_bf16 v241, v41, v244, v241
    v_dot2_f32_bf16 v242, v42, v244, v242
    v_dot2_f32_bf16 v243, v43, v244, v243
    v_dot2_f32_bf16 v240, v44, v244, v240
    v_dot2_f32_bf16 v241, v45, v244, v241
    v_dot2_f32_bf16 v242, v46, v244, v242
    v_dot2_f32_bf16 v243, v47, v244, v243
    s_waitcnt vmcnt(8)
    s_barrier
    s_add_u32 m0, s32, 16640
    s_nop 0
    buffer_load_dwordx4 v4, s[12:15], s31 offen lds
    s_add_u32 m0, s32, 17664
    s_nop 0
    buffer_load_dwordx4 v5, s[12:15], s31 offen lds
    s_add_u32 m0, s32, 18688
    s_nop 0
    buffer_load_dwordx4 v6, s[12:15], s31 offen lds
    s_add_u32 m0, s32, 19712
    s_nop 0
    buffer_load_dwordx4 v7, s[12:15], s31 offen lds
    s_add_u32 s31, s31, 245760
    s_cmp_ge_u32 s31, 2457600
    s_cselect_b32 s31, 0, s31
    s_add_u32 s76, s4, 0x0
    s_addc_u32 s77, s5, 0
    s_mov_b32 s78, 0x100
    s_mov_b32 s79, 0x20000
    s_getreg_b32 s21, hwreg(HW_REG_XCC_ID)
    s_and_b32 s21, s21, 7
    s_lshl_b32 s21, s21, 3
    s_mov_b64 s[22:23], 1
    s_lshl_b64 s[22:23], s[22:23], s21
    v_mov_b32 v20, s22
    v_mov_b32 v21, s23
    s_lshl_b32 s21, s16, 3
    s_add_u32 s21, s21, s20
    s_lshl_b32 s22, s18, 5
    s_cmp_eq_u32 s21, 4
    s_cselect_b32 s21, s22, 0x80000000
    v_mov_b32 v22, s21
    s_mov_b64 exec, 1
    buffer_atomic_add_x2 v[20:21], v22, s[76:79], 0 offen sc1
    s_mov_b64 exec, -1
    ds_read_b64_tr_b16 v[32:33], v10 offset:0
    ds_read_b64_tr_b16 v[34:35], v10 offset:512
    ds_read_b64_tr_b16 v[36:37], v10 offset:1024
    ds_read_b64_tr_b16 v[38:39], v10 offset:1536
    ds_read_b64_tr_b16 v[40:41], v10 offset:2048
    ds_read_b64_tr_b16 v[42:43], v10 offset:2560
    ds_read_b64_tr_b16 v[44:45], v10 offset:3072
    ds_read_b64_tr_b16 v[46:47], v10 offset:3584
    s_waitcnt lgkmcnt(0)
    v_dot2_f32_bf16 v240, v32, v244, v240
    v_dot2_f32_bf16 v241, v33, v244, v241
    v_dot2_f32_bf16 v242, v34, v244, v242
    v_dot2_f32_bf16 v243, v35, v244, v243
    v_dot2_f32_bf16 v240, v36, v244, v240
    v_dot2_f32_bf16 v241, v37, v244, v241
    v_dot2_f32_bf16 v242, v38, v244, v242
    v_dot2_f32_bf16 v243, v39, v244, v243
    v_dot2_f32_bf16 v240, v40, v244, v240
    v_dot2_f32_bf16 v241, v41, v244, v241
    v_dot2_f32_bf16 v242, v42, v244, v242
    v_dot2_f32_bf16 v243, v43, v244, v243
    v_dot2_f32_bf16 v240, v44, v244, v240
    v_dot2_f32_bf16 v241, v45, v244, v241
    v_dot2_f32_bf16 v242, v46, v244, v242
    v_dot2_f32_bf16 v243, v47, v244, v243
    s_waitcnt vmcnt(9)
    s_barrier
    s_add_u32 m0, s32, 33280
    s_nop 0
    buffer_load_dwordx4 v4, s[12:15], s31 offen lds
    s_add_u32 m0, s32, 34304
    s_nop 0
    buffer_load_dwordx4 v5, s[12:15], s31 offen lds
    s_add_u32 m0, s32, 35328
    s_nop 0
    buffer_load_dwordx4 v6, s[12:15], s31 offen lds
    s_add_u32 m0, s32, 36352
    s_nop 0
    buffer_load_dwordx4 v7, s[12:15], s31 offen lds
    s_add_u32 s31, s31, 245760
    s_cmp_ge_u32 s31, 2457600
    s_cselect_b32 s31, 0, s31
    ds_read_b64_tr_b16 v[32:33], v10 offset:16640
    ds_read_b64_tr_b16 v[34:35], v10 offset:17152
    ds_read_b64_tr_b16 v[36:37], v10 offset:17664
    ds_read_b64_tr_b16 v[38:39], v10 offset:18176
    ds_read_b64_tr_b16 v[40:41], v10 offset:18688
    ds_read_b64_tr_b16 v[42:43], v10 offset:19200
    ds_read_b64_tr_b16 v[44:45], v10 offset:19712
    ds_read_b64_tr_b16 v[46:47], v10 offset:20224
    s_waitcnt lgkmcnt(0)
    v_dot2_f32_bf16 v240, v32, v244, v240
    v_dot2_f32_bf16 v241, v33, v244, v241
    v_dot2_f32_bf16 v242, v34, v244, v242
    v_dot2_f32_bf16 v243, v35, v244, v243
    v_dot2_f32_bf16 v240, v36, v244, v240
    v_dot2_f32_bf16 v241, v37, v244, v241
    v_dot2_f32_bf16 v242, v38, v244, v242
    v_dot2_f32_bf16 v243, v39, v244, v243
    v_dot2_f32_bf16 v240, v40, v244, v240
    v_dot2_f32_bf16 v241, v41, v244, v241
    v_dot2_f32_bf16 v242, v42, v244, v242
    v_dot2_f32_bf16 v243, v43, v244, v243
    v_dot2_f32_bf16 v240, v44, v244, v240
    v_dot2_f32_bf16 v241, v45, v244, v241
    v_dot2_f32_bf16 v242, v46, v244, v242
    v_dot2_f32_bf16 v243, v47, v244, v243
    s_waitcnt vmcnt(9)
    s_barrier
    s_add_u32 m0, s32, 49920
    s_nop 0
    buffer_load_dwordx4 v4, s[12:15], s31 offen lds
    s_add_u32 m0, s32, 50944
    s_nop 0
    buffer_load_dwordx4 v5, s[12:15], s31 offen lds
    s_add_u32 m0, s32, 51968
    s_nop 0
    buffer_load_dwordx4 v6, s[12:15], s31 offen lds
    s_add_u32 m0, s32, 52992
    s_nop 0
    buffer_load_dwordx4 v7, s[12:15], s31 offen lds
    s_add_u32 s31, s31, 245760
    s_cmp_ge_u32 s31, 2457600
    s_cselect_b32 s31, 0, s31
    ds_read_b64_tr_b16 v[32:33], v9 offset:0
    ds_read_b64_tr_b16 v[34:35], v9 offset:512
    ds_read_b64_tr_b16 v[36:37], v9 offset:1024
    ds_read_b64_tr_b16 v[38:39], v9 offset:1536
    ds_read_b64_tr_b16 v[40:41], v9 offset:2048
    ds_read_b64_tr_b16 v[42:43], v9 offset:2560
    ds_read_b64_tr_b16 v[44:45], v9 offset:3072
    ds_read_b64_tr_b16 v[46:47], v9 offset:3584
    s_waitcnt lgkmcnt(0)
    v_dot2_f32_bf16 v240, v32, v244, v240
    v_dot2_f32_bf16 v241, v33, v244, v241
    v_dot2_f32_bf16 v242, v34, v244, v242
    v_dot2_f32_bf16 v243, v35, v244, v243
    v_dot2_f32_bf16 v240, v36, v244, v240
    v_dot2_f32_bf16 v241, v37, v244, v241
    v_dot2_f32_bf16 v242, v38, v244, v242
    v_dot2_f32_bf16 v243, v39, v244, v243
    v_dot2_f32_bf16 v240, v40, v244, v240
    v_dot2_f32_bf16 v241, v41, v244, v241
    v_dot2_f32_bf16 v242, v42, v244, v242
    v_dot2_f32_bf16 v243, v43, v244, v243
    v_dot2_f32_bf16 v240, v44, v244, v240
    v_dot2_f32_bf16 v241, v45, v244, v241
    v_dot2_f32_bf16 v242, v46, v244, v242
    v_dot2_f32_bf16 v243, v47, v244, v243
    s_waitcnt vmcnt(9)
    s_barrier
    s_add_u32 m0, s32, 66560
    s_nop 0
    buffer_load_dwordx4 v4, s[12:15], s31 offen lds
    s_add_u32 m0, s32, 67584
    s_nop 0
    buffer_load_dwordx4 v5, s[12:15], s31 offen lds
    s_add_u32 m0, s32, 68608
    s_nop 0
    buffer_load_dwordx4 v6, s[12:15], s31 offen lds
    s_add_u32 m0, s32, 69632
    s_nop 0
    buffer_load_dwordx4 v7, s[12:15], s31 offen lds
    ds_read_b64_tr_b16 v[32:33], v9 offset:16640
    ds_read_b64_tr_b16 v[34:35], v9 offset:17152
    ds_read_b64_tr_b16 v[36:37], v9 offset:17664
    ds_read_b64_tr_b16 v[38:39], v9 offset:18176
    ds_read_b64_tr_b16 v[40:41], v9 offset:18688
    ds_read_b64_tr_b16 v[42:43], v9 offset:19200
    ds_read_b64_tr_b16 v[44:45], v9 offset:19712
    ds_read_b64_tr_b16 v[46:47], v9 offset:20224
    s_waitcnt lgkmcnt(0)
    v_dot2_f32_bf16 v240, v32, v244, v240
    v_dot2_f32_bf16 v241, v33, v244, v241
    v_dot2_f32_bf16 v242, v34, v244, v242
    v_dot2_f32_bf16 v243, v35, v244, v243
    v_dot2_f32_bf16 v240, v36, v244, v240
    v_dot2_f32_bf16 v241, v37, v244, v241
    v_dot2_f32_bf16 v242, v38, v244, v242
    v_dot2_f32_bf16 v243, v39, v244, v243
    v_dot2_f32_bf16 v240, v40, v244, v240
    v_dot2_f32_bf16 v241, v41, v244, v241
    v_dot2_f32_bf16 v242, v42, v244, v242
    v_dot2_f32_bf16 v243, v43, v244, v243
    v_dot2_f32_bf16 v240, v44, v244, v240
    v_dot2_f32_bf16 v241, v45, v244, v241
    v_dot2_f32_bf16 v242, v46, v244, v242
    v_dot2_f32_bf16 v243, v47, v244, v243
    s_waitcnt vmcnt(8)
    s_barrier
    ds_read_b64_tr_b16 v[32:33], v9 offset:33280
    ds_read_b64_tr_b16 v[34:35], v9 offset:33792
    ds_read_b64_tr_b16 v[36:37], v9 offset:34304
    ds_read_b64_tr_b16 v[38:39], v9 offset:34816
    ds_read_b64_tr_b16 v[40:41], v9 offset:35328
    ds_read_b64_tr_b16 v[42:43], v9 offset:35840
    ds_read_b64_tr_b16 v[44:45], v9 offset:36352
    ds_read_b64_tr_b16 v[46:47], v9 offset:36864
    s_waitcnt lgkmcnt(0)
    v_dot2_f32_bf16 v240, v32, v244, v240
    v_dot2_f32_bf16 v241, v33, v244, v241
    v_dot2_f32_bf16 v242, v34, v244, v242
    v_dot2_f32_bf16 v243, v35, v244, v243
    v_dot2_f32_bf16 v240, v36, v244, v240
    v_dot2_f32_bf16 v241, v37, v244, v241
    v_dot2_f32_bf16 v242, v38, v244, v242
    v_dot2_f32_bf16 v243, v39, v244, v243
    v_dot2_f32_bf16 v240, v40, v244, v240
    v_dot2_f32_bf16 v241, v41, v244, v241
    v_dot2_f32_bf16 v242, v42, v244, v242
    v_dot2_f32_bf16 v243, v43, v244, v243
    v_dot2_f32_bf16 v240, v44, v244, v240
    v_dot2_f32_bf16 v241, v45, v244, v241
    v_dot2_f32_bf16 v242, v46, v244, v242
    v_dot2_f32_bf16 v243, v47, v244, v243
    s_cmp_lg_u32 s20, 4
    s_cbranch_scc1 L_cw_8
    s_add_u32 s76, s4, 0x0
    s_addc_u32 s77, s5, 0
    s_mov_b32 s78, 0x100
    s_mov_b32 s79, 0x20000
    s_sub_u32 s21, s18, 1
    s_max_i32 s21, s21, 0
    v_mov_b32 v20, s18
    v_mov_b32 v21, s21
    v_cmp_eq_u32 vcc, 0, v1
    s_nop 1
    v_cndmask_b32 v20, v21, v20, vcc
    v_lshlrev_b32 v20, 5, v20
    s_mov_b32 s35, 0
    s_nop 0
L_cen_9:
    buffer_load_dwordx2 v[22:23], v20, s[76:79], 0 offen sc1
    s_waitcnt vmcnt(0)
    v_sad_u8 v21, v22, 0, 0
    v_sad_u8 v21, v23, 0, v21
    v_cmp_ne_u32 vcc, 32, v21
    s_add_u32 s35, s35, 1
    s_cmp_gt_u32 s35, 65536
    s_cbranch_scc1 L_cenx_10
    s_cbranch_vccz L_cenx_10
    s_sleep 4
    s_branch L_cen_9
L_cenx_10:
    v_readfirstlane_b32 s22, v22
    v_readfirstlane_b32 s23, v23
    s_bcnt1_i32_b64 s21, s[22:23]
    s_cmp_eq_u32 s21, 1
    s_cselect_b32 s17, 1, 0
    v_mov_b32 v20, 162816
    v_mov_b32 v22, s17
    v_mov_b32 v23, 0
    ds_write_b64 v20, v[22:23]
    v_mov_b32 v22, 0
    ds_write_b64 v20, v[22:23] offset:16
    ds_write_b64 v20, v[22:23] offset:24
    ds_write_b64 v20, v[22:23] offset:32
L_cw_8:
    s_waitcnt vmcnt(4)
    s_barrier
    ds_read_b64_tr_b16 v[32:33], v10 offset:0
    ds_read_b64_tr_b16 v[34:35], v10 offset:512
    ds_read_b64_tr_b16 v[36:37], v10 offset:1024
    ds_read_b64_tr_b16 v[38:39], v10 offset:1536
    ds_read_b64_tr_b16 v[40:41], v10 offset:2048
    ds_read_b64_tr_b16 v[42:43], v10 offset:2560
    ds_read_b64_tr_b16 v[44:45], v10 offset:3072
    ds_read_b64_tr_b16 v[46:47], v10 offset:3584
    v_add_u32 v20, s27, v2
    v_lshlrev_b32 v20, 3, v20
    buffer_load_dwordx2 v[16:17], v20, s[36:39], 0 offen sc1
    s_waitcnt lgkmcnt(0)
    v_dot2_f32_bf16 v240, v32, v244, v240
    v_dot2_f32_bf16 v241, v33, v244, v241
    v_dot2_f32_bf16 v242, v34, v244, v242
    v_dot2_f32_bf16 v243, v35, v244, v243
    v_dot2_f32_bf16 v240, v36, v244, v240
    v_dot2_f32_bf16 v241, v37, v244, v241
    v_dot2_f32_bf16 v242, v38, v244, v242
    v_dot2_f32_bf16 v243, v39, v244, v243
    v_dot2_f32_bf16 v240, v40, v244, v240
    v_dot2_f32_bf16 v241, v41, v244, v241
    v_dot2_f32_bf16 v242, v42, v244, v242
    v_dot2_f32_bf16 v243, v43, v244, v243
    v_dot2_f32_bf16 v240, v44, v244, v240
    v_dot2_f32_bf16 v241, v45, v244, v241
    v_dot2_f32_bf16 v242, v46, v244, v242
    v_dot2_f32_bf16 v243, v47, v244, v243
    s_waitcnt vmcnt(1)
    s_barrier
    ds_read_b64_tr_b16 v[32:33], v10 offset:16640
    ds_read_b64_tr_b16 v[34:35], v10 offset:17152
    ds_read_b64_tr_b16 v[36:37], v10 offset:17664
    ds_read_b64_tr_b16 v[38:39], v10 offset:18176
    ds_read_b64_tr_b16 v[40:41], v10 offset:18688
    ds_read_b64_tr_b16 v[42:43], v10 offset:19200
    ds_read_b64_tr_b16 v[44:45], v10 offset:19712
    ds_read_b64_tr_b16 v[46:47], v10 offset:20224
    s_waitcnt lgkmcnt(0)
    v_dot2_f32_bf16 v240, v32, v244, v240
    v_dot2_f32_bf16 v241, v33, v244, v241
    v_dot2_f32_bf16 v242, v34, v244, v242
    v_dot2_f32_bf16 v243, v35, v244, v243
    v_dot2_f32_bf16 v240, v36, v244, v240
    v_dot2_f32_bf16 v241, v37, v244, v241
    v_dot2_f32_bf16 v242, v38, v244, v242
    v_dot2_f32_bf16 v243, v39, v244, v243
    v_dot2_f32_bf16 v240, v40, v244, v240
    v_dot2_f32_bf16 v241, v41, v244, v241
    v_dot2_f32_bf16 v242, v42, v244, v242
    v_dot2_f32_bf16 v243, v43, v244, v243
    v_dot2_f32_bf16 v240, v44, v244, v240
    v_dot2_f32_bf16 v241, v45, v244, v241
    v_dot2_f32_bf16 v242, v46, v244, v242
    v_dot2_f32_bf16 v243, v47, v244, v243
    s_nop 3
    v_add_f32 v240, v240, v241
    v_add_f32 v242, v242, v243
    v_add_f32 v240, v240, v242
    v_mov_b32 v241, v240
    s_nop 1
    v_permlane32_swap_b32 v240, v241
    v_add_f32 v240, v240, v241
    s_lshl_b32 s21, s26, 7
    s_add_u32 s21, s21, 161792
    v_lshlrev_b32 v20, 2, v2
    v_add_u32 v20, s21, v20
    ds_write_b32 v20, v240
    s_waitcnt vmcnt(0)
    s_cmp_lt_u32 s28, 5
    s_cselect_b32 s21, 0x3ea52b5c, 1.0
    v_mul_f32 v17, s21, v17
    s_lshl_b32 s21, s26, 8
    s_add_u32 s21, s21, 160768
    v_lshlrev_b32 v20, 3, v2
    v_add_u32 v20, s21, v20
    ds_write_b64 v20, v[16:17]
    s_waitcnt lgkmcnt(0)
    s_barrier
    v_mov_b32 v20, 162816
    ds_read_b32 v20, v20
    s_waitcnt lgkmcnt(0)
    v_readfirstlane_b32 s17, v20
    s_branch L_p1_done
L_p1b_idle:
    s_branch L_p1_done
    .p2align 4
L_code_end:
.section .rodata,"a"
.p2align 6
.amdhsa_kernel interleave_layers__sliding_block__glu_gated_geglu__prompt_kernel
  .amdhsa_next_free_vgpr 256
  .amdhsa_next_free_sgpr 102
  .amdhsa_accum_offset 256
  .amdhsa_group_segment_fixed_size 0
  .amdhsa_kernarg_size 80
  .amdhsa_user_sgpr_count 2
  .amdhsa_user_sgpr_kernarg_segment_ptr 1
  .amdhsa_system_sgpr_workgroup_id_x 1
.end_amdhsa_kernel
```
